```python
import torch

def _softmax(x, axis=-1):
    return torch.softmax(x, dim=axis)

def _gelu(x):
    return torch.nn.functional.gelu(x, approximate='tanh')

def _silu(x):
    return torch.nn.functional.silu(x)

def _sigmoid(x):
    return torch.sigmoid(x)

def _layernorm(x, axis=-1, eps=1e-05):
    m = x.mean(dim=axis, keepdim=True)
    v = x.var(dim=axis, keepdim=True, unbiased=False)
    return (x - m) / torch.sqrt(v + eps)

def _scatter_add(tgt, idx, src, axis=0):
    return tgt.clone().index_add_(axis, idx, src)

def _segment_sum(src, seg, n):
    out = torch.zeros((n,) + src.shape[1:], dtype=src.dtype)
    return out.index_add_(0, seg, src)

def _pad(x, pw):
    flat = tuple((v for pair in reversed(pw) for v in pair))
    return torch.nn.functional.pad(x, flat)
kernel_name = 'recurrent_scan__memory_aug_recurrent_mem_tr__dense_activation_mish__prompt'

def setup_inputs():

    _w = lambda a: (lambda t: t.to(torch.bfloat16) if t.is_floating_point() else t)(torch.as_tensor(a))

    def _A_setup():
        B, S, Dm = (1, 2048, 640)
        H, Dh = (32, 128)
        M, seg = (8, 32)
        seg = min(seg, S)
        S = S // seg * seg
        return {'x': _w((lambda *s: torch.randn(*s, dtype=torch.bfloat16) * 0.05)(B, S, Dm)), 'mem0': _w((lambda *s: torch.randn(*s, dtype=torch.bfloat16) * 0.8)(B, M, Dm)), 'Wq': _w((lambda *s: torch.randn(*s, dtype=torch.bfloat16) * 0.8)(Dm, H, Dh) * Dm ** (-0.5)), 'Wk': _w((lambda *s: torch.randn(*s, dtype=torch.bfloat16) * 0.8)(Dm, H, Dh) * Dm ** (-0.5)), 'Wv': _w((lambda *s: torch.randn(*s, dtype=torch.bfloat16) * 0.8)(Dm, H, Dh) * Dm ** (-0.5)), 'Wo': _w((lambda *s: torch.randn(*s, dtype=torch.bfloat16) * 0.8)(H, Dh, Dm) * (H * Dh) ** (-0.5)), 'seg_len': seg}
    _A_in = _A_setup()

    def _B_setup():
        B, S, D, F = (1, 2048, 640, 1728)
        return {'x': _w((lambda *s: torch.randn(*s, dtype=torch.bfloat16) * 0.05)(B, S, D)), 'w1': _w((lambda *s: torch.randn(*s, dtype=torch.bfloat16) * 0.8)(D, F) * D ** (-0.5)), 'b1': _w((lambda *s: torch.randn(*s, dtype=torch.bfloat16) * 0.4)(F)), 'w2': _w((lambda *s: torch.randn(*s, dtype=torch.bfloat16) * 0.2)(F, D) * F ** (-0.5))}
    _B_in = _B_setup()
    return {'A_x': _A_in['x'], 'A_mem0': _A_in['mem0'], 'A_Wq': _A_in['Wq'], 'A_Wk': _A_in['Wk'], 'A_Wv': _A_in['Wv'], 'A_Wo': _A_in['Wo'], 'A_seg_len': _A_in['seg_len'], 'B_x': _B_in['x'], 'B_w1': _B_in['w1'], 'B_b1': _B_in['b1'], 'B_w2': _B_in['w2']}

def reference(A_x, A_mem0, A_Wq, A_Wk, A_Wv, A_Wo, A_seg_len, B_x, B_w1, B_b1, B_w2):

    def _A_ref(x, mem0, Wq, Wk, Wv, Wo, seg_len):
        B, S, Dm = x.shape
        H, Dh = (Wq.shape[1], Wq.shape[2])
        M = mem0.shape[1]
        scale = Dh ** (-0.5)
        n_seg = S // seg_len
        L = M + seg_len
        idx = torch.arange(L)
        mask = (idx[:, None] < M) | (idx[:, None] >= idx[None, :])
        mem = mem0
        outs = []
        for s in range(n_seg):
            xs = x[:, s * seg_len:(s + 1) * seg_len, :].clone()
            h = torch.concatenate([mem, xs], axis=1)
            q = torch.einsum('btd,dhe->bhte', h, Wq)
            k = torch.einsum('btd,dhe->bhte', h, Wk)
            v = torch.einsum('btd,dhe->bhte', h, Wv)
            scores = torch.einsum('bhqe,bhke->bhqk', q, k) * scale
            scores = torch.where(mask[None, None], scores, -1000000000.0)
            p = _softmax(scores, axis=-1)
            o = torch.einsum('bhqk,bhke->bhqe', p, v)
            o = torch.einsum('bhte,hed->btd', o, Wo)
            mem = o[:, :M, :].clone()
            outs.append(o[:, M:, :])
        return torch.concatenate(outs, axis=1)

    def _B_ref(x, w1, b1, w2):
        h = torch.einsum('bsd,df->bsf', x, w1) + b1
        sp = torch.log1p(torch.exp(-torch.abs(h))) + torch.where(h > 0, h, torch.zeros_like(h))
        act = h * torch.tanh(sp)
        return torch.einsum('bsf,fd->bsd', act, w2)
    x = A_x
    xn = _layernorm(x, axis=-1)
    s = _A_ref(xn, A_mem0, A_Wq, A_Wk, A_Wv, A_Wo, A_seg_len)
    g = _silu(_B_ref(xn, B_w1, B_b1, B_w2))
    return x + s * g
```

```asm
; @launch grid=(256,1,1) block=(256,1,1) lds=163840
.amdgcn_target "amdgcn-amd-amdhsa--gfx950"
.text
.globl recurrent_scan__memory_aug_recurrent_mem_tr__dense_activation_mish__prompt_kernel
.p2align 8
.type recurrent_scan__memory_aug_recurrent_mem_tr__dense_activation_mish__prompt_kernel,@function
recurrent_scan__memory_aug_recurrent_mem_tr__dense_activation_mish__prompt_kernel:
    s_cmp_ge_u32 s2, 256
    s_cbranch_scc1 Lend
    s_load_dwordx16 s[4:19], s[0:1], 0
    s_load_dwordx8 s[20:27], s[0:1], 64
    s_load_dwordx4 s[28:31], s[0:1], 96
    s_waitcnt lgkmcnt(0)
    s_mov_b32 s32, s30
    s_and_b32 s33, s31, 0xffff
    s_mov_b32 s34, 0x10000000
    s_mov_b32 s35, 0x00020000
    s_mov_b32 s44, s28
    s_and_b32 s45, s29, 0xffff
    s_mov_b32 s46, 0x100
    s_mov_b32 s47, 0x00020000
    v_lshrrev_b32 v1, 6, v0
    s_nop 0
    v_readfirstlane_b32 s3, v1
    s_nop 0
    s_mov_b32 s60, s3
    s_getreg_b32 s58, hwreg(HW_REG_XCC_ID)
    s_and_b32 s58, s58, 7
    v_mov_b32 v3, 20480
    s_cmp_lg_u32 s60, 0
    s_cbranch_scc1 Lrk_1
    s_cmp_lt_u32 s58, 2
    s_cbranch_scc1 Lrk_1w
    s_sleep 22
Lrk_1w:
    s_mov_b64 exec, 1
    v_mov_b32 v1, 1
    s_lshl_b32 s59, s58, 2
    v_mov_b32 v2, s59
    buffer_atomic_add v1, v2, s[44:47], 0 offen sc0 sc1
    s_waitcnt vmcnt(0)
    v_mov_b32 v2, 0
    ds_write2_b32 v3, v1, v2 offset1:1
    s_waitcnt lgkmcnt(0)
    s_mov_b64 exec, -1
Lrk_1:
    s_barrier
    ds_read_b32 v1, v3
    s_waitcnt lgkmcnt(0)
    v_readfirstlane_b32 s59, v1
    s_nop 0
    s_cmp_ge_u32 s59, 32
    s_cbranch_scc1 Lend
    s_and_b32 s61, s59, 7
    s_lshl_b32 s61, s61, 2
    s_lshr_b32 s62, s59, 3
    s_add_u32 s62, s62, 1
    s_and_b32 s62, s62, 3
    s_or_b32 s61, s61, s62
    s_cmp_lt_u32 s58, 2
    s_cselect_b32 s59, s61, s59
    s_sub_u32 s101, s58, 2
    s_lshl_b32 s101, s101, 5
    s_add_u32 s101, s101, s59
    s_cmp_ge_u32 s58, 2
    s_cbranch_scc1 Lworker
    v_and_b32 v16, 63, v0
    v_lshlrev_b32 v0, 4, v16
    s_mul_i32 s79, s60, 34816
    s_add_u32 s79, s79, 24576
    v_add_u32 v1, s79, v0
    s_mov_b32 s70, 0x80000
    s_mov_b32 s84, 0
    s_lshl_b32 s71, s58, 13
    s_add_u32 s62, s71, 88080384
    s_lshl_b32 s74, s58, 14
    s_sub_u32 s63, 92291072, s74
    s_lshl_b32 s72, s60, 5
    s_add_u32 s72, s72, s59
    s_cmp_lt_u32 s72, 80
    s_cselect_b32 s75, 1, 0
    s_add_u32 s72, s72, 16
    s_cmp_ge_u32 s72, 80
    s_cselect_b32 s73, 80, 0
    s_sub_u32 s72, s72, s73
    s_mul_i32 s73, s58, 163840
    s_add_u32 s73, s73, 96468992
    s_lshl_b32 s67, s72, 11
    s_add_u32 s67, s67, s73
    s_lshl_b32 s66, s59, 6
    s_add_u32 s66, s66, s73
    s_lshl_b32 s73, s60, 13
    s_add_u32 s85, s66, s73
    s_lshl_b32 s73, s60, 15
    s_add_u32 s66, s66, s73
    s_add_u32 s66, s66, 32768
    s_lshl_b32 s73, s72, 6
    s_add_u32 s73, s73, s71
    s_add_u32 s64, s73, 88096768
    s_add_u32 s73, s73, s71
    s_add_u32 s65, s73, 92307456
    s_lshl_b32 s72, s59, 8
    s_add_u32 s72, s72, s71
    s_add_u32 s77, s72, 88080384
    s_add_u32 s72, s72, s71
    s_add_u32 s78, s72, 92274688
    s_lshl_b32 s68, s59, 13
    s_lshl_b32 s83, s60, 11
    s_add_u32 s83, s83, s68
    s_lshr_b32 s69, s83, 2
    s_add_u32 s83, s83, 37748736
    s_add_u32 s68, s68, 20971520
    s_cmp_eq_u32 s58, 0
    s_cselect_b64 s[54:55], 0, -1
    s_and_b32 s72, s54, 4194304
    s_add_u32 s69, s69, s72
    s_add_u32 s69, s69, 79691776
    s_mov_b32 s76, 0.12751743082459868
    s_mov_b32 s61, 0
    s_cmp_ge_u32 s59, 20
    s_cselect_b32 s77, 0x10000000, s77
    s_cmp_lg_u32 s60, 3
    s_cselect_b32 s77, 0x10000000, s77
    s_cmp_eq_u32 s77, 0x10000000
    s_cbranch_scc1 Lnoinit_4
    s_mov_b32 s36, s6
    s_and_b32 s37, s7, 0xffff
    s_mov_b32 s38, 0x2800
    s_mov_b32 s39, 0x00020000
    s_mov_b64 exec, 0xffff
    s_sub_u32 s72, s59, 4
    s_lshr_b32 s73, s72, 2
    s_mul_i32 s73, s73, 160
    s_and_b32 s72, s72, 3
    s_lshl_b32 s72, s72, 4
    s_add_u32 s72, s72, s73
    s_mul_i32 s73, s59, 160
    s_add_u32 s73, s73, 128
    s_cmp_lt_u32 s59, 4
    s_cselect_b32 s72, s73, s72
    s_cselect_b32 s73, 16, 8
    s_cselect_b32 s56, 4, 64
    s_cselect_b32 s57, 8, 4
    s_mul_i32 s71, s58, 640
    s_add_u32 s72, s72, s71
    v_bfe_u32 v20, v0, 4, 3
    v_mul_u32_u24 v20, 1280, v20
    v_bfe_u32 v21, v0, 7, 1
    v_mul_u32_u24 v21, s73, v21
    v_add_u32 v20, v20, v21
    buffer_load_dword v36, v20, s[36:39], s72 offen
    s_add_u32 s73, s72, s56
    buffer_load_dword v37, v20, s[36:39], s73 offen
    s_add_u32 s72, s72, s57
    buffer_load_dword v38, v20, s[36:39], s72 offen
    s_add_u32 s73, s72, s56
    buffer_load_dword v39, v20, s[36:39], s73 offen
    s_mov_b64 exec, -1
Lnoinit_4:
    s_mov_b32 s36, s8
    s_and_b32 s37, s9, 0xffff
    s_mov_b32 s38, 0x500000
    s_mov_b32 s39, 0x00020000
    s_mov_b32 s40, s10
    s_and_b32 s41, s11, 0xffff
    s_mov_b32 s42, 0x500000
    s_mov_b32 s43, 0x00020000
    s_mov_b32 s48, s12
    s_and_b32 s49, s13, 0xffff
    s_mov_b32 s50, 0x500000
    s_mov_b32 s51, 0x00020000
    s_mov_b32 s96, s14
    s_and_b32 s97, s15, 0xffff
    s_mov_b32 s98, 0x500000
    s_mov_b32 s99, 0x00020000
    v_bfe_u32 v80, v0, 7, 1
    v_lshlrev_b32 v80, 18, v80
    v_bfe_u32 v18, v0, 9, 1
    v_lshl_add_u32 v80, v18, 13, v80
    v_bfe_u32 v18, v0, 8, 1
    v_lshl_add_u32 v80, v18, 14, v80
    v_bfe_u32 v18, v0, 4, 3
    v_lshl_add_u32 v80, v18, 4, v80
    v_bfe_u32 v81, v0, 7, 1
    v_lshlrev_b32 v81, 14, v81
    v_bfe_u32 v18, v0, 9, 1
    v_lshl_add_u32 v81, v18, 13, v81
    v_bfe_u32 v18, v0, 8, 1
    v_lshl_add_u32 v81, v18, 15, v81
    v_bfe_u32 v18, v0, 4, 3
    v_lshl_add_u32 v81, v18, 4, v81
    s_lshl_b32 s71, s59, 8
    s_and_b32 s72, s60, 2
    s_lshl_b32 s72, s72, 6
    s_add_u32 s71, s71, s72
    s_mul_i32 s80, s58, 2621440
    s_sub_u32 s81, 2621440, s80
    s_add_u32 s80, s80, s71
    s_add_u32 s81, s81, s71
    s_and_b32 s82, s60, 1
    s_xor_b32 s72, s60, 0
    s_mul_i32 s72, s72, 655360
    s_add_u32 s72, s80, s72
    s_add_u32 m0, s79, 0
    s_add_u32 s71, s72, 0
    buffer_load_dwordx4 v80, s[36:39], s71 offen lds
    s_add_u32 m0, s79, 1024
    s_add_u32 s71, s72, 32768
    buffer_load_dwordx4 v80, s[36:39], s71 offen lds
    s_add_u32 m0, s79, 2048
    s_add_u32 s71, s72, 65536
    buffer_load_dwordx4 v80, s[36:39], s71 offen lds
    s_add_u32 m0, s79, 3072
    s_add_u32 s71, s72, 98304
    buffer_load_dwordx4 v80, s[36:39], s71 offen lds
    s_xor_b32 s72, s60, 0
    s_mul_i32 s72, s72, 655360
    s_add_u32 s72, s80, s72
    s_add_u32 m0, s79, 4096
    s_add_u32 s71, s72, 131072
    buffer_load_dwordx4 v80, s[36:39], s71 offen lds
    s_add_u32 m0, s79, 5120
    s_add_u32 s71, s72, 163840
    buffer_load_dwordx4 v80, s[36:39], s71 offen lds
    s_add_u32 m0, s79, 6144
    s_add_u32 s71, s72, 196608
    buffer_load_dwordx4 v80, s[36:39], s71 offen lds
    s_add_u32 m0, s79, 7168
    s_add_u32 s71, s72, 229376
    buffer_load_dwordx4 v80, s[36:39], s71 offen lds
    s_xor_b32 s72, s60, 2
    s_mul_i32 s72, s72, 655360
    s_add_u32 s72, s80, s72
    s_add_u32 m0, s79, 8192
    s_add_u32 s71, s72, 0
    buffer_load_dwordx4 v80, s[36:39], s71 offen lds
    s_add_u32 m0, s79, 9216
    s_add_u32 s71, s72, 32768
    buffer_load_dwordx4 v80, s[36:39], s71 offen lds
    s_add_u32 m0, s79, 10240
    s_add_u32 s71, s72, 65536
    buffer_load_dwordx4 v80, s[36:39], s71 offen lds
    s_add_u32 m0, s79, 11264
    s_add_u32 s71, s72, 98304
    buffer_load_dwordx4 v80, s[36:39], s71 offen lds
    s_xor_b32 s72, s60, 2
    s_mul_i32 s72, s72, 655360
    s_add_u32 s72, s80, s72
    s_add_u32 m0, s79, 12288
    s_add_u32 s71, s72, 131072
    buffer_load_dwordx4 v80, s[36:39], s71 offen lds
    s_add_u32 m0, s79, 13312
    s_add_u32 s71, s72, 163840
    buffer_load_dwordx4 v80, s[36:39], s71 offen lds
    s_add_u32 m0, s79, 14336
    s_add_u32 s71, s72, 196608
    buffer_load_dwordx4 v80, s[36:39], s71 offen lds
    s_add_u32 m0, s79, 15360
    s_add_u32 s71, s72, 229376
    buffer_load_dwordx4 v80, s[36:39], s71 offen lds
    s_mul_i32 s72, s82, 1310720
    s_add_u32 s72, s80, s72
    s_add_u32 m0, s79, 16384
    s_add_u32 s71, s72, 524288
    buffer_load_dwordx4 v81, s[36:39], s71 offen lds
    s_add_u32 m0, s79, 17408
    s_add_u32 s71, s72, 589824
    buffer_load_dwordx4 v81, s[36:39], s71 offen lds
    s_add_u32 m0, s79, 18432
    s_add_u32 s71, s72, 1179648
    buffer_load_dwordx4 v81, s[36:39], s71 offen lds
    s_add_u32 m0, s79, 19456
    s_add_u32 s71, s72, 1245184
    buffer_load_dwordx4 v81, s[36:39], s71 offen lds
    s_xor_b32 s72, s60, 0
    s_mul_i32 s72, s72, 655360
    s_add_u32 s72, s80, s72
    s_add_u32 m0, s79, 20480
    s_add_u32 s71, s72, 0
    buffer_load_dwordx4 v80, s[48:51], s71 offen lds
    s_add_u32 m0, s79, 21504
    s_add_u32 s71, s72, 32768
    buffer_load_dwordx4 v80, s[48:51], s71 offen lds
    s_add_u32 m0, s79, 22528
    s_add_u32 s71, s72, 65536
    buffer_load_dwordx4 v80, s[48:51], s71 offen lds
    s_add_u32 m0, s79, 23552
    s_add_u32 s71, s72, 98304
    buffer_load_dwordx4 v80, s[48:51], s71 offen lds
    v_lshrrev_b32 v16, 4, v0
    v_bfe_u32 v10, v16, 4, 2
    v_lshlrev_b32 v10, 7, v10
    v_bfe_u32 v19, v16, 0, 3
    v_lshl_add_u32 v10, v19, 4, v10
    s_lshl_b32 s71, s60, 10
    v_add_u32 v9, s71, v10
    v_add_u32 v11, s71, v0
    s_mov_b32 s56, 0x00ff00ff
    s_mov_b32 s57, 0x00ff00ff
    v_mov_b32 v2, 0x4444
    v_mov_b32 v19, 0xeeee
    v_cndmask_b32 v2, v19, v2, s[56:57]
    s_mov_b32 s52, 0x33333333
    s_mov_b32 s53, 0x33333333
    s_mov_b64 vcc, s[52:53]
    v_or_b32 v19, 0xf1490000, v2
    v_cndmask_b32 v2, v19, v2, vcc
    s_lshl_b32 s71, s60, 8
    s_add_u32 s71, s71, 8192
    v_bfe_u32 v3, v16, 5, 1
    v_lshlrev_b32 v3, 7, v3
    v_bfe_u32 v19, v16, 0, 4
    v_lshl_add_u32 v3, v19, 3, v3
    v_add_u32 v3, s71, v3
    v_bfe_u32 v19, v16, 4, 1
    v_mul_u32_u24 v19, 2176, v19
    v_add_u32 v3, v3, v19
    v_bfe_u32 v4, v16, 5, 1
    v_lshlrev_b32 v4, 7, v4
    v_bfe_u32 v19, v16, 4, 1
    v_lshl_add_u32 v4, v19, 5, v4
    v_bfe_u32 v19, v16, 2, 2
    v_lshl_add_u32 v4, v19, 3, v4
    v_add_u32 v4, 8192, v4
    v_bfe_u32 v18, v16, 0, 1
    v_lshlrev_b32 v18, 1, v18
    v_bfe_u32 v19, v16, 1, 1
    v_lshl_add_u32 v18, v19, 0, v18
    v_mul_u32_u24 v18, 1088, v18
    v_add_u32 v4, v4, v18
    v_bfe_u32 v8, v16, 5, 1
    v_lshlrev_b32 v8, 14, v8
    v_bfe_u32 v19, v16, 2, 2
    v_lshl_add_u32 v8, v19, 12, v8
    v_bfe_u32 v19, v16, 4, 1
    v_lshl_add_u32 v8, v19, 11, v8
    v_bfe_u32 v19, v16, 0, 2
    v_lshl_add_u32 v8, v19, 4, v8
    v_bfe_u32 v6, v16, 4, 2
    v_lshlrev_b32 v6, 9, v6
    v_bfe_u32 v19, v16, 0, 4
    v_lshl_add_u32 v6, v19, 4, v6
    v_bfe_u32 v7, v16, 5, 1
    v_lshlrev_b32 v7, 7, v7
    v_bfe_u32 v19, v16, 4, 1
    v_lshl_add_u32 v7, v19, 3, v7
    v_bfe_u32 v19, v16, 2, 1
    v_lshl_add_u32 v7, v19, 6, v7
    v_bfe_u32 v19, v16, 3, 1
    v_lshl_add_u32 v7, v19, 5, v7
    v_bfe_u32 v19, v16, 0, 1
    v_lshl_add_u32 v7, v19, 4, v7
    v_add_u32 v19, 20736, v7
    s_lshl_b32 s71, s60, 9
    s_add_u32 s71, s71, 13312
    v_add_u32 v7, s71, v7
    v_cndmask_b32 v7, v19, v7, vcc
    v_bfe_u32 v18, v16, 0, 1
    v_lshlrev_b32 v18, 1, v18
    v_bfe_u32 v19, v16, 2, 1
    v_lshl_add_u32 v18, v19, 0, v18
    v_bfe_u32 v19, v16, 3, 1
    v_lshl_add_u32 v18, v19, 2, v18
    v_mov_b32 v19, 0x3f80
    v_mov_b32 v17, 0x3f800000
    v_cndmask_b32 v17, v17, v19, vcc
    v_cmp_eq_u32 vcc, 0, v18
    s_nop 1
    v_cndmask_b32 v20, 0, v17, vcc
    v_cmp_eq_u32 vcc, 1, v18
    s_nop 1
    v_cndmask_b32 v21, 0, v17, vcc
    v_cmp_eq_u32 vcc, 2, v18
    s_nop 1
    v_cndmask_b32 v22, 0, v17, vcc
    v_cmp_eq_u32 vcc, 3, v18
    s_nop 1
    v_cndmask_b32 v23, 0, v17, vcc
    v_bfe_u32 v27, v16, 4, 2
    v_lshlrev_b32 v27, 8, v27
    v_bfe_u32 v19, v16, 0, 2
    v_lshl_add_u32 v27, v19, 6, v27
    v_bfe_u32 v19, v16, 2, 2
    v_lshl_add_u32 v27, v19, 4, v27
    v_bfe_u32 v24, v16, 1, 2
    v_lshlrev_b32 v24, 4, v24
    v_bfe_u32 v19, v16, 4, 2
    v_lshl_add_u32 v24, v19, 2, v24
    v_bfe_u32 v19, v16, 0, 1
    v_lshl_add_u32 v24, v19, 28, v24
    v_bfe_u32 v19, v16, 3, 1
    v_lshl_add_u32 v24, v19, 28, v24
    v_bfe_u32 v25, v16, 5, 1
    v_lshlrev_b32 v25, 5, v25
    v_bfe_u32 v19, v16, 1, 1
    v_lshl_add_u32 v25, v19, 4, v25
    v_bfe_u32 v19, v16, 4, 1
    v_lshl_add_u32 v25, v19, 3, v25
    v_bfe_u32 v19, v16, 2, 1
    v_lshl_add_u32 v25, v19, 2, v25
    v_bfe_u32 v19, v16, 0, 1
    v_lshl_add_u32 v25, v19, 28, v25
    v_bfe_u32 v19, v16, 3, 1
    v_lshl_add_u32 v25, v19, 28, v25
    v_bfe_u32 v28, v16, 3, 1
    v_lshlrev_b32 v28, 12, v28
    v_bfe_u32 v19, v16, 4, 1
    v_lshl_add_u32 v28, v19, 11, v28
    v_bfe_u32 v19, v16, 2, 1
    v_lshl_add_u32 v28, v19, 4, v28
    v_bfe_u32 v19, v16, 5, 1
    v_lshl_add_u32 v28, v19, 5, v28
    v_bfe_u32 v19, v16, 0, 2
    v_lshl_add_u32 v28, v19, 2, v28
    ds_write_b32 v0, v28 offset:22528
    v_bfe_u32 v26, v16, 5, 1
    v_lshlrev_b32 v26, 9, v26
    v_bfe_u32 v19, v16, 3, 1
    v_lshl_add_u32 v26, v19, 8, v26
    v_bfe_u32 v19, v16, 4, 1
    v_lshl_add_u32 v26, v19, 7, v26
    v_bfe_u32 v19, v16, 0, 3
    v_lshl_add_u32 v26, v19, 4, v26
    ds_write_b128 v0, v[20:23] offset:18432
    ds_write_b128 v0, v[24:27] offset:19456
    s_waitcnt lgkmcnt(0)
    s_lshl_b32 s71, s82, 6
    s_add_u32 s71, s71, s79
    v_bfe_u32 v14, v0, 6, 1
    v_lshlrev_b32 v14, 7, v14
    v_bfe_u32 v18, v0, 8, 1
    v_lshl_add_u32 v14, v18, 8, v14
    v_bfe_u32 v18, v0, 9, 1
    v_lshl_add_u32 v14, v18, 10, v14
    v_bfe_u32 v18, v0, 7, 1
    v_lshl_add_u32 v14, v18, 5, v14
    v_bfe_u32 v18, v0, 4, 2
    v_lshl_add_u32 v14, v18, 3, v14
    v_add_u32 v14, s71, v14
    s_mul_i32 s72, s82, 34816
    v_subrev_u32 v82, s72, v14
    s_sub_u32 s72, 34816, s72
    v_add_u32 v15, s72, v82
    v_bfe_u32 v12, v0, 6, 1
    v_lshlrev_b32 v12, 7, v12
    v_bfe_u32 v18, v0, 8, 1
    v_lshl_add_u32 v12, v18, 8, v12
    v_bfe_u32 v18, v0, 9, 1
    v_lshl_add_u32 v12, v18, 11, v12
    v_bfe_u32 v18, v0, 7, 1
    v_lshl_add_u32 v12, v18, 5, v12
    v_bfe_u32 v18, v0, 4, 2
    v_lshl_add_u32 v12, v18, 3, v12
    v_bfe_u32 v18, v0, 7, 1
    v_lshl_add_u32 v12, v18, 10, v12
    v_xor_b32 v13, 1024, v12
    v_add_u32 v12, s71, v12
    v_add_u32 v13, s71, v13
    v_bfe_u32 v83, v0, 7, 1
    v_bfe_u32 v18, v0, 8, 1
    v_lshl_add_u32 v83, v18, 2, v83
    v_bfe_u32 v18, v0, 9, 1
    v_lshl_add_u32 v83, v18, 1, v83
    v_mul_u32_u24 v83, 1280, v83
    v_and_b32 v18, 0x70, v0
    v_add_u32 v83, v83, v18
    s_mul_i32 s87, s59, 163840
    s_mul_i32 s71, s58, 640
    s_add_u32 s87, s87, s71
    s_and_b32 s71, s60, 2
    s_mul_i32 s71, s71, 5120
    s_add_u32 s87, s87, s71
    s_mul_i32 s71, s82, 20480
    s_add_u32 s87, s87, s71
    s_waitcnt vmcnt(20)
    s_barrier
    ds_read_b64_tr_b16 v[88:89], v12 offset:0
    ds_read_b64_tr_b16 v[90:91], v12 offset:512
    ds_read_b64_tr_b16 v[96:97], v13 offset:0
    ds_read_b64_tr_b16 v[98:99], v13 offset:512
    ds_read_b64_tr_b16 v[104:105], v15 offset:0
    ds_read_b64_tr_b16 v[106:107], v15 offset:512
    ds_read_b64_tr_b16 v[108:109], v15 offset:2048
    ds_read_b64_tr_b16 v[110:111], v15 offset:2560
    s_waitcnt lgkmcnt(0)
    s_mov_b64 exec, 0xffff
    s_mov_b32 s56, 0x05040100
    s_mov_b32 s57, 0x07060302
    v_perm_b32 v24, v37, v36, s56
    v_min_u32 v24, -2, v24
    v_perm_b32 v25, v37, v36, s57
    v_min_u32 v25, -2, v25
    v_perm_b32 v26, v39, v38, s56
    v_min_u32 v26, -2, v26
    v_perm_b32 v27, v39, v38, s57
    v_min_u32 v27, -2, v27
    buffer_store_dwordx4 v[24:27], v0, s[32:35], s77 offen
    s_cmp_eq_u32 s77, 0x10000000
    s_cselect_b32 s72, s77, s78
    buffer_store_dwordx4 v[24:27], v0, s[32:35], s72 offen sc1
    s_add_u32 s72, s72, 8192
    buffer_store_dwordx4 v[24:27], v0, s[32:35], s72 offen sc1
    s_add_u32 s72, s72, 8192
    s_mov_b64 exec, -1
    s_waitcnt vmcnt(19)
    s_barrier
    ds_read_b64_tr_b16 v[92:93], v12 offset:4096
    ds_read_b64_tr_b16 v[94:95], v12 offset:4608
    ds_read_b64_tr_b16 v[100:101], v13 offset:4096
    ds_read_b64_tr_b16 v[102:103], v13 offset:4608
    ds_read_b64_tr_b16 v[76:77], v15 offset:4096
    ds_read_b64_tr_b16 v[78:79], v15 offset:4608
    ds_read_b64_tr_b16 v[72:73], v15 offset:6144
    ds_read_b64_tr_b16 v[74:75], v15 offset:6656
    s_xor_b32 s72, s60, 0
    s_mul_i32 s72, s72, 655360
    s_add_u32 s72, s80, s72
    s_add_u32 m0, s79, 0
    s_add_u32 s71, s72, 131072
    buffer_load_dwordx4 v80, s[48:51], s71 offen lds
    s_add_u32 m0, s79, 1024
    s_add_u32 s71, s72, 163840
    buffer_load_dwordx4 v80, s[48:51], s71 offen lds
    s_add_u32 m0, s79, 2048
    s_add_u32 s71, s72, 196608
    buffer_load_dwordx4 v80, s[48:51], s71 offen lds
    s_add_u32 m0, s79, 3072
    s_add_u32 s71, s72, 229376
    buffer_load_dwordx4 v80, s[48:51], s71 offen lds
    s_waitcnt lgkmcnt(0)
    ds_write_b128 v1, v[76:79] offset:24576
    ds_write_b128 v1, v[72:75] offset:25600
    v_mov_b64 v[84:85], -1
    v_mov_b64 v[86:87], -1
    s_lshl_b32 s86, s59, 1
    s_lshr_b32 s73, s60, 1
    s_add_u32 s86, s86, s73
    s_mul_i32 s86, s86, 32768
    s_add_u32 s86, s86, s74
    s_add_u32 s86, s86, 92308480
    s_and_b32 s73, s60, 1
    s_lshl_b32 s73, s73, 13
    s_add_u32 s86, s86, s73
    s_cmp_eq_u32 s75, 0
    s_cselect_b32 s73, 0x10000000, s67
    buffer_store_dwordx4 v[84:87], v0, s[32:35], s73 offen offset:0
    s_cmp_eq_u32 s75, 0
    s_cselect_b32 s73, 0x10000000, s67
    buffer_store_dwordx4 v[84:87], v0, s[32:35], s73 offen offset:1024
    s_waitcnt vmcnt(21)
    s_barrier
    ds_read_b64_tr_b16 v[112:113], v14 offset:8192
    ds_read_b64_tr_b16 v[114:115], v14 offset:8704
    ds_read_b64_tr_b16 v[116:117], v14 offset:10240
    ds_read_b64_tr_b16 v[118:119], v14 offset:10752
    ds_read_b64_tr_b16 v[76:77], v15 offset:8192
    ds_read_b64_tr_b16 v[78:79], v15 offset:8704
    ds_read_b64_tr_b16 v[72:73], v15 offset:10240
    ds_read_b64_tr_b16 v[74:75], v15 offset:10752
    s_xor_b32 s72, s60, 2
    s_mul_i32 s72, s72, 655360
    s_add_u32 s72, s80, s72
    s_add_u32 m0, s79, 4096
    s_add_u32 s71, s72, 0
    buffer_load_dwordx4 v80, s[48:51], s71 offen lds
    s_add_u32 m0, s79, 5120
    s_add_u32 s71, s72, 32768
    buffer_load_dwordx4 v80, s[48:51], s71 offen lds
    s_add_u32 m0, s79, 6144
    s_add_u32 s71, s72, 65536
    buffer_load_dwordx4 v80, s[48:51], s71 offen lds
    s_add_u32 m0, s79, 7168
    s_add_u32 s71, s72, 98304
    buffer_load_dwordx4 v80, s[48:51], s71 offen lds
    s_waitcnt lgkmcnt(0)
    ds_write_b128 v1, v[76:79] offset:26624
    ds_write_b128 v1, v[72:75] offset:27648
    s_mov_b64 exec, 0xffff
    s_add_u32 s73, s77, 16384
    buffer_store_dwordx4 v[84:87], v0, s[32:35], s73 offen
    s_mov_b64 exec, -1
    s_mov_b64 exec, 0xffff
    s_add_u32 s73, s77, 32768
    buffer_store_dwordx4 v[84:87], v0, s[32:35], s73 offen
    s_mov_b64 exec, -1
    s_mov_b64 exec, 0xffff
    s_add_u32 s73, s77, 49152
    buffer_store_dwordx4 v[84:87], v0, s[32:35], s73 offen
    s_mov_b64 exec, -1
    s_waitcnt vmcnt(24)
    s_barrier
    ds_read_b64_tr_b16 v[120:121], v14 offset:12288
    ds_read_b64_tr_b16 v[122:123], v14 offset:12800
    ds_read_b64_tr_b16 v[124:125], v14 offset:14336
    ds_read_b64_tr_b16 v[126:127], v14 offset:14848
    ds_read_b64_tr_b16 v[128:129], v15 offset:12288
    ds_read_b64_tr_b16 v[130:131], v15 offset:12800
    ds_read_b64_tr_b16 v[132:133], v15 offset:14336
    ds_read_b64_tr_b16 v[134:135], v15 offset:14848
    s_xor_b32 s72, s60, 2
    s_mul_i32 s72, s72, 655360
    s_add_u32 s72, s80, s72
    s_add_u32 m0, s79, 8192
    s_add_u32 s71, s72, 131072
    buffer_load_dwordx4 v80, s[48:51], s71 offen lds
    s_add_u32 m0, s79, 9216
    s_add_u32 s71, s72, 163840
    buffer_load_dwordx4 v80, s[48:51], s71 offen lds
    s_add_u32 m0, s79, 10240
    s_add_u32 s71, s72, 196608
    buffer_load_dwordx4 v80, s[48:51], s71 offen lds
    s_add_u32 m0, s79, 11264
    s_add_u32 s71, s72, 229376
    buffer_load_dwordx4 v80, s[48:51], s71 offen lds
    s_waitcnt lgkmcnt(0)
    s_waitcnt vmcnt(24)
    s_barrier
    ds_read_b64_tr_b16 v[136:137], v82 offset:16384
    ds_read_b64_tr_b16 v[138:139], v82 offset:16896
    ds_read_b64_tr_b16 v[140:141], v82 offset:18432
    ds_read_b64_tr_b16 v[142:143], v82 offset:18944
    ds_read_b64_tr_b16 v[144:145], v82 offset:51200
    ds_read_b64_tr_b16 v[146:147], v82 offset:51712
    ds_read_b64_tr_b16 v[148:149], v82 offset:53248
    ds_read_b64_tr_b16 v[150:151], v82 offset:53760
    s_mul_i32 s72, s82, 1310720
    s_add_u32 s72, s80, s72
    s_add_u32 m0, s79, 12288
    s_add_u32 s71, s72, 524288
    buffer_load_dwordx4 v81, s[48:51], s71 offen lds
    s_add_u32 m0, s79, 13312
    s_add_u32 s71, s72, 589824
    buffer_load_dwordx4 v81, s[48:51], s71 offen lds
    s_add_u32 m0, s79, 14336
    s_add_u32 s71, s72, 1179648
    buffer_load_dwordx4 v81, s[48:51], s71 offen lds
    s_add_u32 m0, s79, 15360
    s_add_u32 s71, s72, 1245184
    buffer_load_dwordx4 v81, s[48:51], s71 offen lds
    s_waitcnt lgkmcnt(0)
    s_sub_u32 s73, s86, 1024
    buffer_store_dwordx4 v[84:87], v0, s[32:35], s73 offen sc1
    s_waitcnt vmcnt(25)
    s_barrier
    ds_read_b64_tr_b16 v[76:77], v12 offset:20480
    ds_read_b64_tr_b16 v[78:79], v12 offset:20992
    ds_read_b64_tr_b16 v[152:153], v13 offset:20480
    ds_read_b64_tr_b16 v[154:155], v13 offset:20992
    ds_read_b64_tr_b16 v[160:161], v15 offset:20480
    ds_read_b64_tr_b16 v[162:163], v15 offset:20992
    ds_read_b64_tr_b16 v[164:165], v15 offset:22528
    ds_read_b64_tr_b16 v[166:167], v15 offset:23040
    s_xor_b32 s72, s60, 0
    s_mul_i32 s72, s72, 655360
    s_add_u32 s72, s80, s72
    s_add_u32 m0, s79, 16384
    s_add_u32 s71, s72, 0
    buffer_load_dwordx4 v80, s[40:43], s71 offen lds
    s_add_u32 m0, s79, 17408
    s_add_u32 s71, s72, 32768
    buffer_load_dwordx4 v80, s[40:43], s71 offen lds
    s_add_u32 m0, s79, 18432
    s_add_u32 s71, s72, 65536
    buffer_load_dwordx4 v80, s[40:43], s71 offen lds
    s_add_u32 m0, s79, 19456
    s_add_u32 s71, s72, 98304
    buffer_load_dwordx4 v80, s[40:43], s71 offen lds
    s_waitcnt lgkmcnt(0)
    ds_write_b128 v1, v[76:79] offset:28672
    s_waitcnt vmcnt(22)
    s_barrier
    ds_read_b64_tr_b16 v[76:77], v12 offset:0
    ds_read_b64_tr_b16 v[78:79], v12 offset:512
    ds_read_b64_tr_b16 v[156:157], v13 offset:0
    ds_read_b64_tr_b16 v[158:159], v13 offset:512
    ds_read_b64_tr_b16 v[168:169], v15 offset:0
    ds_read_b64_tr_b16 v[170:171], v15 offset:512
    ds_read_b64_tr_b16 v[172:173], v15 offset:2048
    ds_read_b64_tr_b16 v[174:175], v15 offset:2560
    s_xor_b32 s72, s60, 0
    s_mul_i32 s72, s72, 655360
    s_add_u32 s72, s80, s72
    s_add_u32 m0, s79, 20480
    s_add_u32 s71, s72, 131072
    buffer_load_dwordx4 v80, s[40:43], s71 offen lds
    s_add_u32 m0, s79, 21504
    s_add_u32 s71, s72, 163840
    buffer_load_dwordx4 v80, s[40:43], s71 offen lds
    s_add_u32 m0, s79, 22528
    s_add_u32 s71, s72, 196608
    buffer_load_dwordx4 v80, s[40:43], s71 offen lds
    s_add_u32 m0, s79, 23552
    s_add_u32 s71, s72, 229376
    buffer_load_dwordx4 v80, s[40:43], s71 offen lds
    s_waitcnt lgkmcnt(0)
    ds_write_b128 v1, v[76:79] offset:29696
    buffer_store_dwordx4 v[84:87], v0, s[32:35], s86 offen offset:0 sc1
    s_waitcnt vmcnt(21)
    s_barrier
    ds_read_b64_tr_b16 v[76:77], v14 offset:4096
    ds_read_b64_tr_b16 v[78:79], v14 offset:4608
    ds_read_b64_tr_b16 v[72:73], v14 offset:6144
    ds_read_b64_tr_b16 v[74:75], v14 offset:6656
    ds_read_b64_tr_b16 v[68:69], v15 offset:4096
    ds_read_b64_tr_b16 v[70:71], v15 offset:4608
    ds_read_b64_tr_b16 v[64:65], v15 offset:6144
    ds_read_b64_tr_b16 v[66:67], v15 offset:6656
    s_xor_b32 s72, s60, 2
    s_mul_i32 s72, s72, 655360
    s_add_u32 s72, s80, s72
    s_add_u32 m0, s79, 0
    s_add_u32 s71, s72, 0
    buffer_load_dwordx4 v80, s[40:43], s71 offen lds
    s_add_u32 m0, s79, 1024
    s_add_u32 s71, s72, 32768
    buffer_load_dwordx4 v80, s[40:43], s71 offen lds
    s_add_u32 m0, s79, 2048
    s_add_u32 s71, s72, 65536
    buffer_load_dwordx4 v80, s[40:43], s71 offen lds
    s_add_u32 m0, s79, 3072
    s_add_u32 s71, s72, 98304
    buffer_load_dwordx4 v80, s[40:43], s71 offen lds
    s_waitcnt lgkmcnt(0)
    ds_write_b128 v1, v[76:79] offset:30720
    ds_write_b128 v1, v[72:75] offset:31744
    ds_write_b128 v1, v[68:71] offset:32768
    ds_write_b128 v1, v[64:67] offset:33792
    s_waitcnt vmcnt(18)
    s_barrier
    ds_read_b64_tr_b16 v[176:177], v14 offset:8192
    ds_read_b64_tr_b16 v[178:179], v14 offset:8704
    ds_read_b64_tr_b16 v[180:181], v14 offset:10240
    ds_read_b64_tr_b16 v[182:183], v14 offset:10752
    ds_read_b64_tr_b16 v[184:185], v15 offset:8192
    ds_read_b64_tr_b16 v[186:187], v15 offset:8704
    ds_read_b64_tr_b16 v[188:189], v15 offset:10240
    ds_read_b64_tr_b16 v[190:191], v15 offset:10752
    s_xor_b32 s72, s60, 2
    s_mul_i32 s72, s72, 655360
    s_add_u32 s72, s80, s72
    s_add_u32 m0, s79, 4096
    s_add_u32 s71, s72, 131072
    buffer_load_dwordx4 v80, s[40:43], s71 offen lds
    s_add_u32 m0, s79, 5120
    s_add_u32 s71, s72, 163840
    buffer_load_dwordx4 v80, s[40:43], s71 offen lds
    s_add_u32 m0, s79, 6144
    s_add_u32 s71, s72, 196608
    buffer_load_dwordx4 v80, s[40:43], s71 offen lds
    s_add_u32 m0, s79, 7168
    s_add_u32 s71, s72, 229376
    buffer_load_dwordx4 v80, s[40:43], s71 offen lds
    s_waitcnt lgkmcnt(0)
    buffer_store_dwordx4 v[84:87], v0, s[32:35], s86 offen offset:1024 sc1
    s_waitcnt vmcnt(19)
    s_barrier
    ds_read_b64_tr_b16 v[192:193], v82 offset:12288
    ds_read_b64_tr_b16 v[194:195], v82 offset:12800
    ds_read_b64_tr_b16 v[196:197], v82 offset:14336
    ds_read_b64_tr_b16 v[198:199], v82 offset:14848
    ds_read_b64_tr_b16 v[76:77], v82 offset:47104
    ds_read_b64_tr_b16 v[78:79], v82 offset:47616
    ds_read_b64_tr_b16 v[72:73], v82 offset:49152
    ds_read_b64_tr_b16 v[74:75], v82 offset:49664
    s_mul_i32 s72, s82, 1310720
    s_add_u32 s72, s80, s72
    s_add_u32 m0, s79, 8192
    s_add_u32 s71, s72, 524288
    buffer_load_dwordx4 v81, s[40:43], s71 offen lds
    s_add_u32 m0, s79, 9216
    s_add_u32 s71, s72, 589824
    buffer_load_dwordx4 v81, s[40:43], s71 offen lds
    s_add_u32 m0, s79, 10240
    s_add_u32 s71, s72, 1179648
    buffer_load_dwordx4 v81, s[40:43], s71 offen lds
    s_add_u32 m0, s79, 11264
    s_add_u32 s71, s72, 1245184
    buffer_load_dwordx4 v81, s[40:43], s71 offen lds
    s_waitcnt lgkmcnt(0)
    s_waitcnt vmcnt(18)
    s_barrier
    ds_read_b64_tr_b16 v[200:201], v12 offset:16384
    ds_read_b64_tr_b16 v[202:203], v12 offset:16896
    ds_read_b64_tr_b16 v[208:209], v13 offset:16384
    ds_read_b64_tr_b16 v[210:211], v13 offset:16896
    ds_read_b64_tr_b16 v[68:69], v15 offset:16384
    ds_read_b64_tr_b16 v[70:71], v15 offset:16896
    ds_read_b64_tr_b16 v[64:65], v15 offset:18432
    ds_read_b64_tr_b16 v[66:67], v15 offset:18944
    s_xor_b32 s72, s60, 0
    s_mul_i32 s72, s72, 655360
    s_add_u32 s72, s81, s72
    s_add_u32 m0, s79, 12288
    s_add_u32 s71, s72, 0
    buffer_load_dwordx4 v80, s[36:39], s71 offen lds
    s_add_u32 m0, s79, 13312
    s_add_u32 s71, s72, 32768
    buffer_load_dwordx4 v80, s[36:39], s71 offen lds
    s_add_u32 m0, s79, 14336
    s_add_u32 s71, s72, 65536
    buffer_load_dwordx4 v80, s[36:39], s71 offen lds
    s_add_u32 m0, s79, 15360
    s_add_u32 s71, s72, 98304
    buffer_load_dwordx4 v80, s[36:39], s71 offen lds
    s_waitcnt lgkmcnt(0)
    buffer_store_dwordx4 v[84:87], v0, s[32:35], s86 offen offset:2048 sc1
    s_waitcnt vmcnt(19)
    s_barrier
    ds_read_b64_tr_b16 v[204:205], v12 offset:20480
    ds_read_b64_tr_b16 v[206:207], v12 offset:20992
    ds_read_b64_tr_b16 v[212:213], v13 offset:20480
    ds_read_b64_tr_b16 v[214:215], v13 offset:20992
    ds_read_b64_tr_b16 v[216:217], v15 offset:20480
    ds_read_b64_tr_b16 v[218:219], v15 offset:20992
    ds_read_b64_tr_b16 v[220:221], v15 offset:22528
    ds_read_b64_tr_b16 v[222:223], v15 offset:23040
    s_xor_b32 s72, s60, 0
    s_mul_i32 s72, s72, 655360
    s_add_u32 s72, s81, s72
    s_add_u32 m0, s79, 16384
    s_add_u32 s71, s72, 131072
    buffer_load_dwordx4 v80, s[36:39], s71 offen lds
    s_add_u32 m0, s79, 17408
    s_add_u32 s71, s72, 163840
    buffer_load_dwordx4 v80, s[36:39], s71 offen lds
    s_add_u32 m0, s79, 18432
    s_add_u32 s71, s72, 196608
    buffer_load_dwordx4 v80, s[36:39], s71 offen lds
    s_add_u32 m0, s79, 19456
    s_add_u32 s71, s72, 229376
    buffer_load_dwordx4 v80, s[36:39], s71 offen lds
    s_waitcnt lgkmcnt(0)
    s_waitcnt vmcnt(18)
    s_barrier
    ds_read_b64_tr_b16 v[224:225], v14 offset:0
    ds_read_b64_tr_b16 v[226:227], v14 offset:512
    ds_read_b64_tr_b16 v[228:229], v14 offset:2048
    ds_read_b64_tr_b16 v[230:231], v14 offset:2560
    ds_read_b64_tr_b16 v[232:233], v15 offset:0
    ds_read_b64_tr_b16 v[234:235], v15 offset:512
    ds_read_b64_tr_b16 v[236:237], v15 offset:2048
    ds_read_b64_tr_b16 v[238:239], v15 offset:2560
    s_xor_b32 s72, s60, 2
    s_mul_i32 s72, s72, 655360
    s_add_u32 s72, s81, s72
    s_add_u32 m0, s79, 20480
    s_add_u32 s71, s72, 0
    buffer_load_dwordx4 v80, s[36:39], s71 offen lds
    s_add_u32 m0, s79, 21504
    s_add_u32 s71, s72, 32768
    buffer_load_dwordx4 v80, s[36:39], s71 offen lds
    s_add_u32 m0, s79, 22528
    s_add_u32 s71, s72, 65536
    buffer_load_dwordx4 v80, s[36:39], s71 offen lds
    s_add_u32 m0, s79, 23552
    s_add_u32 s71, s72, 98304
    buffer_load_dwordx4 v80, s[36:39], s71 offen lds
    s_waitcnt lgkmcnt(0)
    buffer_store_dwordx4 v[84:87], v0, s[32:35], s86 offen offset:3072 sc1
    s_waitcnt vmcnt(19)
    s_barrier
    ds_read_b64_tr_b16 v[240:241], v14 offset:4096
    ds_read_b64_tr_b16 v[242:243], v14 offset:4608
    ds_read_b64_tr_b16 v[244:245], v14 offset:6144
    ds_read_b64_tr_b16 v[246:247], v14 offset:6656
    ds_read_b64_tr_b16 v[248:249], v15 offset:4096
    ds_read_b64_tr_b16 v[250:251], v15 offset:4608
    ds_read_b64_tr_b16 v[252:253], v15 offset:6144
    ds_read_b64_tr_b16 v[254:255], v15 offset:6656
    s_xor_b32 s72, s60, 2
    s_mul_i32 s72, s72, 655360
    s_add_u32 s72, s81, s72
    s_add_u32 m0, s79, 0
    s_add_u32 s71, s72, 131072
    buffer_load_dwordx4 v80, s[36:39], s71 offen lds
    s_add_u32 m0, s79, 1024
    s_add_u32 s71, s72, 163840
    buffer_load_dwordx4 v80, s[36:39], s71 offen lds
    s_add_u32 m0, s79, 2048
    s_add_u32 s71, s72, 196608
    buffer_load_dwordx4 v80, s[36:39], s71 offen lds
    s_add_u32 m0, s79, 3072
    s_add_u32 s71, s72, 229376
    buffer_load_dwordx4 v80, s[36:39], s71 offen lds
    s_waitcnt lgkmcnt(0)
    s_waitcnt vmcnt(18)
    s_barrier
    ds_read_b64_tr_b16 v[60:61], v82 offset:8192
    ds_read_b64_tr_b16 v[62:63], v82 offset:8704
    ds_read_b64_tr_b16 v[56:57], v82 offset:10240
    ds_read_b64_tr_b16 v[58:59], v82 offset:10752
    ds_read_b64_tr_b16 a[0:1], v82 offset:43008
    ds_read_b64_tr_b16 a[2:3], v82 offset:43520
    ds_read_b64_tr_b16 a[4:5], v82 offset:45056
    ds_read_b64_tr_b16 a[6:7], v82 offset:45568
    s_mul_i32 s72, s82, 1310720
    s_add_u32 s72, s81, s72
    s_add_u32 m0, s79, 4096
    s_add_u32 s71, s72, 524288
    buffer_load_dwordx4 v81, s[36:39], s71 offen lds
    s_add_u32 m0, s79, 5120
    s_add_u32 s71, s72, 589824
    buffer_load_dwordx4 v81, s[36:39], s71 offen lds
    s_add_u32 m0, s79, 6144
    s_add_u32 s71, s72, 1179648
    buffer_load_dwordx4 v81, s[36:39], s71 offen lds
    s_add_u32 m0, s79, 7168
    s_add_u32 s71, s72, 1245184
    buffer_load_dwordx4 v81, s[36:39], s71 offen lds
    s_waitcnt lgkmcnt(0)
    s_waitcnt vmcnt(18)
    s_barrier
    ds_read_b64_tr_b16 a[8:9], v12 offset:12288
    ds_read_b64_tr_b16 a[10:11], v12 offset:12800
    ds_read_b64_tr_b16 v[52:53], v13 offset:12288
    ds_read_b64_tr_b16 v[54:55], v13 offset:12800
    ds_read_b64_tr_b16 a[16:17], v15 offset:12288
    ds_read_b64_tr_b16 a[18:19], v15 offset:12800
    ds_read_b64_tr_b16 a[20:21], v15 offset:14336
    ds_read_b64_tr_b16 a[22:23], v15 offset:14848
    s_xor_b32 s72, s60, 0
    s_mul_i32 s72, s72, 655360
    s_add_u32 s72, s81, s72
    s_add_u32 m0, s79, 8192
    s_add_u32 s71, s72, 0
    buffer_load_dwordx4 v80, s[48:51], s71 offen lds
    s_add_u32 m0, s79, 9216
    s_add_u32 s71, s72, 32768
    buffer_load_dwordx4 v80, s[48:51], s71 offen lds
    s_add_u32 m0, s79, 10240
    s_add_u32 s71, s72, 65536
    buffer_load_dwordx4 v80, s[48:51], s71 offen lds
    s_add_u32 m0, s79, 11264
    s_add_u32 s71, s72, 98304
    buffer_load_dwordx4 v80, s[48:51], s71 offen lds
    s_waitcnt lgkmcnt(0)
    s_waitcnt vmcnt(17)
    s_barrier
    ds_read_b64_tr_b16 a[12:13], v12 offset:16384
    ds_read_b64_tr_b16 a[14:15], v12 offset:16896
    ds_read_b64_tr_b16 v[48:49], v13 offset:16384
    ds_read_b64_tr_b16 v[50:51], v13 offset:16896
    ds_read_b64_tr_b16 a[24:25], v15 offset:16384
    ds_read_b64_tr_b16 a[26:27], v15 offset:16896
    ds_read_b64_tr_b16 a[28:29], v15 offset:18432
    ds_read_b64_tr_b16 a[30:31], v15 offset:18944
    s_xor_b32 s72, s60, 0
    s_mul_i32 s72, s72, 655360
    s_add_u32 s72, s81, s72
    s_add_u32 m0, s79, 12288
    s_add_u32 s71, s72, 131072
    buffer_load_dwordx4 v80, s[48:51], s71 offen lds
    s_add_u32 m0, s79, 13312
    s_add_u32 s71, s72, 163840
    buffer_load_dwordx4 v80, s[48:51], s71 offen lds
    s_add_u32 m0, s79, 14336
    s_add_u32 s71, s72, 196608
    buffer_load_dwordx4 v80, s[48:51], s71 offen lds
    s_add_u32 m0, s79, 15360
    s_add_u32 s71, s72, 229376
    buffer_load_dwordx4 v80, s[48:51], s71 offen lds
    s_waitcnt lgkmcnt(0)
    s_waitcnt vmcnt(17)
    s_barrier
    ds_read_b64_tr_b16 a[32:33], v14 offset:20480
    ds_read_b64_tr_b16 a[34:35], v14 offset:20992
    ds_read_b64_tr_b16 a[36:37], v14 offset:22528
    ds_read_b64_tr_b16 a[38:39], v14 offset:23040
    ds_read_b64_tr_b16 a[40:41], v15 offset:20480
    ds_read_b64_tr_b16 a[42:43], v15 offset:20992
    ds_read_b64_tr_b16 a[44:45], v15 offset:22528
    ds_read_b64_tr_b16 a[46:47], v15 offset:23040
    s_xor_b32 s72, s60, 2
    s_mul_i32 s72, s72, 655360
    s_add_u32 s72, s81, s72
    s_add_u32 m0, s79, 16384
    s_add_u32 s71, s72, 0
    buffer_load_dwordx4 v80, s[48:51], s71 offen lds
    s_add_u32 m0, s79, 17408
    s_add_u32 s71, s72, 32768
    buffer_load_dwordx4 v80, s[48:51], s71 offen lds
    s_add_u32 m0, s79, 18432
    s_add_u32 s71, s72, 65536
    buffer_load_dwordx4 v80, s[48:51], s71 offen lds
    s_add_u32 m0, s79, 19456
    s_add_u32 s71, s72, 98304
    buffer_load_dwordx4 v80, s[48:51], s71 offen lds
    s_waitcnt lgkmcnt(0)
    s_waitcnt vmcnt(16)
    s_barrier
    ds_read_b64_tr_b16 a[48:49], v14 offset:0
    ds_read_b64_tr_b16 a[50:51], v14 offset:512
    ds_read_b64_tr_b16 a[52:53], v14 offset:2048
    ds_read_b64_tr_b16 a[54:55], v14 offset:2560
    ds_read_b64_tr_b16 v[44:45], v15 offset:0
    ds_read_b64_tr_b16 v[46:47], v15 offset:512
    ds_read_b64_tr_b16 v[40:41], v15 offset:2048
    ds_read_b64_tr_b16 v[42:43], v15 offset:2560
    s_xor_b32 s72, s60, 2
    s_mul_i32 s72, s72, 655360
    s_add_u32 s72, s81, s72
    s_add_u32 m0, s79, 20480
    s_add_u32 s71, s72, 131072
    buffer_load_dwordx4 v80, s[48:51], s71 offen lds
    s_add_u32 m0, s79, 21504
    s_add_u32 s71, s72, 163840
    buffer_load_dwordx4 v80, s[48:51], s71 offen lds
    s_add_u32 m0, s79, 22528
    s_add_u32 s71, s72, 196608
    buffer_load_dwordx4 v80, s[48:51], s71 offen lds
    s_add_u32 m0, s79, 23552
    s_add_u32 s71, s72, 229376
    buffer_load_dwordx4 v80, s[48:51], s71 offen lds
    s_waitcnt lgkmcnt(0)
    s_waitcnt vmcnt(16)
    s_barrier
    ds_read_b64_tr_b16 a[56:57], v82 offset:4096
    ds_read_b64_tr_b16 a[58:59], v82 offset:4608
    ds_read_b64_tr_b16 a[60:61], v82 offset:6144
    ds_read_b64_tr_b16 a[62:63], v82 offset:6656
    ds_read_b64_tr_b16 a[64:65], v82 offset:38912
    ds_read_b64_tr_b16 a[66:67], v82 offset:39424
    ds_read_b64_tr_b16 a[68:69], v82 offset:40960
    ds_read_b64_tr_b16 a[70:71], v82 offset:41472
    s_mul_i32 s72, s82, 1310720
    s_add_u32 s72, s81, s72
    s_add_u32 m0, s79, 0
    s_add_u32 s71, s72, 524288
    buffer_load_dwordx4 v81, s[48:51], s71 offen lds
    s_add_u32 m0, s79, 1024
    s_add_u32 s71, s72, 589824
    buffer_load_dwordx4 v81, s[48:51], s71 offen lds
    s_add_u32 m0, s79, 2048
    s_add_u32 s71, s72, 1179648
    buffer_load_dwordx4 v81, s[48:51], s71 offen lds
    s_add_u32 m0, s79, 3072
    s_add_u32 s71, s72, 1245184
    buffer_load_dwordx4 v81, s[48:51], s71 offen lds
    s_waitcnt lgkmcnt(0)
    s_waitcnt vmcnt(16)
    s_barrier
    ds_read_b64_tr_b16 a[72:73], v12 offset:8192
    ds_read_b64_tr_b16 a[74:75], v12 offset:8704
    ds_read_b64_tr_b16 a[80:81], v13 offset:8192
    ds_read_b64_tr_b16 a[82:83], v13 offset:8704
    ds_read_b64_tr_b16 a[88:89], v15 offset:8192
    ds_read_b64_tr_b16 a[90:91], v15 offset:8704
    ds_read_b64_tr_b16 a[92:93], v15 offset:10240
    ds_read_b64_tr_b16 a[94:95], v15 offset:10752
    s_xor_b32 s72, s60, 0
    s_mul_i32 s72, s72, 655360
    s_add_u32 s72, s81, s72
    s_add_u32 m0, s79, 4096
    s_add_u32 s71, s72, 0
    buffer_load_dwordx4 v80, s[40:43], s71 offen lds
    s_add_u32 m0, s79, 5120
    s_add_u32 s71, s72, 32768
    buffer_load_dwordx4 v80, s[40:43], s71 offen lds
    s_add_u32 m0, s79, 6144
    s_add_u32 s71, s72, 65536
    buffer_load_dwordx4 v80, s[40:43], s71 offen lds
    s_add_u32 m0, s79, 7168
    s_add_u32 s71, s72, 98304
    buffer_load_dwordx4 v80, s[40:43], s71 offen lds
    s_waitcnt lgkmcnt(0)
    s_mul_i32 s71, s60, 5
    v_bfe_u32 v84, v0, 7, 1
    v_add_u32 v84, 2, v84
    v_add_u32 v84, s71, v84
    v_and_b32 v87, 3, v84
    v_lshrrev_b32 v84, 2, v84
    v_lshlrev_b32 v84, 10, v84
    v_lshl_add_u32 v84, v87, 5, v84
    v_bfe_u32 v87, v0, 6, 1
    v_lshl_add_u32 v84, v87, 7, v84
    v_bfe_u32 v87, v0, 8, 1
    v_lshl_add_u32 v84, v87, 8, v84
    v_bfe_u32 v87, v0, 4, 2
    v_lshl_add_u32 v84, v87, 3, v84
    v_bfe_u32 v87, v0, 9, 1
    v_mul_u32_u24 v87, 69632, v87
    v_add_u32 v84, v84, v87
    v_add_u32 v84, 24576, v84
    v_bfe_u32 v85, v0, 7, 1
    v_add_u32 v85, s71, v85
    v_and_b32 v87, 3, v85
    v_lshrrev_b32 v85, 2, v85
    v_lshlrev_b32 v85, 10, v85
    v_lshl_add_u32 v85, v87, 5, v85
    v_bfe_u32 v87, v0, 6, 1
    v_lshl_add_u32 v85, v87, 7, v85
    v_bfe_u32 v87, v0, 8, 1
    v_lshl_add_u32 v85, v87, 8, v85
    v_bfe_u32 v87, v0, 4, 2
    v_lshl_add_u32 v85, v87, 3, v85
    v_bfe_u32 v87, v0, 9, 1
    v_mul_u32_u24 v87, 69632, v87
    v_add_u32 v85, v85, v87
    v_add_u32 v85, 24576, v85
    v_mov_b32 v86, 4
    v_add_u32 v86, s71, v86
    v_and_b32 v87, 3, v86
    v_lshrrev_b32 v86, 2, v86
    v_lshlrev_b32 v86, 10, v86
    v_lshl_add_u32 v86, v87, 5, v86
    v_bfe_u32 v87, v0, 6, 1
    v_lshl_add_u32 v86, v87, 7, v86
    v_bfe_u32 v87, v0, 8, 1
    v_lshl_add_u32 v86, v87, 8, v86
    v_bfe_u32 v87, v0, 4, 2
    v_lshl_add_u32 v86, v87, 3, v86
    v_bfe_u32 v87, v0, 7, 1
    v_mul_u32_u24 v87, 69632, v87
    v_add_u32 v86, v86, v87
    v_bfe_u32 v87, v0, 9, 1
    v_mul_u32_u24 v87, 34816, v87
    v_add_u32 v86, v86, v87
    v_add_u32 v86, 24576, v86
    s_waitcnt vmcnt(16)
    s_barrier
    ds_read_b64_tr_b16 a[76:77], v12 offset:12288
    ds_read_b64_tr_b16 a[78:79], v12 offset:12800
    ds_read_b64_tr_b16 a[84:85], v13 offset:12288
    ds_read_b64_tr_b16 a[86:87], v13 offset:12800
    ds_read_b64_tr_b16 a[96:97], v15 offset:12288
    ds_read_b64_tr_b16 a[98:99], v15 offset:12800
    ds_read_b64_tr_b16 a[100:101], v15 offset:14336
    ds_read_b64_tr_b16 a[102:103], v15 offset:14848
    s_xor_b32 s72, s60, 0
    s_mul_i32 s72, s72, 655360
    s_add_u32 s72, s81, s72
    s_add_u32 m0, s79, 8192
    s_add_u32 s71, s72, 131072
    buffer_load_dwordx4 v80, s[40:43], s71 offen lds
    s_add_u32 m0, s79, 9216
    s_add_u32 s71, s72, 163840
    buffer_load_dwordx4 v80, s[40:43], s71 offen lds
    s_add_u32 m0, s79, 10240
    s_add_u32 s71, s72, 196608
    buffer_load_dwordx4 v80, s[40:43], s71 offen lds
    s_add_u32 m0, s79, 11264
    s_add_u32 s71, s72, 229376
    buffer_load_dwordx4 v80, s[40:43], s71 offen lds
    s_waitcnt lgkmcnt(0)
    s_waitcnt vmcnt(16)
    s_barrier
    ds_read_b64_tr_b16 a[104:105], v14 offset:16384
    ds_read_b64_tr_b16 a[106:107], v14 offset:16896
    ds_read_b64_tr_b16 a[108:109], v14 offset:18432
    ds_read_b64_tr_b16 a[110:111], v14 offset:18944
    ds_read_b64_tr_b16 a[112:113], v15 offset:16384
    ds_read_b64_tr_b16 a[114:115], v15 offset:16896
    ds_read_b64_tr_b16 a[116:117], v15 offset:18432
    ds_read_b64_tr_b16 a[118:119], v15 offset:18944
    s_xor_b32 s72, s60, 2
    s_mul_i32 s72, s72, 655360
    s_add_u32 s72, s81, s72
    s_add_u32 m0, s79, 12288
    s_add_u32 s71, s72, 0
    buffer_load_dwordx4 v80, s[40:43], s71 offen lds
    s_add_u32 m0, s79, 13312
    s_add_u32 s71, s72, 32768
    buffer_load_dwordx4 v80, s[40:43], s71 offen lds
    s_add_u32 m0, s79, 14336
    s_add_u32 s71, s72, 65536
    buffer_load_dwordx4 v80, s[40:43], s71 offen lds
    s_add_u32 m0, s79, 15360
    s_add_u32 s71, s72, 98304
    buffer_load_dwordx4 v80, s[40:43], s71 offen lds
    s_waitcnt lgkmcnt(0)
    s_waitcnt vmcnt(16)
    s_barrier
    ds_read_b64_tr_b16 a[120:121], v14 offset:20480
    ds_read_b64_tr_b16 a[122:123], v14 offset:20992
    ds_read_b64_tr_b16 a[124:125], v14 offset:22528
    ds_read_b64_tr_b16 a[126:127], v14 offset:23040
    ds_read_b64_tr_b16 a[128:129], v15 offset:20480
    ds_read_b64_tr_b16 a[130:131], v15 offset:20992
    ds_read_b64_tr_b16 a[132:133], v15 offset:22528
    ds_read_b64_tr_b16 a[134:135], v15 offset:23040
    s_xor_b32 s72, s60, 2
    s_mul_i32 s72, s72, 655360
    s_add_u32 s72, s81, s72
    s_add_u32 m0, s79, 16384
    s_add_u32 s71, s72, 131072
    buffer_load_dwordx4 v80, s[40:43], s71 offen lds
    s_add_u32 m0, s79, 17408
    s_add_u32 s71, s72, 163840
    buffer_load_dwordx4 v80, s[40:43], s71 offen lds
    s_add_u32 m0, s79, 18432
    s_add_u32 s71, s72, 196608
    buffer_load_dwordx4 v80, s[40:43], s71 offen lds
    s_add_u32 m0, s79, 19456
    s_add_u32 s71, s72, 229376
    buffer_load_dwordx4 v80, s[40:43], s71 offen lds
    s_waitcnt lgkmcnt(0)
    s_waitcnt vmcnt(16)
    s_barrier
    ds_read_b64_tr_b16 a[136:137], v82 offset:0
    ds_read_b64_tr_b16 a[138:139], v82 offset:512
    ds_read_b64_tr_b16 a[140:141], v82 offset:2048
    ds_read_b64_tr_b16 a[142:143], v82 offset:2560
    ds_read_b64_tr_b16 a[144:145], v82 offset:34816
    ds_read_b64_tr_b16 a[146:147], v82 offset:35328
    ds_read_b64_tr_b16 a[148:149], v82 offset:36864
    ds_read_b64_tr_b16 a[150:151], v82 offset:37376
    s_mul_i32 s72, s82, 1310720
    s_add_u32 s72, s81, s72
    s_add_u32 m0, s79, 20480
    s_add_u32 s71, s72, 524288
    buffer_load_dwordx4 v81, s[40:43], s71 offen lds
    s_add_u32 m0, s79, 21504
    s_add_u32 s71, s72, 589824
    buffer_load_dwordx4 v81, s[40:43], s71 offen lds
    s_add_u32 m0, s79, 22528
    s_add_u32 s71, s72, 1179648
    buffer_load_dwordx4 v81, s[40:43], s71 offen lds
    s_add_u32 m0, s79, 23552
    s_add_u32 s71, s72, 1245184
    buffer_load_dwordx4 v81, s[40:43], s71 offen lds
    s_waitcnt lgkmcnt(0)
    s_mov_b64 exec, 1
    v_mov_b32 v5, 1
    s_cmp_eq_u32 s60, 0
    s_cselect_b32 s71, 64, s46
    buffer_atomic_add v5, off, s[44:47], s71 sc1
    s_mov_b64 exec, -1
    s_waitcnt vmcnt(17)
    s_barrier
    ds_read_b64_tr_b16 a[152:153], v12 offset:4096
    ds_read_b64_tr_b16 a[154:155], v12 offset:4608
    ds_read_b64_tr_b16 a[160:161], v13 offset:4096
    ds_read_b64_tr_b16 a[162:163], v13 offset:4608
    ds_read_b64_tr_b16 v[36:37], v15 offset:4096
    ds_read_b64_tr_b16 v[38:39], v15 offset:4608
    ds_read_b64_tr_b16 v[32:33], v15 offset:6144
    ds_read_b64_tr_b16 v[34:35], v15 offset:6656
    s_add_u32 m0, s79, 0
    s_add_u32 s71, s87, 0
    buffer_load_dwordx4 v83, s[96:99], s71 offen lds
    s_add_u32 m0, s79, 1024
    s_add_u32 s71, s87, 128
    buffer_load_dwordx4 v83, s[96:99], s71 offen lds
    s_add_u32 m0, s79, 2048
    s_add_u32 s71, s87, 256
    buffer_load_dwordx4 v83, s[96:99], s71 offen lds
    s_add_u32 m0, s79, 3072
    s_add_u32 s71, s87, 384
    buffer_load_dwordx4 v83, s[96:99], s71 offen lds
    s_waitcnt lgkmcnt(0)
    s_waitcnt vmcnt(17)
    s_barrier
    ds_read_b64_tr_b16 a[156:157], v12 offset:8192
    ds_read_b64_tr_b16 a[158:159], v12 offset:8704
    ds_read_b64_tr_b16 a[164:165], v13 offset:8192
    ds_read_b64_tr_b16 a[166:167], v13 offset:8704
    ds_read_b64_tr_b16 a[168:169], v15 offset:8192
    ds_read_b64_tr_b16 a[170:171], v15 offset:8704
    ds_read_b64_tr_b16 a[172:173], v15 offset:10240
    ds_read_b64_tr_b16 a[174:175], v15 offset:10752
    s_add_u32 m0, s79, 4096
    s_add_u32 s71, s87, 512
    buffer_load_dwordx4 v83, s[96:99], s71 offen lds
    s_add_u32 m0, s79, 5120
    s_add_u32 s71, s87, 40960
    buffer_load_dwordx4 v83, s[96:99], s71 offen lds
    s_add_u32 m0, s79, 6144
    s_add_u32 s71, s87, 41088
    buffer_load_dwordx4 v83, s[96:99], s71 offen lds
    s_add_u32 m0, s79, 7168
    s_add_u32 s71, s87, 41216
    buffer_load_dwordx4 v83, s[96:99], s71 offen lds
    s_waitcnt lgkmcnt(0)
    s_waitcnt vmcnt(17)
    s_barrier
    ds_read_b64_tr_b16 v[28:29], v14 offset:12288
    ds_read_b64_tr_b16 v[30:31], v14 offset:12800
    ds_read_b64_tr_b16 v[24:25], v14 offset:14336
    ds_read_b64_tr_b16 v[26:27], v14 offset:14848
    ds_read_b64_tr_b16 a[176:177], v15 offset:12288
    ds_read_b64_tr_b16 a[178:179], v15 offset:12800
    ds_read_b64_tr_b16 a[180:181], v15 offset:14336
    ds_read_b64_tr_b16 a[182:183], v15 offset:14848
    s_add_u32 m0, s79, 8192
    s_add_u32 s71, s87, 41344
    buffer_load_dwordx4 v83, s[96:99], s71 offen lds
    s_add_u32 m0, s79, 9216
    s_add_u32 s71, s87, 41472
    buffer_load_dwordx4 v83, s[96:99], s71 offen lds
    s_add_u32 m0, s79, 10240
    s_add_u32 s71, s87, 81920
    buffer_load_dwordx4 v83, s[96:99], s71 offen lds
    s_add_u32 m0, s79, 11264
    s_add_u32 s71, s87, 82048
    buffer_load_dwordx4 v83, s[96:99], s71 offen lds
    s_waitcnt lgkmcnt(0)
    s_waitcnt vmcnt(17)
    s_barrier
    ds_read_b64_tr_b16 a[184:185], v14 offset:16384
    ds_read_b64_tr_b16 a[186:187], v14 offset:16896
    ds_read_b64_tr_b16 a[188:189], v14 offset:18432
    ds_read_b64_tr_b16 a[190:191], v14 offset:18944
    ds_read_b64_tr_b16 a[192:193], v15 offset:16384
    ds_read_b64_tr_b16 a[194:195], v15 offset:16896
    ds_read_b64_tr_b16 a[196:197], v15 offset:18432
    ds_read_b64_tr_b16 a[198:199], v15 offset:18944
    s_add_u32 m0, s79, 12288
    s_add_u32 s71, s87, 82176
    buffer_load_dwordx4 v83, s[96:99], s71 offen lds
    s_add_u32 m0, s79, 13312
    s_add_u32 s71, s87, 82304
    buffer_load_dwordx4 v83, s[96:99], s71 offen lds
    s_add_u32 m0, s79, 14336
    s_add_u32 s71, s87, 82432
    buffer_load_dwordx4 v83, s[96:99], s71 offen lds
    s_add_u32 m0, s79, 15360
    s_add_u32 s71, s87, 122880
    buffer_load_dwordx4 v83, s[96:99], s71 offen lds
    s_waitcnt lgkmcnt(0)
    s_waitcnt vmcnt(17)
    s_barrier
    ds_read_b64_tr_b16 a[200:201], v82 offset:20480
    ds_read_b64_tr_b16 a[202:203], v82 offset:20992
    ds_read_b64_tr_b16 a[204:205], v82 offset:22528
    ds_read_b64_tr_b16 a[206:207], v82 offset:23040
    ds_read_b64_tr_b16 v[20:21], v82 offset:55296
    ds_read_b64_tr_b16 v[22:23], v82 offset:55808
    ds_read_b64_tr_b16 v[16:17], v82 offset:57344
    ds_read_b64_tr_b16 v[18:19], v82 offset:57856
    s_add_u32 m0, s79, 16384
    s_add_u32 s71, s87, 123008
    buffer_load_dwordx4 v83, s[96:99], s71 offen lds
    s_add_u32 m0, s79, 17408
    s_add_u32 s71, s87, 123136
    buffer_load_dwordx4 v83, s[96:99], s71 offen lds
    s_add_u32 m0, s79, 18432
    s_add_u32 s71, s87, 123264
    buffer_load_dwordx4 v83, s[96:99], s71 offen lds
    s_add_u32 m0, s79, 19456
    s_add_u32 s71, s87, 123392
    buffer_load_dwordx4 v83, s[96:99], s71 offen lds
    s_waitcnt lgkmcnt(0)
    s_waitcnt vmcnt(15)
    s_barrier
    ds_write_b128 v1, v[76:79] offset:20480
    ds_write_b128 v1, v[72:75] offset:21504
    ds_write_b128 v1, v[68:71] offset:22528
    ds_write_b128 v1, v[64:67] offset:23552
    ds_read_b64_tr_b16 a[208:209], v84 offset:0
    ds_read_b64_tr_b16 a[210:211], v84 offset:512
    ds_read_b64_tr_b16 a[212:213], v84 offset:34816
    ds_read_b64_tr_b16 a[214:215], v84 offset:35328
    ds_read_b64_tr_b16 v[64:65], v85 offset:0
    ds_read_b64_tr_b16 v[66:67], v85 offset:512
    ds_read_b64_tr_b16 v[68:69], v85 offset:34816
    ds_read_b64_tr_b16 v[70:71], v85 offset:35328
    ds_read_b64_tr_b16 a[216:217], v86 offset:0
    ds_read_b64_tr_b16 a[218:219], v86 offset:512
    s_waitcnt lgkmcnt(0)
    s_cmp_eq_u32 s75, 0
    s_cselect_b32 s72, 0x10000000, s67
    v_lshlrev_b32 v87, 3, v0
    s_mov_b64 exec, 0xffff
    buffer_load_dword v5, v87, s[32:35], s72 offen sc1
    v_bfe_u32 v87, v0, 4, 1
    v_lshlrev_b32 v87, 7, v87
    v_bfe_u32 v83, v0, 5, 2
    v_lshl_add_u32 v87, v83, 14, v87
    s_mov_b64 exec, 0xff
    buffer_load_dword v5, v87, s[32:35], s77 offen sc1
    s_mov_b64 exec, -1
    s_add_u32 s77, s77, 49152
    s_lshr_b32 s81, s59, 1
    s_lshl_b32 s81, s81, 7
    s_add_u32 s81, s81, 91226112
    s_waitcnt vmcnt(12)
    s_barrier
    ds_write_b128 v1, v[60:63] offset:0
    ds_write_b128 v1, v[56:59] offset:1024
    ds_write_b128 v1, v[52:55] offset:2048
    ds_write_b128 v1, v[48:51] offset:3072
    ds_write_b128 v1, v[44:47] offset:4096
    ds_read_b64_tr_b16 a[224:225], v84 offset:5120
    ds_read_b64_tr_b16 a[226:227], v84 offset:5632
    ds_read_b64_tr_b16 a[228:229], v84 offset:39936
    ds_read_b64_tr_b16 a[230:231], v84 offset:40448
    ds_read_b64_tr_b16 v[44:45], v85 offset:5120
    ds_read_b64_tr_b16 v[46:47], v85 offset:5632
    ds_read_b64_tr_b16 v[48:49], v85 offset:39936
    ds_read_b64_tr_b16 v[50:51], v85 offset:40448
    ds_read_b64_tr_b16 a[220:221], v86 offset:5120
    ds_read_b64_tr_b16 a[222:223], v86 offset:5632
    s_waitcnt lgkmcnt(0)
    s_cmp_eq_u32 s60, 3
    s_cselect_b32 s56, 0, s46
    buffer_load_dwordx2 v[80:81], off, s[44:47], s56 offset:140 sc1
    s_waitcnt vmcnt(8)
    s_barrier
    ds_write_b128 v1, v[40:43] offset:5120
    ds_write_b128 v1, v[36:39] offset:6144
    ds_write_b128 v1, v[32:35] offset:7168
    ds_write_b128 v1, v[28:31] offset:8192
    ds_write_b128 v1, v[24:27] offset:9216
    ds_read_b64_tr_b16 a[232:233], v84 offset:10240
    ds_read_b64_tr_b16 a[234:235], v84 offset:10752
    ds_read_b64_tr_b16 a[236:237], v84 offset:45056
    ds_read_b64_tr_b16 a[238:239], v84 offset:45568
    ds_read_b64_tr_b16 v[24:25], v85 offset:10240
    ds_read_b64_tr_b16 v[26:27], v85 offset:10752
    ds_read_b64_tr_b16 v[28:29], v85 offset:45056
    ds_read_b64_tr_b16 v[30:31], v85 offset:45568
    ds_read_b64_tr_b16 a[240:241], v86 offset:10240
    ds_read_b64_tr_b16 a[242:243], v86 offset:10752
    s_waitcnt lgkmcnt(0)
    s_waitcnt vmcnt(3)
    s_barrier
    ds_write_b128 v1, v[20:23] offset:10240
    ds_write_b128 v1, v[16:19] offset:11264
    ds_write_b128 v1, v[64:67] offset:12288
    ds_write_b128 v1, v[68:71] offset:13312
    ds_write_b128 v1, v[44:47] offset:14336
    ds_read_b64_tr_b16 a[248:249], v84 offset:15360
    ds_read_b64_tr_b16 a[250:251], v84 offset:15872
    ds_read_b64_tr_b16 a[252:253], v84 offset:50176
    ds_read_b64_tr_b16 a[254:255], v84 offset:50688
    ds_read_b64_tr_b16 v[44:45], v85 offset:15360
    ds_read_b64_tr_b16 v[46:47], v85 offset:15872
    ds_read_b64_tr_b16 v[68:69], v85 offset:50176
    ds_read_b64_tr_b16 v[70:71], v85 offset:50688
    ds_read_b64_tr_b16 a[244:245], v86 offset:15360
    ds_read_b64_tr_b16 a[246:247], v86 offset:15872
    s_waitcnt lgkmcnt(0)
    s_waitcnt vmcnt(0)
    s_cmp_lg_u32 s60, 3
    s_cbranch_scc1 Lnw_5
    s_branch Lgw_8
Lgw_7:
    s_sub_u32 s70, s70, 1
    s_cbranch_scc1 Lrec_timeout_2
    buffer_load_dwordx2 v[80:81], off, s[44:47], s56 offset:140 sc1
    s_waitcnt vmcnt(0)
Lgw_8:
    v_readfirstlane_b32 s80, v80
    s_nop 0
    s_cmp_lg_u32 s80, 0
    s_cbranch_scc1 Lkv_6
    s_sleep 4
    s_branch Lgw_7
Lkv_6:
    s_mul_i32 s80, s80, 3
    s_sub_u32 s80, s80, 2
    v_mov_b32 v17, 20480
    ds_write_b32 v17, v81
    s_waitcnt lgkmcnt(0)
Lnw_5:
    s_barrier
    ds_write_b128 v1, v[48:51] offset:15360
    ds_write_b128 v1, v[24:27] offset:16384
    ds_write_b128 v1, v[28:31] offset:17408
    ds_write_b128 v1, v[44:47] offset:18432
    ds_write_b128 v1, v[68:71] offset:19456
    s_waitcnt lgkmcnt(0)
    s_waitcnt lgkmcnt(0)
    v_mov_b32 v17, 20480
    ds_read_b32 v16, v17
    s_waitcnt lgkmcnt(0)
    v_readfirstlane_b32 s71, v16
    s_nop 0
    s_and_b32 s71, s71, 8192
    s_add_u32 s63, s63, s71
    s_add_u32 s65, s65, s71
    v_mov_b64 v[16:17], 0
    v_mov_b64 v[18:19], 0
    v_mov_b64 v[20:21], 0
    v_mov_b64 v[22:23], 0
    v_mov_b64 v[24:25], 0
    v_mov_b64 v[26:27], 0
    ds_read_b128 v[80:83], v1 offset:28672
    ds_read_b128 v[84:87], v1 offset:29696
    ds_read_b128 v[64:67], v1 offset:22528
    ds_read_b128 v[68:71], v1 offset:23552
    ds_read_b128 v[72:75], v1 offset:24576
    ds_read_b128 v[76:79], v1 offset:25600
    v_xor_b32 v60, 1024, v9
    v_xor_b32 v61, 2048, v9
    v_xor_b32 v62, 3072, v9
    v_lshrrev_b32 v63, 2, v11
    v_mov_b64 v[28:29], -1
    v_mov_b64 v[30:31], -1
    v_mov_b32 v12, -1
    s_and_b32 s78, s60, 1
    s_lshl_b32 s71, s58, 7
    s_lshl_b32 s72, s60, 5
    s_add_u32 s71, s71, s72
    s_add_u32 s71, s71, s59
    s_cmp_eq_u32 s71, 127
    s_cselect_b32 s86, 0x5702800, s34
    s_lshl_b32 s78, s78, 12
    s_add_u32 s78, s78, s68
    s_lshr_b32 s72, s60, 1
    s_mul_i32 s72, s72, 16777216
    s_add_u32 s78, s78, s72
    s_add_u32 s78, s78, 524288
    ds_read_b32 v15, v0 offset:19464
    s_waitcnt lgkmcnt(0)
    buffer_load_dwordx4 v[28:31], v11, s[32:35], s62 offen offset:1024 sc1
    buffer_load_dword v12, v63, s[32:35], s62 offen sc1
    s_mov_b32 s87, 8
    s_cmp_lg_u32 s60, 3
    s_cbranch_scc1 Lnokd_14
    s_nop 7
    s_add_u32 s71, s68, 0
    s_mov_b32 m0, 0
    s_nop 0
    buffer_load_dwordx4 v15, s[32:35], s71 offen offset:0 lds
    buffer_load_dwordx4 v15, s[32:35], s71 offen offset:1024 lds
    buffer_load_dwordx4 v15, s[32:35], s71 offen offset:2048 lds
    buffer_load_dwordx4 v15, s[32:35], s71 offen offset:3072 lds
    s_add_u32 s71, s68, 4096
    s_mov_b32 m0, 4096
    s_nop 0
    buffer_load_dwordx4 v15, s[32:35], s71 offen offset:0 lds
    buffer_load_dwordx4 v15, s[32:35], s71 offen offset:1024 lds
    buffer_load_dwordx4 v15, s[32:35], s71 offen offset:2048 lds
    buffer_load_dwordx4 v15, s[32:35], s71 offen offset:3072 lds
    v_lshlrev_b32 v14, 3, v0
    s_add_u32 s71, s68, 16777216
    buffer_load_dword v5, v14, s[32:35], s71 offen
    s_add_u32 s71, s68, 262144
    buffer_load_dword v5, v14, s[32:35], s71 offen
    s_add_u32 s71, s68, 17039360
    buffer_load_dword v5, v14, s[32:35], s71 offen
Lnokd_14:
    s_lshl_b32 s71, s60, 11
    s_add_u32 m0, s71, 0
    s_add_u32 s68, s68, s71
    s_add_u32 s68, s68, 262144
    s_branch Lalc_13
    .p2align 6
Lstep_9:
Lal_12:
    buffer_load_dwordx4 v[28:31], v11, s[32:35], s62 offen offset:1024 sc1
    buffer_load_dword v12, v63, s[32:35], s62 offen sc1
    s_mov_b32 s87, 1
    s_sub_u32 s70, s70, 1
    s_cbranch_scc1 Lrec_timeout_2
Lalc_13:
    v_max3_u32 v14, v28, v29, v30
    v_max3_u32 v14, v14, v31, v12
    v_cmp_eq_u32 vcc, -1, v14
    s_nop 3
    s_cbranch_vccz Lgo_15
    s_sub_u32 s87, s87, 1
    s_cbranch_scc0 Lalc_13
    s_branch Lal_12
Lgo_15:
    ds_write_b128 v11, v[28:31] offset:9216
    v_smfmac_f32_16x16x64_bf16 v[20:23], v[28:31], v[88:95], v2
    ds_write_b32 v63, v12 offset:8192
    v_mov_b32_dpp v32, v28 row_ror:8 row_mask:0xf bank_mask:0xf
    v_smfmac_f32_16x16x64_bf16 v[24:27], v[28:31], v[200:207], v2
    v_mov_b32_dpp v33, v29 row_ror:8 row_mask:0xf bank_mask:0xf
    v_mov_b32_dpp v34, v30 row_ror:8 row_mask:0xf bank_mask:0xf
    v_smfmac_f32_16x16x64_bf16 v[16:19], v[28:31], v[80:87], v2
    v_mov_b32_dpp v35, v31 row_ror:8 row_mask:0xf bank_mask:0xf
    buffer_load_dwordx4 v[36:39], v11, s[32:35], s63 offen offset:1024 sc1
    buffer_load_dword v13, v63, s[32:35], s63 offen sc1
    s_waitcnt lgkmcnt(0)
    s_barrier
    ds_read_b128 v[40:43], v60 offset:9216
    ds_read_b128 v[44:47], v60 offset:9728
    v_smfmac_f32_16x16x64_bf16 v[20:23], v[32:35], v[96:103], v2
    ds_read_b128 v[48:51], v61 offset:9216
    v_smfmac_f32_16x16x64_bf16 v[24:27], v[32:35], v[208:215], v2
    ds_read_b128 v[80:83], v1 offset:30720
    v_smfmac_f32_16x16x64_bf16 v[16:19], v[32:35], v[152:159], v2
    ds_read_b128 v[84:87], v1 offset:31744
    s_waitcnt lgkmcnt(4)
    v_smfmac_f32_16x16x64_bf16 v[20:23], v[40:43], v[104:111], v2
    ds_read_b128 v[52:55], v61 offset:9728
    v_smfmac_f32_16x16x64_bf16 v[24:27], v[40:43], v[64:71], v2
    ds_read_b128 v[32:35], v62 offset:9216
    v_smfmac_f32_16x16x64_bf16 v[16:19], v[40:43], v[160:167], v2
    ds_read_b128 v[64:67], v1 offset:26624
    s_waitcnt lgkmcnt(6)
    v_smfmac_f32_16x16x64_bf16 v[20:23], v[44:47], v[72:79], v2
    ds_read_b128 v[68:71], v1 offset:27648
    v_smfmac_f32_16x16x64_bf16 v[24:27], v[44:47], v[216:223], v2
    ds_read_b128 v[72:75], v1 offset:32768
    v_smfmac_f32_16x16x64_bf16 v[16:19], v[44:47], v[168:175], v2
    buffer_load_dwordx4 v[56:59], v11, s[32:35], s63 offen offset:1024 sc1
    ds_read_b128 v[76:79], v1 offset:33792
    s_waitcnt lgkmcnt(8)
    v_smfmac_f32_16x16x64_bf16 v[20:23], v[48:51], v[112:119], v2
    buffer_load_dword v5, v63, s[32:35], s63 offen sc1
    ds_read_b128 v[40:43], v62 offset:9728
    v_smfmac_f32_16x16x64_bf16 v[24:27], v[48:51], v[224:231], v2
    ds_read_b128 v[44:47], v10 offset:8192
    s_waitcnt lgkmcnt(8)
    v_smfmac_f32_16x16x64_bf16 v[16:19], v[48:51], v[80:87], v2
    ds_read_b128 v[80:83], v1 offset:0
    s_waitcnt lgkmcnt(8)
    v_smfmac_f32_16x16x64_bf16 v[20:23], v[52:55], v[120:127], v2
    ds_read_b128 v[84:87], v1 offset:1024
    v_smfmac_f32_16x16x64_bf16 v[24:27], v[52:55], v[240:247], v2
    v_smfmac_f32_16x16x64_bf16 v[16:19], v[52:55], v[176:183], v2
    ds_read_b128 v[52:55], v10 offset:8704
    s_waitcnt lgkmcnt(7)
    v_smfmac_f32_16x16x64_bf16 v[20:23], v[32:35], v[64:71], v2
    v_mov_b32 v15, s61
    ds_read_b128 v[64:67], v1 offset:20480
    v_smfmac_f32_16x16x64_bf16 v[24:27], v[32:35], v[232:239], v2
    ds_read_b128 v[68:71], v1 offset:21504
    s_waitcnt lgkmcnt(7)
    v_smfmac_f32_16x16x64_bf16 v[16:19], v[32:35], v[72:79], v2
    ds_read_b128 v[72:75], v1 offset:2048
    s_waitcnt lgkmcnt(7)
    v_smfmac_f32_16x16x64_bf16 v[20:23], v[40:43], v[128:135], v2
    s_waitcnt vmcnt(2)
    ds_write_b128 v11, v[36:39] offset:14336
    v_max3_u32 v14, v36, v37, v38
    v_smfmac_f32_16x16x64_bf16 v[24:27], v[40:43], v[248:255], v2
    ds_write_b32 v63, v13 offset:13312
    v_max3_u32 v14, v14, v39, v13
    v_cmp_eq_u32 vcc, -1, v14
    v_smfmac_f32_16x16x64_bf16 v[16:19], v[40:43], v[184:191], v2
    s_cbranch_vccnz Lar_10
Laro_11:
    v_mov_b32_dpp v48, v36 row_ror:8 row_mask:0xf bank_mask:0xf
    ds_read_b128 v[76:79], v1 offset:3072
    s_waitcnt lgkmcnt(9)
    v_smfmac_f32_16x16x64_bf16 v[20:23], v[44:47], v[136:143], v2
    v_mov_b32_dpp v49, v37 row_ror:8 row_mask:0xf bank_mask:0xf
    s_waitcnt lgkmcnt(7)
    v_smfmac_f32_16x16x64_bf16 v[24:27], v[44:47], v[80:87], v2
    v_mov_b32_dpp v50, v38 row_ror:8 row_mask:0xf bank_mask:0xf
    v_mov_b32_dpp v51, v39 row_ror:8 row_mask:0xf bank_mask:0xf
    ds_read_b128 v[80:83], v1 offset:6144
    v_smfmac_f32_16x16x64_bf16 v[16:19], v[44:47], v[192:199], v2
    buffer_store_dword v15, v0, s[32:35], s86 offen sc1
    s_waitcnt lgkmcnt(2)
    s_barrier
    ds_read_b128 v[28:31], v60 offset:14336
    ds_read_b128 v[84:87], v1 offset:7168
    v_smfmac_f32_16x16x64_bf16 v[20:23], v[52:55], v[144:151], v2
    ds_read_b128 v[32:35], v60 offset:14848
    v_smfmac_f32_16x16x64_bf16 v[24:27], v[52:55], a[0:7], v2
    ds_read_b128 v[40:43], v61 offset:14848
    v_smfmac_f32_16x16x64_bf16 v[16:19], v[52:55], v[64:71], v2
    ds_read_b128 v[52:55], v61 offset:14336
    v_smfmac_f32_16x16x64_bf16 v[20:23], v[36:39], a[8:15], v2
    ds_read_b128 v[64:67], v1 offset:8192
    v_smfmac_f32_16x16x64_bf16 v[24:27], v[36:39], a[152:159], v2
    ds_read_b128 v[68:71], v1 offset:9216
    s_waitcnt lgkmcnt(8)
    v_smfmac_f32_16x16x64_bf16 v[20:23], v[48:51], v[72:79], v2
    ds_read_b128 v[44:47], v62 offset:14336
    v_smfmac_f32_16x16x64_bf16 v[24:27], v[48:51], a[160:167], v2
    ds_read_b128 v[72:75], v1 offset:4096
    s_waitcnt lgkmcnt(8)
    v_smfmac_f32_16x16x64_bf16 v[20:23], v[28:31], a[16:23], v2
    ds_read_b128 v[76:79], v1 offset:5120
    s_waitcnt lgkmcnt(8)
    v_smfmac_f32_16x16x64_bf16 v[24:27], v[28:31], v[80:87], v2
    ds_read_b128 v[80:83], v10 offset:13312
    s_waitcnt lgkmcnt(8)
    v_smfmac_f32_16x16x64_bf16 v[20:23], v[32:35], a[24:31], v2
    ds_read_b128 v[84:87], v10 offset:13824
    v_smfmac_f32_16x16x64_bf16 v[24:27], v[32:35], a[168:175], v2
    s_waitcnt vmcnt(1)
    ds_read_b128 v[56:59], v62 offset:14848
    s_waitcnt lgkmcnt(8)
    v_smfmac_f32_16x16x64_bf16 v[20:23], v[52:55], a[32:39], v2
    s_waitcnt lgkmcnt(6)
    v_smfmac_f32_16x16x64_bf16 v[24:27], v[52:55], v[64:71], v2
    ds_read_b128 v[64:67], v1 offset:10240
    v_smfmac_f32_16x16x64_bf16 v[20:23], v[40:43], a[48:55], v2
    ds_read_b128 v[68:71], v1 offset:11264
    v_smfmac_f32_16x16x64_bf16 v[24:27], v[40:43], a[184:191], v2
    s_waitcnt lgkmcnt(7)
    v_smfmac_f32_16x16x64_bf16 v[20:23], v[44:47], a[40:47], v2
    v_smfmac_f32_16x16x64_bf16 v[24:27], v[44:47], a[176:183], v2
    s_waitcnt lgkmcnt(2)
    v_smfmac_f32_16x16x64_bf16 v[20:23], v[56:59], v[72:79], v2
    v_smfmac_f32_16x16x64_bf16 v[24:27], v[56:59], a[192:199], v2
    v_smfmac_f32_16x16x64_bf16 v[20:23], v[80:83], a[56:63], v2
    v_smfmac_f32_16x16x64_bf16 v[20:23], v[84:87], a[64:71], v2
    v_smfmac_f32_16x16x64_bf16 v[24:27], v[80:83], a[200:207], v2
    s_waitcnt lgkmcnt(0)
    v_smfmac_f32_16x16x64_bf16 v[24:27], v[84:87], v[64:71], v2
    v_cvt_pk_bf16_f32 v60, v20, v21
    v_cvt_pk_bf16_f32 v62, v22, v23
    v_smfmac_f32_16x16x64_bf16 v[16:19], v[28:31], a[88:95], v2
    v_smfmac_f32_16x16x64_bf16 v[16:19], v[32:35], a[96:103], v2
    v_cvt_pk_bf16_f32 v61, v24, v25
    v_cvt_pk_bf16_f32 v63, v26, v27
    ds_write2_b64 v3, v[60:61], v[62:63] offset0:0 offset1:136
    v_smfmac_f32_16x16x64_bf16 v[16:19], v[36:39], a[72:79], v2
    buffer_load_dwordx4 v[20:23], v6, s[32:35], s83 offen
    v_mov_b32 v12, v61
    ds_read_b128 v[32:35], v6 offset:256
    v_smfmac_f32_16x16x64_bf16 v[16:19], v[40:43], a[120:127], v2
    buffer_load_dwordx4 v[26:29], v6, s[32:35], s83 offen offset:256
    v_mov_b32 v13, v63
    ds_read_b128 v[36:39], v6 offset:2304
    v_smfmac_f32_16x16x64_bf16 v[16:19], v[44:47], a[112:119], v2
    s_waitcnt lgkmcnt(2)
    s_barrier
    ds_read_b64_tr_b16 v[64:65], v4 offset:0
    ds_read_b64_tr_b16 v[66:67], v4 offset:64
    ds_read_b64_tr_b16 v[68:69], v4 offset:256
    ds_read_b64_tr_b16 v[70:71], v4 offset:320
    v_smfmac_f32_16x16x64_bf16 v[16:19], v[48:51], a[80:87], v2
    v_lshlrev_b32 v15, 2, v0
    ds_read_b64_tr_b16 v[72:73], v4 offset:512
    ds_read_b64_tr_b16 v[74:75], v4 offset:576
    ds_read_b64_tr_b16 v[76:77], v4 offset:768
    ds_read_b64_tr_b16 v[78:79], v4 offset:832
    v_smfmac_f32_16x16x64_bf16 v[16:19], v[52:55], a[104:111], v2
    buffer_load_dword v5, v15, s[32:35], s78 offen
    ds_read_b128 v[40:43], v6 offset:4352
    ds_read_b128 v[44:47], v6 offset:6400
    v_smfmac_f32_16x16x64_bf16 v[16:19], v[80:83], a[136:143], v2
    ds_read_b128 v[48:51], v6 offset:0
    ds_read_b128 v[52:55], v6 offset:2048
    v_smfmac_f32_16x16x64_bf16 v[16:19], v[84:87], a[144:151], v2
    ds_read_b128 v[80:83], v6 offset:4096
    ds_read_b128 v[84:87], v6 offset:6144
    v_smfmac_f32_16x16x64_bf16 v[16:19], v[56:59], a[128:135], v2
    v_mov_b32 v25, 0
    s_waitcnt lgkmcnt(12)
    v_mfma_f32_16x16x32_bf16 v[60:63], v[32:35], v[64:67], 0
    s_cmp_eq_u32 s61, 63
    s_waitcnt lgkmcnt(10)
    v_mfma_f32_16x16x32_bf16 v[60:63], v[36:39], v[68:71], v[60:63]
    v_cvt_pk_bf16_f32 v24, v16, v17
    v_cvt_pk_bf16_f32 v30, v18, v19
    s_waitcnt lgkmcnt(5)
    v_mfma_f32_16x16x32_bf16 v[60:63], v[40:43], v[72:75], v[60:63]
    v_cndmask_b32 v12, v12, v24, s[54:55]
    v_cndmask_b32 v13, v13, v30, s[54:55]
    s_cbranch_scc1 Lrec_fin_16
    s_waitcnt lgkmcnt(4)
    v_mfma_f32_16x16x32_bf16 v[60:63], v[44:47], v[76:79], v[60:63]
    v_permlane32_swap_b32 v24, v30
    v_mov_b32 v38, v2
    s_waitcnt lgkmcnt(3)
    v_mfma_f32_16x16x32_bf16 v[56:59], v[48:51], v[64:67], 0
    v_mov_b32 v39, v2
    v_mov_b32 v40, 0x3f803f80
    s_waitcnt lgkmcnt(2)
    v_mfma_f32_16x16x32_bf16 v[56:59], v[52:55], v[68:71], v[56:59]
    v_mov_b32 v41, 0x3f803f80
    v_mov_b32 v42, 0x3f803f80
    s_waitcnt lgkmcnt(1)
    v_mfma_f32_16x16x32_bf16 v[56:59], v[80:83], v[72:75], v[56:59]
    v_mov_b32 v43, 0x3f803f80
    v_mov_b64 v[44:45], 0
    s_waitcnt lgkmcnt(0)
    v_mfma_f32_16x16x32_bf16 v[56:59], v[84:87], v[76:79], v[56:59]
    s_mov_b64 vcc, s[52:53]
    v_mov_b64 v[46:47], 0
    v_mfma_f32_16x16x32_bf16 v[36:39], v[64:67], v[64:67], v[36:39]
    ds_read_b128 v[80:83], v1 offset:12288
    ds_read_b128 v[84:87], v1 offset:13312
    v_mfma_f32_16x16x32_bf16 v[36:39], v[68:71], v[68:71], v[36:39]
    v_cndmask_b32_dpp v60, v56, v60, vcc quad_perm:[0,1,0,1] row_mask:0xf bank_mask:0xf
    v_cndmask_b32_dpp v61, v57, v61, vcc quad_perm:[0,1,0,1] row_mask:0xf bank_mask:0xf
    v_mfma_f32_16x16x32_bf16 v[36:39], v[72:75], v[72:75], v[36:39]
    v_cndmask_b32_dpp v62, v58, v62, vcc quad_perm:[0,1,0,1] row_mask:0xf bank_mask:0xf
    v_cndmask_b32_dpp v63, v59, v63, vcc quad_perm:[0,1,0,1] row_mask:0xf bank_mask:0xf
    v_mfma_f32_16x16x32_bf16 v[36:39], v[76:79], v[76:79], v[36:39]
    v_max3_f32 v14, v60, v61, v62
    ds_read_b128 v[64:67], v1 offset:14336
    v_max_f32 v14, v14, v63
    ds_read_b128 v[68:71], v1 offset:15360
    v_mov_b64 v[48:49], 0
    v_mov_b64 v[50:51], 0
    s_nop 1
    v_max3_f32 v14, v14, v38, v39
    v_mov_b32 v37, 0
    ds_read_b128 v[72:75], v1 offset:16384
    v_max_f32_dpp v15, v14, v14 quad_perm:[2,3,0,1] row_mask:0xf bank_mask:0xf
    v_max_f32_dpp v14, v14, v14 quad_perm:[2,3,0,1] row_mask:0xf bank_mask:0xf
    ds_read_b128 v[76:79], v1 offset:17408
    v_mov_b64 v[52:53], 0
    v_permlane16_swap_b32 v14, v15
    v_max_f32 v14, v14, v15
    v_mov_b32 v15, v14
    v_mov_b64 v[54:55], 0
    s_add_u32 s61, s61, 1
    v_permlane32_swap_b32 v14, v15
    v_max_f32 v14, v14, v15
    v_mul_f32 v14, s76, v14
    v_fma_f32 v60, v60, s76, -v14
    v_fma_f32 v61, v61, s76, -v14
    v_fma_f32 v62, v62, s76, -v14
    v_fma_f32 v63, v63, s76, -v14
    v_fma_f32 v38, v38, s76, -v14
    v_fma_f32 v39, v39, s76, -v14
    v_exp_f32 v60, v60
    v_exp_f32 v61, v61
    v_exp_f32 v62, v62
    v_cvt_pk_bf16_f32 v34, v60, v61
    v_exp_f32 v63, v63
    v_exp_f32 v38, v38
    v_cvt_pk_bf16_f32 v35, v62, v63
    v_exp_f32 v39, v39
    v_mov_b32_dpp v32, v34 quad_perm:[2,3,2,3] row_mask:0xf bank_mask:0xf
    v_cvt_pk_bf16_f32 v36, v38, v39
    v_mov_b32_dpp v33, v35 quad_perm:[2,3,2,3] row_mask:0xf bank_mask:0xf
    s_waitcnt vmcnt(1)
    v_mfma_f32_16x16x32_bf16 v[56:59], v[40:43], v[34:37], 0
    v_mfma_f32_16x16x32_bf16 v[60:63], v[22:25], v[34:37], 0
    v_lshrrev_b32 v38, 1, v0
    v_mfma_f32_16x16x32_bf16 v[16:19], v[28:31], v[34:37], 0
    v_add_f32_dpp v14, v56, v56 quad_perm:[2,3,0,1] row_mask:0xf bank_mask:0xf
    v_mfma_f32_16x16x16_bf16 v[60:63], v[20:21], v[32:33], v[60:63]
    v_rcp_f32 v14, v14
    ds_read_b32 v40, v0 offset:19464
    v_mfma_f32_16x16x16_bf16 v[16:19], v[26:27], v[32:33], v[16:19]
    s_nop 3
    v_mul_f32 v60, v60, v14
    v_mul_f32 v61, v61, v14
    v_mul_f32 v62, v62, v14
    v_mul_f32 v63, v63, v14
    v_cvt_pk_bf16_f32 v32, v60, v61
    v_cvt_pk_bf16_f32 v33, v62, v63
    v_mul_f32 v16, v16, v14
    v_mul_f32 v17, v17, v14
    v_mul_f32 v18, v18, v14
    v_mul_f32 v19, v19, v14
    v_cvt_pk_bf16_f32 v34, v16, v17
    v_cvt_pk_bf16_f32 v35, v18, v19
    ds_write2_b64 v7, v[32:33], v[34:35] offset0:0 offset1:32
    buffer_store_dwordx2 v[12:13], v38, s[32:35], s69 offen sc1
    ds_read_b128 v[56:59], v1 offset:18432
    ds_read_b128 v[60:63], v1 offset:19456
    s_nop 3
    s_waitcnt lgkmcnt(2)
    s_barrier
    ds_read_b128 v[32:35], v0 offset:13312
    ds_read_b128 v[36:39], v0 offset:14336
    ds_read_b128 v[16:19], v10 offset:13312
    ds_read_b128 v[20:23], v10 offset:13824
    ds_read_b128 v[24:27], v10 offset:14336
    ds_read_b128 v[28:31], v10 offset:14848
    ds_read_b32 v15, v0 offset:22528
    buffer_load_dwordx4 v40, s[32:35], s68 offen offset:0 lds
    buffer_load_dwordx4 v40, s[32:35], s68 offen offset:1024 lds
    s_waitcnt lgkmcnt(6)
    v_smfmac_f32_16x16x64_bf16 v[44:47], v[32:35], a[216:223], v2
    s_waitcnt lgkmcnt(5)
    v_smfmac_f32_16x16x64_bf16 v[44:47], v[36:39], a[240:247], v2
    s_waitcnt lgkmcnt(4)
    v_smfmac_f32_16x16x64_bf16 v[48:51], v[16:19], a[208:215], v2
    ds_read_b128 v[40:43], v0 offset:18432
    v_not_b32 v35, s84
    s_waitcnt lgkmcnt(4)
    v_smfmac_f32_16x16x64_bf16 v[48:51], v[20:23], a[224:231], v2
    v_permlane32_swap_b32 v44, v46
    v_permlane32_swap_b32 v45, v47
    s_waitcnt lgkmcnt(3)
    v_smfmac_f32_16x16x64_bf16 v[48:51], v[24:27], a[232:239], v2
    v_add_f32 v44, v44, v46
    v_add_f32 v45, v45, v47
    s_waitcnt lgkmcnt(2)
    v_smfmac_f32_16x16x64_bf16 v[48:51], v[28:31], a[248:255], v2
    v_cvt_pk_bf16_f32 v44, v44, v45
    v_bfi_b32 v44, 1, s84, v44
    ds_read_b32 v46, v0 offset:19468
    v_smfmac_f32_16x16x64_bf16 v[52:55], v[16:19], v[80:87], v2
    s_waitcnt lgkmcnt(2)
    buffer_store_dword v44, v15, s[32:35], s85 offen
    v_smfmac_f32_16x16x64_bf16 v[52:55], v[20:23], v[64:71], v2
    v_cvt_pk_bf16_f32 v51, v50, v51
    v_cvt_pk_bf16_f32 v50, v48, v49
    v_smfmac_f32_16x16x64_bf16 v[52:55], v[24:27], v[72:79], v2
    v_bfi_b32 v51, 1, s84, v51
    v_not_b32 v39, s84
    v_smfmac_f32_16x16x64_bf16 v[52:55], v[28:31], v[56:63], v2
    ds_read_b96 v[60:62], v0 offset:19456
    ds_read_b128 v[80:83], v1 offset:28672
    ds_read_b128 v[84:87], v1 offset:29696
    v_mov_b64 v[16:17], 0
    v_mov_b64 v[18:19], 0
    v_mov_b64 v[20:21], 0
    s_cmp_eq_u32 s75, 0
    s_nop 0
    v_cvt_pk_bf16_f32 v48, v52, v53
    v_cvt_pk_bf16_f32 v49, v54, v55
    buffer_store_dwordx4 v[48:51], v8, s[32:35], s66 offen
    s_cbranch_scc1 Lnored_17
    ds_read_b128 v[64:67], v1 offset:22528
    ds_read_b128 v[68:71], v1 offset:23552
    ds_read_b128 v[72:75], v1 offset:24576
    ds_read_b128 v[76:79], v1 offset:25600
    v_mov_b64 v[22:23], 0
    v_mov_b64 v[24:25], 0
    v_mov_b64 v[26:27], 0
    v_mov_b64 v[28:29], -1
    v_mov_b64 v[30:31], -1
    v_mov_b32 v12, -1
    s_add_u32 s69, s69, 65536
    s_add_u32 s62, s62, 16384
    s_bitset0_b32 s62, 16
    s_add_u32 s63, s63, 32768
    s_add_u32 s83, s83, 262144
    s_add_u32 s78, s78, 262144
    s_add_u32 s68, s68, 262144
    s_cmp_eq_u32 s60, 2
    s_cselect_b64 vcc, -1, 0
    s_waitcnt lgkmcnt(6)
    v_cndmask_b32 v60, v60, v61, vcc
    s_nop 3
    s_nop 3
    s_nop 3
    s_nop 3
    s_nop 3
    s_nop 3
    s_nop 3
    s_nop 3
    s_nop 3
    s_nop 3
    s_waitcnt lgkmcnt(0)
Lrp_18:
    buffer_load_dwordx4 v[32:35], v46, s[32:35], s67 offen offset:0 sc1
    buffer_load_dwordx4 v[36:39], v46, s[32:35], s67 offen offset:1024 sc1
    s_mov_b32 s87, 1
    s_sub_u32 s70, s70, 1
    s_cbranch_scc1 Lrec_timeout_2
Lrc_19:
    v_bitop3_b32 v14, v35, v39, s84 bitop3:0x7e
    v_and_b32 v14, 1, v14
    v_cmp_ne_u32 vcc, 0, v14
    v_mfma_f32_16x16x32_bf16 v[52:55], v[32:35], v[40:43], 0
    v_mfma_f32_16x16x32_bf16 v[52:55], v[36:39], v[40:43], v[52:55]
    s_nop 2
    s_cbranch_vccz Lro_20
    s_sub_u32 s87, s87, 1
    s_cbranch_scc0 Lrc_19
    s_branch Lrp_18
Lro_20:
    v_xor_b32 v61, 2048, v9
    v_xor_b32 v62, 3072, v9
    v_lshrrev_b32 v63, 2, v11
    s_xor_b32 s84, s84, 1
    v_add_f32 v52, v52, v53
    v_add_f32 v54, v54, v55
    v_add_f32 v52, v52, v54
    s_nop 1
    v_mov_b32_dpp v53, v52 quad_perm:[1,1,3,3] row_mask:0xf bank_mask:0xf
    v_cvt_pk_bf16_f32 v52, v52, v53
    v_min_u32 v52, -2, v52
    buffer_store_dword v52, v60, s[32:35], s64 offen
    buffer_store_dword v52, v60, s[32:35], s65 offen sc1
    s_barrier
    s_add_u32 s64, s64, 16384
    s_bitset0_b32 s64, 16
    s_nop 3
    s_nop 3
    s_nop 3
    s_nop 3
    s_nop 3
    s_nop 3
    s_nop 3
    s_nop 3
    s_add_u32 s65, s65, 32768
    v_xor_b32 v60, 1024, v9
    s_branch Lstep_9
Lnored_17:
    s_cmp_lg_u32 s60, 3
    s_cbranch_scc1 Lnot3_21
    s_cmp_lt_i32 s61, s80
    s_cbranch_scc0 Lrdy_22
Lrdyb_23:
    s_waitcnt lgkmcnt(2)
    v_mov_b64 v[28:29], -1
    v_mov_b64 v[30:31], -1
    v_mov_b32 v12, -1
    s_mov_b64 exec, 0xffff
    buffer_store_dwordx4 v[28:31], v0, s[32:35], s77 offen
    s_mov_b64 exec, -1
    s_add_u32 s77, s77, 16384
    s_bitset0_b32 s77, 16
Lnot3_21:
    ds_read_b128 v[64:67], v1 offset:22528
    ds_read_b128 v[68:71], v1 offset:23552
    ds_read_b128 v[72:75], v1 offset:24576
    ds_read_b128 v[76:79], v1 offset:25600
    v_mov_b64 v[22:23], 0
    v_mov_b64 v[24:25], 0
    v_mov_b64 v[26:27], 0
    v_mov_b64 v[28:29], -1
    v_mov_b64 v[30:31], -1
    v_mov_b32 v12, -1
    s_add_u32 s69, s69, 65536
    s_add_u32 s62, s62, 16384
    s_bitset0_b32 s62, 16
    s_add_u32 s63, s63, 32768
    s_add_u32 s83, s83, 262144
    s_add_u32 s78, s78, 262144
    s_add_u32 s68, s68, 262144
    s_waitcnt lgkmcnt(0)
    v_xor_b32 v60, 1024, v9
    v_xor_b32 v61, 2048, v9
    v_xor_b32 v62, 3072, v9
    v_lshrrev_b32 v63, 2, v11
    s_xor_b32 s84, s84, 1
    s_barrier
    s_nop 3
    s_nop 3
    s_nop 3
    s_nop 3
    s_nop 3
    s_nop 3
    s_nop 3
    s_nop 3
    s_branch Lstep_9
Lar_10:
    s_waitcnt vmcnt(0)
Lar2_24:
    ds_write_b128 v11, v[56:59] offset:14336
    ds_write_b32 v63, v5 offset:13312
    v_max3_u32 v14, v56, v57, v58
    v_max3_u32 v14, v14, v59, v5
    v_cmp_eq_u32 vcc, -1, v14
    v_mov_b64 v[36:37], v[56:57]
    v_mov_b64 v[38:39], v[58:59]
    s_sub_u32 s70, s70, 1
    s_cbranch_scc1 Lrec_timeout_2
    s_waitcnt lgkmcnt(0)
    s_cbranch_vccz Laro_11
    buffer_load_dwordx4 v[36:39], v11, s[32:35], s63 offen offset:1024 sc1
    buffer_load_dword v13, v63, s[32:35], s63 offen sc1
    s_sub_u32 s70, s70, 1
    s_cbranch_scc1 Lrec_timeout_2
    s_sleep 3
    buffer_load_dwordx4 v[56:59], v11, s[32:35], s63 offen offset:1024 sc1
    buffer_load_dword v5, v63, s[32:35], s63 offen sc1
    s_waitcnt vmcnt(2)
    ds_write_b128 v11, v[36:39] offset:14336
    ds_write_b32 v63, v13 offset:13312
    v_max3_u32 v14, v36, v37, v38
    v_max3_u32 v14, v14, v39, v13
    v_cmp_eq_u32 vcc, -1, v14
    s_waitcnt lgkmcnt(0)
    s_cbranch_vccz Laro_11
    s_waitcnt vmcnt(0)
    s_branch Lar2_24
Lrec_timeout_2:
    s_mov_b64 exec, 1
    s_waitcnt vmcnt(0) lgkmcnt(0)
    v_mov_b32 v16, s61
    v_add_u32 v16, 0x1000, v16
    buffer_store_dword v16, off, s[44:47], 0 offset:36 sc1
    s_mov_b64 exec, -1
    s_branch Lrec_end_3
Lrdy_22:
    v_bfe_u32 v15, v0, 2, 6
    v_min_u32 v15, 20, v15
    buffer_load_dword v5, v15, s[32:35], s81 offen offset:12 sc1
    s_sub_u32 s70, s70, 1
    s_cbranch_scc1 Lrec_timeout_2
    s_waitcnt vmcnt(0)
    v_min_u32_dpp v5, v5, v5 row_ror:8 row_mask:0xf bank_mask:0xf
    s_nop 1
    v_min_u32_dpp v5, v5, v5 row_ror:4 row_mask:0xf bank_mask:0xf
    s_nop 1
    v_min_u32_dpp v5, v5, v5 row_ror:2 row_mask:0xf bank_mask:0xf
    s_nop 1
    v_min_u32_dpp v5, v5, v5 row_ror:1 row_mask:0xf bank_mask:0xf
    s_nop 0
    v_readfirstlane_b32 s80, v5
    s_nop 0
    s_mul_i32 s80, s80, 3
    s_sub_u32 s80, s80, 2
    s_cmp_lt_i32 s61, s80
    s_cbranch_scc1 Lrdyb_23
    s_sleep 4
    s_branch Lrdy_22
Lrec_fin_16:
    v_lshrrev_b32 v15, 1, v0
    buffer_store_dwordx2 v[12:13], v15, s[32:35], s69 offen sc1
Lrec_end_3:
    s_waitcnt vmcnt(0) lgkmcnt(0)
    s_endpgm
Lworker:
    s_barrier
    s_mov_b32 s100, 0x8000
    s_cmp_ge_u32 s101, 165
    s_cbranch_scc1 Lattn
    s_mul_hi_u32 s91, s101, 0x55555556
    s_mul_i32 s90, s91, 3
    s_sub_u32 s90, s101, s90
    s_cmp_eq_u32 s90, 0
    s_cselect_b32 s92, 22, 21
    s_mov_b32 s93, 3
    s_and_b32 s94, s91, 15
    s_lshl_b32 s94, s94, 5
    s_lshr_b32 s95, s91, 4
    s_mul_i32 s95, s95, 3
    s_add_u32 s94, s94, s95
    s_add_u32 s94, s94, s90
    s_lshl_b32 s94, s94, 2
    s_add_u32 s94, s94, 91226112
    s_cmp_lg_u32 s3, 0
    s_cselect_b32 s94, 0x10000000, s94
    s_cmp_ge_u32 s91, 48
    s_cselect_b32 s94, 0x10000000, s94
    s_mov_b32 s89, s90
    v_and_b32 v1, 63, v0
    s_lshl_b32 s52, s91, 2
    s_add_u32 s52, s52, s3
    s_lshr_b32 s57, s91, 4
    s_and_b32 s52, s52, 63
    s_lshl_b32 s54, s52, 7
    s_cmp_eq_u32 s57, 1
    s_cbranch_scc1 LpK_26
    s_cmp_eq_u32 s57, 2
    s_cbranch_scc1 LpV_27
    s_cmp_eq_u32 s57, 3
    s_cbranch_scc1 LpH_28
LpQ_25:
    s_mov_b32 s36, s8
    s_and_b32 s37, s9, 0xffff
    s_mov_b32 s38, 0x500000
    s_mov_b32 s39, 0x00020000
    s_mov_b32 s53, 8192
    s_mov_b32 s55, 0x400000
    s_mov_b32 s56, 262144
    s_branch LpW_29
LpK_26:
    s_mov_b32 s36, s10
    s_and_b32 s37, s11, 0xffff
    s_mov_b32 s38, 0x500000
    s_mov_b32 s39, 0x00020000
    s_mov_b32 s53, 8192
    s_mov_b32 s55, 0x1400000
    s_mov_b32 s56, 262144
    s_branch LpW_29
LpV_27:
    s_mov_b32 s36, s12
    s_and_b32 s37, s13, 0xffff
    s_mov_b32 s38, 0x500000
    s_mov_b32 s39, 0x00020000
    s_mov_b32 s53, 8192
    s_mov_b32 s55, 0x2400000
    s_mov_b32 s56, 262144
    s_branch LpW_29
LpH_28:
    s_cmp_lg_u32 s3, 0
    s_cbranch_scc1 Lpv_31
    s_sub_u32 s64, s101, 144
    s_lshl_b32 s64, s64, 15
    s_add_u32 s64, s64, 92280832
    s_add_u32 s65, s64, 8192
    s_mov_b64 exec, 0xff
    v_lshlrev_b32 v10, 7, v1
    v_mov_b32 v8, 1
    buffer_store_dword v8, v10, s[32:35], s64 offen sc1
    buffer_store_dword v8, v10, s[32:35], s65 offen sc1
    s_mov_b64 exec, 1
    s_mov_b32 s66, -1
    s_mov_b32 s67, -1
    v_mov_b32 v9, 0
    s_mov_b32 s98, 0
    s_waitcnt vmcnt(0)
    buffer_load_dword v9, off, s[32:35], s64 offset:0 sc1
Lpl_32:
    v_readfirstlane_b32 s99, v9
    s_add_u32 s98, s98, 1
    s_lshr_b32 vcc_lo, s98, 10
    s_or_b32 s99, s99, vcc_lo
    s_cbranch_scc0 Lpl_32
    s_min_u32 s66, s66, s98
    v_mov_b32 v9, 0
    s_mov_b32 s98, 0
    s_waitcnt vmcnt(0)
    buffer_load_dword v9, off, s[32:35], s65 offset:0 sc1
Lpl_33:
    v_readfirstlane_b32 s99, v9
    s_add_u32 s98, s98, 1
    s_lshr_b32 vcc_lo, s98, 10
    s_or_b32 s99, s99, vcc_lo
    s_cbranch_scc0 Lpl_33
    s_min_u32 s67, s67, s98
    v_mov_b32 v9, 0
    s_mov_b32 s98, 0
    s_waitcnt vmcnt(0)
    buffer_load_dword v9, off, s[32:35], s64 offset:128 sc1
Lpl_34:
    v_readfirstlane_b32 s99, v9
    s_add_u32 s98, s98, 1
    s_lshr_b32 vcc_lo, s98, 10
    s_or_b32 s99, s99, vcc_lo
    s_cbranch_scc0 Lpl_34
    s_min_u32 s66, s66, s98
    v_mov_b32 v9, 0
    s_mov_b32 s98, 0
    s_waitcnt vmcnt(0)
    buffer_load_dword v9, off, s[32:35], s65 offset:128 sc1
Lpl_35:
    v_readfirstlane_b32 s99, v9
    s_add_u32 s98, s98, 1
    s_lshr_b32 vcc_lo, s98, 10
    s_or_b32 s99, s99, vcc_lo
    s_cbranch_scc0 Lpl_35
    s_min_u32 s67, s67, s98
    v_mov_b32 v9, 0
    s_mov_b32 s98, 0
    s_waitcnt vmcnt(0)
    buffer_load_dword v9, off, s[32:35], s64 offset:256 sc1
Lpl_36:
    v_readfirstlane_b32 s99, v9
    s_add_u32 s98, s98, 1
    s_lshr_b32 vcc_lo, s98, 10
    s_or_b32 s99, s99, vcc_lo
    s_cbranch_scc0 Lpl_36
    s_min_u32 s66, s66, s98
    v_mov_b32 v9, 0
    s_mov_b32 s98, 0
    s_waitcnt vmcnt(0)
    buffer_load_dword v9, off, s[32:35], s65 offset:256 sc1
Lpl_37:
    v_readfirstlane_b32 s99, v9
    s_add_u32 s98, s98, 1
    s_lshr_b32 vcc_lo, s98, 10
    s_or_b32 s99, s99, vcc_lo
    s_cbranch_scc0 Lpl_37
    s_min_u32 s67, s67, s98
    v_mov_b32 v9, 0
    s_mov_b32 s98, 0
    s_waitcnt vmcnt(0)
    buffer_load_dword v9, off, s[32:35], s64 offset:384 sc1
Lpl_38:
    v_readfirstlane_b32 s99, v9
    s_add_u32 s98, s98, 1
    s_lshr_b32 vcc_lo, s98, 10
    s_or_b32 s99, s99, vcc_lo
    s_cbranch_scc0 Lpl_38
    s_min_u32 s66, s66, s98
    v_mov_b32 v9, 0
    s_mov_b32 s98, 0
    s_waitcnt vmcnt(0)
    buffer_load_dword v9, off, s[32:35], s65 offset:384 sc1
Lpl_39:
    v_readfirstlane_b32 s99, v9
    s_add_u32 s98, s98, 1
    s_lshr_b32 vcc_lo, s98, 10
    s_or_b32 s99, s99, vcc_lo
    s_cbranch_scc0 Lpl_39
    s_min_u32 s67, s67, s98
    s_sub_u32 s66, 2048, s66
    s_sub_u32 s67, 2048, s67
    v_mov_b32 v8, s66
    v_mov_b32 v9, s67
    buffer_atomic_umax v8, off, s[44:47], 0 offset:240 sc1
    buffer_atomic_umax v9, off, s[44:47], 0 offset:244 sc1
    s_barrier
    v_mov_b32 v11, 1
    s_waitcnt vmcnt(0)
    buffer_atomic_add v11, off, s[44:47], 0 offset:136 sc1
    s_mov_b64 exec, -1
    s_branch Lpv_31b
Lpv_31:
    s_barrier
Lpv_31b:
    s_mov_b32 s36, s14
    s_and_b32 s37, s15, 0xffff
    s_mov_b32 s38, 0x500000
    s_mov_b32 s39, 0x00020000
    s_sub_u32 s64, s101, 144
    s_lshl_b32 s64, s64, 2
    s_add_u32 s64, s64, s3
    s_lshl_b32 s64, s64, 13
    v_lshlrev_b32 v10, 7, v1
    buffer_load_dword v9, v10, s[36:39], s64 offen
    s_add_u32 s64, s64, 688128
    buffer_load_dword v9, v10, s[36:39], s64 offen
    s_add_u32 s64, s64, 688128
    buffer_load_dword v9, v10, s[36:39], s64 offen
    s_add_u32 s64, s64, 688128
    buffer_load_dword v9, v10, s[36:39], s64 offen
    s_add_u32 s64, s64, 688128
    buffer_load_dword v9, v10, s[36:39], s64 offen
    s_add_u32 s64, s64, 688128
    buffer_load_dword v9, v10, s[36:39], s64 offen
    s_add_u32 s64, s64, 688128
    buffer_load_dword v9, v10, s[36:39], s64 offen
    s_add_u32 s64, s64, 688128
    buffer_load_dword v9, v10, s[36:39], s64 offen
    s_add_u32 s64, s64, 688128
    s_waitcnt vmcnt(0)
    s_mov_b32 s40, s22
    s_and_b32 s41, s23, 0xffff
    s_mov_b32 s42, 0xd80
    s_mov_b32 s43, 0x00020000
    v_lshrrev_b32 v2, 5, v1
    v_lshlrev_b32 v2, 3, v2
    s_lshl_b32 s58, s52, 7
    buffer_load_dwordx2 v[64:65], v2, s[40:43], s58 offen offset:0
    buffer_load_dwordx2 v[66:67], v2, s[40:43], s58 offen offset:16
    buffer_load_dwordx2 v[68:69], v2, s[40:43], s58 offen offset:32
    buffer_load_dwordx2 v[70:71], v2, s[40:43], s58 offen offset:48
    buffer_load_dwordx2 v[72:73], v2, s[40:43], s58 offen offset:64
    buffer_load_dwordx2 v[74:75], v2, s[40:43], s58 offen offset:80
    buffer_load_dwordx2 v[76:77], v2, s[40:43], s58 offen offset:96
    buffer_load_dwordx2 v[78:79], v2, s[40:43], s58 offen offset:112
    s_waitcnt vmcnt(7)
    v_lshlrev_b32 v32, 16, v64
    v_and_b32 v33, 0xffff0000, v64
    v_lshlrev_b32 v34, 16, v65
    v_and_b32 v35, 0xffff0000, v65
    s_waitcnt vmcnt(6)
    v_lshlrev_b32 v36, 16, v66
    v_and_b32 v37, 0xffff0000, v66
    v_lshlrev_b32 v38, 16, v67
    v_and_b32 v39, 0xffff0000, v67
    s_waitcnt vmcnt(5)
    v_lshlrev_b32 v40, 16, v68
    v_and_b32 v41, 0xffff0000, v68
    v_lshlrev_b32 v42, 16, v69
    v_and_b32 v43, 0xffff0000, v69
    s_waitcnt vmcnt(4)
    v_lshlrev_b32 v44, 16, v70
    v_and_b32 v45, 0xffff0000, v70
    v_lshlrev_b32 v46, 16, v71
    v_and_b32 v47, 0xffff0000, v71
    s_waitcnt vmcnt(3)
    v_lshlrev_b32 v48, 16, v72
    v_and_b32 v49, 0xffff0000, v72
    v_lshlrev_b32 v50, 16, v73
    v_and_b32 v51, 0xffff0000, v73
    s_waitcnt vmcnt(2)
    v_lshlrev_b32 v52, 16, v74
    v_and_b32 v53, 0xffff0000, v74
    v_lshlrev_b32 v54, 16, v75
    v_and_b32 v55, 0xffff0000, v75
    s_waitcnt vmcnt(1)
    v_lshlrev_b32 v56, 16, v76
    v_and_b32 v57, 0xffff0000, v76
    v_lshlrev_b32 v58, 16, v77
    v_and_b32 v59, 0xffff0000, v77
    s_waitcnt vmcnt(0)
    v_lshlrev_b32 v60, 16, v78
    v_and_b32 v61, 0xffff0000, v78
    v_lshlrev_b32 v62, 16, v79
    v_and_b32 v63, 0xffff0000, v79
    s_mov_b32 s36, s20
    s_and_b32 s37, s21, 0xffff
    s_mov_b32 s38, 0x21c000
    s_mov_b32 s39, 0x00020000
    s_mov_b32 s53, 3456
    s_mov_b32 s56, 110592
    s_mov_b32 s55, 0x4400000
    s_cmp_eq_u32 s52, 27
    s_cselect_b32 s55, 0x10000000, s55
LpW_29:
    s_lshl_b32 s58, s52, 12
    s_add_u32 s55, s55, s58
    v_lshrrev_b32 v2, 3, v1
    v_mul_lo_u32 v2, v2, s53
    v_and_b32 v3, 7, v1
    v_lshl_add_u32 v2, v3, 4, v2
    v_lshrrev_b32 v3, 5, v1
    v_lshlrev_b32 v3, 10, v3
    v_bfe_u32 v4, v1, 2, 2
    v_lshl_add_u32 v3, v4, 7, v3
    v_bfe_u32 v4, v1, 4, 1
    v_lshl_add_u32 v3, v4, 5, v3
    v_and_b32 v4, 3, v1
    v_lshl_add_u32 v3, v4, 3, v3
    s_mul_i32 s58, s3, 40960
    v_add_u32 v3, s58, v3
    s_lshl_b32 s59, s53, 3
    s_mov_b32 s60, s54
    s_add_u32 s60, s89, 0
    s_and_b32 s60, s60, 3
    s_mul_i32 s60, s60, 20
    s_mul_i32 s60, s60, s59
    s_add_u32 s60, s60, s54
    s_add_u32 m0, s58, 0
    s_nop 0
    buffer_load_dwordx4 v2, s[36:39], s60 offen lds
    s_add_u32 s60, s60, s59
    s_add_u32 m0, s58, 1024
    s_nop 0
    buffer_load_dwordx4 v2, s[36:39], s60 offen lds
    s_add_u32 s60, s60, s59
    s_add_u32 m0, s58, 2048
    s_nop 0
    buffer_load_dwordx4 v2, s[36:39], s60 offen lds
    s_add_u32 s60, s60, s59
    s_add_u32 m0, s58, 3072
    s_nop 0
    buffer_load_dwordx4 v2, s[36:39], s60 offen lds
    s_add_u32 s60, s60, s59
    s_add_u32 m0, s58, 4096
    s_nop 0
    buffer_load_dwordx4 v2, s[36:39], s60 offen lds
    s_add_u32 s60, s60, s59
    s_add_u32 m0, s58, 5120
    s_nop 0
    buffer_load_dwordx4 v2, s[36:39], s60 offen lds
    s_add_u32 s60, s60, s59
    s_add_u32 m0, s58, 6144
    s_nop 0
    buffer_load_dwordx4 v2, s[36:39], s60 offen lds
    s_add_u32 s60, s60, s59
    s_add_u32 m0, s58, 7168
    s_nop 0
    buffer_load_dwordx4 v2, s[36:39], s60 offen lds
    s_add_u32 s60, s60, s59
    s_add_u32 m0, s58, 8192
    s_nop 0
    buffer_load_dwordx4 v2, s[36:39], s60 offen lds
    s_add_u32 s60, s60, s59
    s_add_u32 m0, s58, 9216
    s_nop 0
    buffer_load_dwordx4 v2, s[36:39], s60 offen lds
    s_add_u32 s60, s60, s59
    s_add_u32 m0, s58, 10240
    s_nop 0
    buffer_load_dwordx4 v2, s[36:39], s60 offen lds
    s_add_u32 s60, s60, s59
    s_add_u32 m0, s58, 11264
    s_nop 0
    buffer_load_dwordx4 v2, s[36:39], s60 offen lds
    s_add_u32 s60, s60, s59
    s_add_u32 m0, s58, 12288
    s_nop 0
    buffer_load_dwordx4 v2, s[36:39], s60 offen lds
    s_add_u32 s60, s60, s59
    s_add_u32 m0, s58, 13312
    s_nop 0
    buffer_load_dwordx4 v2, s[36:39], s60 offen lds
    s_add_u32 s60, s60, s59
    s_add_u32 m0, s58, 14336
    s_nop 0
    buffer_load_dwordx4 v2, s[36:39], s60 offen lds
    s_add_u32 s60, s60, s59
    s_add_u32 m0, s58, 15360
    s_nop 0
    buffer_load_dwordx4 v2, s[36:39], s60 offen lds
    s_add_u32 s60, s60, s59
    s_add_u32 m0, s58, 16384
    s_nop 0
    buffer_load_dwordx4 v2, s[36:39], s60 offen lds
    s_add_u32 s60, s60, s59
    s_add_u32 m0, s58, 17408
    s_nop 0
    buffer_load_dwordx4 v2, s[36:39], s60 offen lds
    s_add_u32 s60, s60, s59
    s_add_u32 m0, s58, 18432
    s_nop 0
    buffer_load_dwordx4 v2, s[36:39], s60 offen lds
    s_add_u32 s60, s60, s59
    s_add_u32 m0, s58, 19456
    s_nop 0
    buffer_load_dwordx4 v2, s[36:39], s60 offen lds
    s_add_u32 s60, s60, s59
    s_add_u32 s60, s89, 1
    s_and_b32 s60, s60, 3
    s_mul_i32 s60, s60, 20
    s_mul_i32 s60, s60, s59
    s_add_u32 s60, s60, s54
    s_add_u32 m0, s58, 20480
    s_nop 0
    buffer_load_dwordx4 v2, s[36:39], s60 offen lds
    s_add_u32 s60, s60, s59
    s_add_u32 m0, s58, 21504
    s_nop 0
    buffer_load_dwordx4 v2, s[36:39], s60 offen lds
    s_add_u32 s60, s60, s59
    s_add_u32 m0, s58, 22528
    s_nop 0
    buffer_load_dwordx4 v2, s[36:39], s60 offen lds
    s_add_u32 s60, s60, s59
    s_add_u32 m0, s58, 23552
    s_nop 0
    buffer_load_dwordx4 v2, s[36:39], s60 offen lds
    s_add_u32 s60, s60, s59
    s_add_u32 m0, s58, 24576
    s_nop 0
    buffer_load_dwordx4 v2, s[36:39], s60 offen lds
    s_add_u32 s60, s60, s59
    s_add_u32 m0, s58, 25600
    s_nop 0
    buffer_load_dwordx4 v2, s[36:39], s60 offen lds
    s_add_u32 s60, s60, s59
    s_add_u32 m0, s58, 26624
    s_nop 0
    buffer_load_dwordx4 v2, s[36:39], s60 offen lds
    s_add_u32 s60, s60, s59
    s_add_u32 m0, s58, 27648
    s_nop 0
    buffer_load_dwordx4 v2, s[36:39], s60 offen lds
    s_add_u32 s60, s60, s59
    s_add_u32 m0, s58, 28672
    s_nop 0
    buffer_load_dwordx4 v2, s[36:39], s60 offen lds
    s_add_u32 s60, s60, s59
    s_add_u32 m0, s58, 29696
    s_nop 0
    buffer_load_dwordx4 v2, s[36:39], s60 offen lds
    s_add_u32 s60, s60, s59
    s_add_u32 m0, s58, 30720
    s_nop 0
    buffer_load_dwordx4 v2, s[36:39], s60 offen lds
    s_add_u32 s60, s60, s59
    s_add_u32 m0, s58, 31744
    s_nop 0
    buffer_load_dwordx4 v2, s[36:39], s60 offen lds
    s_add_u32 s60, s60, s59
    s_add_u32 m0, s58, 32768
    s_nop 0
    buffer_load_dwordx4 v2, s[36:39], s60 offen lds
    s_add_u32 s60, s60, s59
    s_add_u32 m0, s58, 33792
    s_nop 0
    buffer_load_dwordx4 v2, s[36:39], s60 offen lds
    s_add_u32 s60, s60, s59
    s_add_u32 m0, s58, 34816
    s_nop 0
    buffer_load_dwordx4 v2, s[36:39], s60 offen lds
    s_add_u32 s60, s60, s59
    s_add_u32 m0, s58, 35840
    s_nop 0
    buffer_load_dwordx4 v2, s[36:39], s60 offen lds
    s_add_u32 s60, s60, s59
    s_add_u32 m0, s58, 36864
    s_nop 0
    buffer_load_dwordx4 v2, s[36:39], s60 offen lds
    s_add_u32 s60, s60, s59
    s_add_u32 m0, s58, 37888
    s_nop 0
    buffer_load_dwordx4 v2, s[36:39], s60 offen lds
    s_add_u32 s60, s60, s59
    s_add_u32 m0, s58, 38912
    s_nop 0
    buffer_load_dwordx4 v2, s[36:39], s60 offen lds
    s_add_u32 s60, s60, s59
    s_add_u32 m0, s58, 39936
    s_nop 0
    buffer_load_dwordx4 v2, s[36:39], s60 offen lds
    s_add_u32 s60, s60, s59
    s_waitcnt vmcnt(38)
    ds_read_b64_tr_b16 a[0:1], v3 offset:0
    ds_read_b64_tr_b16 a[2:3], v3 offset:512
    ds_read_b64_tr_b16 a[4:5], v3 offset:64
    ds_read_b64_tr_b16 a[6:7], v3 offset:576
    s_waitcnt lgkmcnt(0)
    s_add_u32 s60, s89, 2
    s_and_b32 s60, s60, 3
    s_mul_i32 s60, s60, 20
    s_mul_i32 s60, s60, s59
    s_add_u32 s60, s60, s54
    s_add_u32 m0, s58, 0
    s_nop 0
    buffer_load_dwordx4 v2, s[36:39], s60 offen lds
    s_add_u32 s60, s60, s59
    s_add_u32 m0, s58, 1024
    s_nop 0
    buffer_load_dwordx4 v2, s[36:39], s60 offen lds
    s_add_u32 s60, s60, s59
    s_waitcnt vmcnt(38)
    ds_read_b64_tr_b16 a[8:9], v3 offset:2048
    ds_read_b64_tr_b16 a[10:11], v3 offset:2560
    ds_read_b64_tr_b16 a[12:13], v3 offset:2112
    ds_read_b64_tr_b16 a[14:15], v3 offset:2624
    s_waitcnt lgkmcnt(0)
    s_add_u32 m0, s58, 2048
    s_nop 0
    buffer_load_dwordx4 v2, s[36:39], s60 offen lds
    s_add_u32 s60, s60, s59
    s_add_u32 m0, s58, 3072
    s_nop 0
    buffer_load_dwordx4 v2, s[36:39], s60 offen lds
    s_add_u32 s60, s60, s59
    s_waitcnt vmcnt(38)
    ds_read_b64_tr_b16 a[16:17], v3 offset:4096
    ds_read_b64_tr_b16 a[18:19], v3 offset:4608
    ds_read_b64_tr_b16 a[20:21], v3 offset:4160
    ds_read_b64_tr_b16 a[22:23], v3 offset:4672
    s_waitcnt lgkmcnt(0)
    s_add_u32 m0, s58, 4096
    s_nop 0
    buffer_load_dwordx4 v2, s[36:39], s60 offen lds
    s_add_u32 s60, s60, s59
    s_add_u32 m0, s58, 5120
    s_nop 0
    buffer_load_dwordx4 v2, s[36:39], s60 offen lds
    s_add_u32 s60, s60, s59
    s_waitcnt vmcnt(38)
    ds_read_b64_tr_b16 a[24:25], v3 offset:6144
    ds_read_b64_tr_b16 a[26:27], v3 offset:6656
    ds_read_b64_tr_b16 a[28:29], v3 offset:6208
    ds_read_b64_tr_b16 a[30:31], v3 offset:6720
    s_waitcnt lgkmcnt(0)
    s_add_u32 m0, s58, 6144
    s_nop 0
    buffer_load_dwordx4 v2, s[36:39], s60 offen lds
    s_add_u32 s60, s60, s59
    s_add_u32 m0, s58, 7168
    s_nop 0
    buffer_load_dwordx4 v2, s[36:39], s60 offen lds
    s_add_u32 s60, s60, s59
    s_waitcnt vmcnt(38)
    ds_read_b64_tr_b16 a[32:33], v3 offset:8192
    ds_read_b64_tr_b16 a[34:35], v3 offset:8704
    ds_read_b64_tr_b16 a[36:37], v3 offset:8256
    ds_read_b64_tr_b16 a[38:39], v3 offset:8768
    s_waitcnt lgkmcnt(0)
    s_add_u32 m0, s58, 8192
    s_nop 0
    buffer_load_dwordx4 v2, s[36:39], s60 offen lds
    s_add_u32 s60, s60, s59
    s_add_u32 m0, s58, 9216
    s_nop 0
    buffer_load_dwordx4 v2, s[36:39], s60 offen lds
    s_add_u32 s60, s60, s59
    s_waitcnt vmcnt(38)
    ds_read_b64_tr_b16 a[40:41], v3 offset:10240
    ds_read_b64_tr_b16 a[42:43], v3 offset:10752
    ds_read_b64_tr_b16 a[44:45], v3 offset:10304
    ds_read_b64_tr_b16 a[46:47], v3 offset:10816
    s_waitcnt lgkmcnt(0)
    s_add_u32 m0, s58, 10240
    s_nop 0
    buffer_load_dwordx4 v2, s[36:39], s60 offen lds
    s_add_u32 s60, s60, s59
    s_add_u32 m0, s58, 11264
    s_nop 0
    buffer_load_dwordx4 v2, s[36:39], s60 offen lds
    s_add_u32 s60, s60, s59
    s_waitcnt vmcnt(38)
    ds_read_b64_tr_b16 a[48:49], v3 offset:12288
    ds_read_b64_tr_b16 a[50:51], v3 offset:12800
    ds_read_b64_tr_b16 a[52:53], v3 offset:12352
    ds_read_b64_tr_b16 a[54:55], v3 offset:12864
    s_waitcnt lgkmcnt(0)
    s_add_u32 m0, s58, 12288
    s_nop 0
    buffer_load_dwordx4 v2, s[36:39], s60 offen lds
    s_add_u32 s60, s60, s59
    s_add_u32 m0, s58, 13312
    s_nop 0
    buffer_load_dwordx4 v2, s[36:39], s60 offen lds
    s_add_u32 s60, s60, s59
    s_waitcnt vmcnt(38)
    ds_read_b64_tr_b16 a[56:57], v3 offset:14336
    ds_read_b64_tr_b16 a[58:59], v3 offset:14848
    ds_read_b64_tr_b16 a[60:61], v3 offset:14400
    ds_read_b64_tr_b16 a[62:63], v3 offset:14912
    s_waitcnt lgkmcnt(0)
    s_add_u32 m0, s58, 14336
    s_nop 0
    buffer_load_dwordx4 v2, s[36:39], s60 offen lds
    s_add_u32 s60, s60, s59
    s_add_u32 m0, s58, 15360
    s_nop 0
    buffer_load_dwordx4 v2, s[36:39], s60 offen lds
    s_add_u32 s60, s60, s59
    s_waitcnt vmcnt(38)
    ds_read_b64_tr_b16 a[64:65], v3 offset:16384
    ds_read_b64_tr_b16 a[66:67], v3 offset:16896
    ds_read_b64_tr_b16 a[68:69], v3 offset:16448
    ds_read_b64_tr_b16 a[70:71], v3 offset:16960
    s_waitcnt lgkmcnt(0)
    s_add_u32 m0, s58, 16384
    s_nop 0
    buffer_load_dwordx4 v2, s[36:39], s60 offen lds
    s_add_u32 s60, s60, s59
    s_add_u32 m0, s58, 17408
    s_nop 0
    buffer_load_dwordx4 v2, s[36:39], s60 offen lds
    s_add_u32 s60, s60, s59
    s_waitcnt vmcnt(38)
    ds_read_b64_tr_b16 a[72:73], v3 offset:18432
    ds_read_b64_tr_b16 a[74:75], v3 offset:18944
    ds_read_b64_tr_b16 a[76:77], v3 offset:18496
    ds_read_b64_tr_b16 a[78:79], v3 offset:19008
    s_waitcnt lgkmcnt(0)
    s_add_u32 m0, s58, 18432
    s_nop 0
    buffer_load_dwordx4 v2, s[36:39], s60 offen lds
    s_add_u32 s60, s60, s59
    s_add_u32 m0, s58, 19456
    s_nop 0
    buffer_load_dwordx4 v2, s[36:39], s60 offen lds
    s_add_u32 s60, s60, s59
    s_waitcnt vmcnt(38)
    ds_read_b64_tr_b16 a[80:81], v3 offset:20480
    ds_read_b64_tr_b16 a[82:83], v3 offset:20992
    ds_read_b64_tr_b16 a[84:85], v3 offset:20544
    ds_read_b64_tr_b16 a[86:87], v3 offset:21056
    s_waitcnt lgkmcnt(0)
    s_add_u32 s60, s89, 3
    s_and_b32 s60, s60, 3
    s_mul_i32 s60, s60, 20
    s_mul_i32 s60, s60, s59
    s_add_u32 s60, s60, s54
    s_add_u32 m0, s58, 20480
    s_nop 0
    buffer_load_dwordx4 v2, s[36:39], s60 offen lds
    s_add_u32 s60, s60, s59
    s_add_u32 m0, s58, 21504
    s_nop 0
    buffer_load_dwordx4 v2, s[36:39], s60 offen lds
    s_add_u32 s60, s60, s59
    s_waitcnt vmcnt(38)
    ds_read_b64_tr_b16 a[88:89], v3 offset:22528
    ds_read_b64_tr_b16 a[90:91], v3 offset:23040
    ds_read_b64_tr_b16 a[92:93], v3 offset:22592
    ds_read_b64_tr_b16 a[94:95], v3 offset:23104
    s_waitcnt lgkmcnt(0)
    s_add_u32 m0, s58, 22528
    s_nop 0
    buffer_load_dwordx4 v2, s[36:39], s60 offen lds
    s_add_u32 s60, s60, s59
    s_add_u32 m0, s58, 23552
    s_nop 0
    buffer_load_dwordx4 v2, s[36:39], s60 offen lds
    s_add_u32 s60, s60, s59
    s_waitcnt vmcnt(38)
    ds_read_b64_tr_b16 a[96:97], v3 offset:24576
    ds_read_b64_tr_b16 a[98:99], v3 offset:25088
    ds_read_b64_tr_b16 a[100:101], v3 offset:24640
    ds_read_b64_tr_b16 a[102:103], v3 offset:25152
    s_waitcnt lgkmcnt(0)
    s_add_u32 m0, s58, 24576
    s_nop 0
    buffer_load_dwordx4 v2, s[36:39], s60 offen lds
    s_add_u32 s60, s60, s59
    s_add_u32 m0, s58, 25600
    s_nop 0
    buffer_load_dwordx4 v2, s[36:39], s60 offen lds
    s_add_u32 s60, s60, s59
    s_waitcnt vmcnt(38)
    ds_read_b64_tr_b16 a[104:105], v3 offset:26624
    ds_read_b64_tr_b16 a[106:107], v3 offset:27136
    ds_read_b64_tr_b16 a[108:109], v3 offset:26688
    ds_read_b64_tr_b16 a[110:111], v3 offset:27200
    s_waitcnt lgkmcnt(0)
    s_add_u32 m0, s58, 26624
    s_nop 0
    buffer_load_dwordx4 v2, s[36:39], s60 offen lds
    s_add_u32 s60, s60, s59
    s_add_u32 m0, s58, 27648
    s_nop 0
    buffer_load_dwordx4 v2, s[36:39], s60 offen lds
    s_add_u32 s60, s60, s59
    s_waitcnt vmcnt(38)
    ds_read_b64_tr_b16 a[112:113], v3 offset:28672
    ds_read_b64_tr_b16 a[114:115], v3 offset:29184
    ds_read_b64_tr_b16 a[116:117], v3 offset:28736
    ds_read_b64_tr_b16 a[118:119], v3 offset:29248
    s_waitcnt lgkmcnt(0)
    s_add_u32 m0, s58, 28672
    s_nop 0
    buffer_load_dwordx4 v2, s[36:39], s60 offen lds
    s_add_u32 s60, s60, s59
    s_add_u32 m0, s58, 29696
    s_nop 0
    buffer_load_dwordx4 v2, s[36:39], s60 offen lds
    s_add_u32 s60, s60, s59
    s_waitcnt vmcnt(38)
    ds_read_b64_tr_b16 a[120:121], v3 offset:30720
    ds_read_b64_tr_b16 a[122:123], v3 offset:31232
    ds_read_b64_tr_b16 a[124:125], v3 offset:30784
    ds_read_b64_tr_b16 a[126:127], v3 offset:31296
    s_waitcnt lgkmcnt(0)
    s_add_u32 m0, s58, 30720
    s_nop 0
    buffer_load_dwordx4 v2, s[36:39], s60 offen lds
    s_add_u32 s60, s60, s59
    s_add_u32 m0, s58, 31744
    s_nop 0
    buffer_load_dwordx4 v2, s[36:39], s60 offen lds
    s_add_u32 s60, s60, s59
    s_waitcnt vmcnt(38)
    ds_read_b64_tr_b16 a[128:129], v3 offset:32768
    ds_read_b64_tr_b16 a[130:131], v3 offset:33280
    ds_read_b64_tr_b16 a[132:133], v3 offset:32832
    ds_read_b64_tr_b16 a[134:135], v3 offset:33344
    s_waitcnt lgkmcnt(0)
    s_add_u32 m0, s58, 32768
    s_nop 0
    buffer_load_dwordx4 v2, s[36:39], s60 offen lds
    s_add_u32 s60, s60, s59
    s_add_u32 m0, s58, 33792
    s_nop 0
    buffer_load_dwordx4 v2, s[36:39], s60 offen lds
    s_add_u32 s60, s60, s59
    s_waitcnt vmcnt(38)
    ds_read_b64_tr_b16 a[136:137], v3 offset:34816
    ds_read_b64_tr_b16 a[138:139], v3 offset:35328
    ds_read_b64_tr_b16 a[140:141], v3 offset:34880
    ds_read_b64_tr_b16 a[142:143], v3 offset:35392
    s_waitcnt lgkmcnt(0)
    s_add_u32 m0, s58, 34816
    s_nop 0
    buffer_load_dwordx4 v2, s[36:39], s60 offen lds
    s_add_u32 s60, s60, s59
    s_add_u32 m0, s58, 35840
    s_nop 0
    buffer_load_dwordx4 v2, s[36:39], s60 offen lds
    s_add_u32 s60, s60, s59
    s_waitcnt vmcnt(38)
    ds_read_b64_tr_b16 a[144:145], v3 offset:36864
    ds_read_b64_tr_b16 a[146:147], v3 offset:37376
    ds_read_b64_tr_b16 a[148:149], v3 offset:36928
    ds_read_b64_tr_b16 a[150:151], v3 offset:37440
    s_waitcnt lgkmcnt(0)
    s_add_u32 m0, s58, 36864
    s_nop 0
    buffer_load_dwordx4 v2, s[36:39], s60 offen lds
    s_add_u32 s60, s60, s59
    s_add_u32 m0, s58, 37888
    s_nop 0
    buffer_load_dwordx4 v2, s[36:39], s60 offen lds
    s_add_u32 s60, s60, s59
    s_waitcnt vmcnt(38)
    ds_read_b64_tr_b16 a[152:153], v3 offset:38912
    ds_read_b64_tr_b16 a[154:155], v3 offset:39424
    ds_read_b64_tr_b16 a[156:157], v3 offset:38976
    ds_read_b64_tr_b16 a[158:159], v3 offset:39488
    s_waitcnt lgkmcnt(0)
    s_add_u32 m0, s58, 38912
    s_nop 0
    buffer_load_dwordx4 v2, s[36:39], s60 offen lds
    s_add_u32 s60, s60, s59
    s_add_u32 m0, s58, 39936
    s_nop 0
    buffer_load_dwordx4 v2, s[36:39], s60 offen lds
    s_add_u32 s60, s60, s59
    s_waitcnt vmcnt(38)
    ds_read_b64_tr_b16 a[160:161], v3 offset:0
    ds_read_b64_tr_b16 a[162:163], v3 offset:512
    ds_read_b64_tr_b16 a[164:165], v3 offset:64
    ds_read_b64_tr_b16 a[166:167], v3 offset:576
    s_waitcnt vmcnt(36)
    ds_read_b64_tr_b16 a[168:169], v3 offset:2048
    ds_read_b64_tr_b16 a[170:171], v3 offset:2560
    ds_read_b64_tr_b16 a[172:173], v3 offset:2112
    ds_read_b64_tr_b16 a[174:175], v3 offset:2624
    s_waitcnt vmcnt(34)
    ds_read_b64_tr_b16 a[176:177], v3 offset:4096
    ds_read_b64_tr_b16 a[178:179], v3 offset:4608
    ds_read_b64_tr_b16 a[180:181], v3 offset:4160
    ds_read_b64_tr_b16 a[182:183], v3 offset:4672
    s_waitcnt vmcnt(32)
    ds_read_b64_tr_b16 a[184:185], v3 offset:6144
    ds_read_b64_tr_b16 a[186:187], v3 offset:6656
    ds_read_b64_tr_b16 a[188:189], v3 offset:6208
    ds_read_b64_tr_b16 a[190:191], v3 offset:6720
    s_waitcnt vmcnt(30)
    ds_read_b64_tr_b16 a[192:193], v3 offset:8192
    ds_read_b64_tr_b16 a[194:195], v3 offset:8704
    ds_read_b64_tr_b16 a[196:197], v3 offset:8256
    ds_read_b64_tr_b16 a[198:199], v3 offset:8768
    s_waitcnt vmcnt(28)
    ds_read_b64_tr_b16 a[200:201], v3 offset:10240
    ds_read_b64_tr_b16 a[202:203], v3 offset:10752
    ds_read_b64_tr_b16 a[204:205], v3 offset:10304
    ds_read_b64_tr_b16 a[206:207], v3 offset:10816
    s_waitcnt vmcnt(26)
    ds_read_b64_tr_b16 a[208:209], v3 offset:12288
    ds_read_b64_tr_b16 a[210:211], v3 offset:12800
    ds_read_b64_tr_b16 a[212:213], v3 offset:12352
    ds_read_b64_tr_b16 a[214:215], v3 offset:12864
    s_waitcnt vmcnt(24)
    ds_read_b64_tr_b16 a[216:217], v3 offset:14336
    ds_read_b64_tr_b16 a[218:219], v3 offset:14848
    ds_read_b64_tr_b16 a[220:221], v3 offset:14400
    ds_read_b64_tr_b16 a[222:223], v3 offset:14912
    s_waitcnt vmcnt(22)
    ds_read_b64_tr_b16 a[224:225], v3 offset:16384
    ds_read_b64_tr_b16 a[226:227], v3 offset:16896
    ds_read_b64_tr_b16 a[228:229], v3 offset:16448
    ds_read_b64_tr_b16 a[230:231], v3 offset:16960
    s_waitcnt vmcnt(20)
    ds_read_b64_tr_b16 a[232:233], v3 offset:18432
    ds_read_b64_tr_b16 a[234:235], v3 offset:18944
    ds_read_b64_tr_b16 a[236:237], v3 offset:18496
    ds_read_b64_tr_b16 a[238:239], v3 offset:19008
    s_waitcnt vmcnt(18)
    ds_read_b64_tr_b16 a[240:241], v3 offset:20480
    ds_read_b64_tr_b16 a[242:243], v3 offset:20992
    ds_read_b64_tr_b16 a[244:245], v3 offset:20544
    ds_read_b64_tr_b16 a[246:247], v3 offset:21056
    s_waitcnt vmcnt(16)
    ds_read_b64_tr_b16 a[248:249], v3 offset:22528
    ds_read_b64_tr_b16 a[250:251], v3 offset:23040
    ds_read_b64_tr_b16 a[252:253], v3 offset:22592
    ds_read_b64_tr_b16 a[254:255], v3 offset:23104
    s_waitcnt vmcnt(14)
    ds_read_b64_tr_b16 v[192:193], v3 offset:24576
    ds_read_b64_tr_b16 v[194:195], v3 offset:25088
    ds_read_b64_tr_b16 v[196:197], v3 offset:24640
    ds_read_b64_tr_b16 v[198:199], v3 offset:25152
    s_waitcnt vmcnt(12)
    ds_read_b64_tr_b16 v[200:201], v3 offset:26624
    ds_read_b64_tr_b16 v[202:203], v3 offset:27136
    ds_read_b64_tr_b16 v[204:205], v3 offset:26688
    ds_read_b64_tr_b16 v[206:207], v3 offset:27200
    s_waitcnt vmcnt(10)
    ds_read_b64_tr_b16 v[208:209], v3 offset:28672
    ds_read_b64_tr_b16 v[210:211], v3 offset:29184
    ds_read_b64_tr_b16 v[212:213], v3 offset:28736
    ds_read_b64_tr_b16 v[214:215], v3 offset:29248
    s_waitcnt vmcnt(8)
    ds_read_b64_tr_b16 v[216:217], v3 offset:30720
    ds_read_b64_tr_b16 v[218:219], v3 offset:31232
    ds_read_b64_tr_b16 v[220:221], v3 offset:30784
    ds_read_b64_tr_b16 v[222:223], v3 offset:31296
    s_waitcnt vmcnt(6)
    ds_read_b64_tr_b16 v[224:225], v3 offset:32768
    ds_read_b64_tr_b16 v[226:227], v3 offset:33280
    ds_read_b64_tr_b16 v[228:229], v3 offset:32832
    ds_read_b64_tr_b16 v[230:231], v3 offset:33344
    s_waitcnt vmcnt(4)
    ds_read_b64_tr_b16 v[232:233], v3 offset:34816
    ds_read_b64_tr_b16 v[234:235], v3 offset:35328
    ds_read_b64_tr_b16 v[236:237], v3 offset:34880
    ds_read_b64_tr_b16 v[238:239], v3 offset:35392
    s_waitcnt vmcnt(2)
    ds_read_b64_tr_b16 v[240:241], v3 offset:36864
    ds_read_b64_tr_b16 v[242:243], v3 offset:37376
    ds_read_b64_tr_b16 v[244:245], v3 offset:36928
    ds_read_b64_tr_b16 v[246:247], v3 offset:37440
    s_waitcnt vmcnt(0)
    ds_read_b64_tr_b16 v[248:249], v3 offset:38912
    ds_read_b64_tr_b16 v[250:251], v3 offset:39424
    ds_read_b64_tr_b16 v[252:253], v3 offset:38976
    ds_read_b64_tr_b16 v[254:255], v3 offset:39488
    s_waitcnt lgkmcnt(0)
    s_sub_u32 s96, s91, 16
    s_cmp_lt_u32 s96, 32
    s_cbranch_scc1 Lnp_40
    s_or_b32 s95, s101, s3
    s_cbranch_scc1 Lnc_41
Lc_42:
    s_sub_u32 s100, s100, 1
    s_cselect_b32 s100, 0, s100
    s_cbranch_scc1 Lck_43
    buffer_load_dword v7, off, s[44:47], 0 offset:32 sc1
    s_waitcnt vmcnt(0)
    v_readfirstlane_b32 s95, v7
    s_nop 0
    s_and_b32 s95, s95, 0xff
    s_cmp_ge_u32 s95, 27
    s_cbranch_scc1 Lck_43
    s_sleep 1
    s_branch Lc_42
Lck_43:
Lc_44:
    s_sub_u32 s100, s100, 1
    s_cselect_b32 s100, 0, s100
    s_cbranch_scc1 Lck_45
    buffer_load_dword v7, off, s[44:47], 0 offset:136 sc1
    s_waitcnt vmcnt(0)
    v_readfirstlane_b32 s96, v7
    s_nop 0
    s_and_b32 s95, s96, 0xff
    s_cmp_ge_u32 s95, 21
    s_cbranch_scc1 Lck_45
    s_sleep 1
    s_branch Lc_44
Lck_45:
    buffer_load_dwordx2 v[8:9], off, s[44:47], 0 offset:240 sc1
    s_waitcnt vmcnt(0)
    v_readfirstlane_b32 s95, v8
    v_readfirstlane_b32 s96, v9
    s_nop 0
    s_cmp_gt_u32 s95, s96
    s_cselect_b32 s96, 0x2001, 1
    v_and_b32 v10, 3, v1
    v_min_u32 v10, 2, v10
    v_lshlrev_b32 v10, 3, v10
    v_lshrrev_b32 v11, 2, v1
    v_lshl_add_u32 v10, v11, 7, v10
    s_mov_b32 s97, 0x5700000
Lc_46:
    s_sub_u32 s100, s100, 1
    s_cselect_b32 s100, 0, s100
    s_cbranch_scc1 Lck_47
    buffer_load_dwordx2 v[8:9], v10, s[32:35], s97 offen offset:12 sc1
    s_waitcnt vmcnt(0)
    v_min_u32 v8, v8, v9
    v_cmp_eq_u32 vcc, 0, v8
    s_nop 0
    s_cmp_eq_u64 vcc, 0
    s_cbranch_scc1 Lck_47
    s_sleep 1
    s_branch Lc_46
Lck_47:
    v_mov_b32 v7, s96
    buffer_store_dword v7, off, s[44:47], 0 offset:144 sc1
Lc_48:
    s_sub_u32 s100, s100, 1
    s_cselect_b32 s100, 0, s100
    s_cbranch_scc1 Lck_49
    buffer_load_dwordx2 v[8:9], v10, s[32:35], s97 offen offset:12 sc1
    buffer_load_dword v7, off, s[44:47], 0 offset:64 sc1
    s_waitcnt vmcnt(0)
    v_readfirstlane_b32 s95, v7
    s_nop 0
    s_cmp_ge_u32 s95, 64
    s_cbranch_scc1 Lck_49
    s_sleep 1
    s_branch Lc_48
Lck_49:
    v_min_u32 v8, v8, v9
    s_mov_b32 s96, 1
    v_cmp_gt_u32 vcc, 2, v8
    s_nop 0
    s_cmp_eq_u64 vcc, 0
    s_cselect_b32 s96, 2, s96
    v_cmp_gt_u32 vcc, 3, v8
    s_nop 0
    s_cmp_eq_u64 vcc, 0
    s_cselect_b32 s96, 3, s96
    v_cmp_gt_u32 vcc, 4, v8
    s_nop 0
    s_cmp_eq_u64 vcc, 0
    s_cselect_b32 s96, 4, s96
    v_mov_b32 v7, s96
    buffer_store_dword v7, off, s[44:47], 0 offset:140 sc1
Lnc_41:
    s_cmp_lg_u32 s3, 0
    s_cbranch_scc1 Lwkrl_51
Lwrl_50:
    s_sub_u32 s100, s100, 1
    s_cselect_b32 s100, 0, s100
    s_cbranch_scc1 Lwkrl_51
    buffer_load_dword v7, off, s[44:47], 0 offset:140 sc1
    s_waitcnt vmcnt(0)
    v_readfirstlane_b32 s95, v7
    s_nop 0
    s_cmp_lg_u32 s95, 0
    s_cbranch_scc1 Lwkrl_51
    s_sleep 24
    s_branch Lwrl_50
Lwkrl_51:
    s_waitcnt vmcnt(0)
Lnp_40:
    s_cmp_lg_u32 s3, 0
    s_cbranch_scc1 Lwkln_53
Lwln_52:
    s_sub_u32 s100, s100, 1
    s_cselect_b32 s100, 0, s100
    s_cbranch_scc1 Lwkln_53
    buffer_load_dword v7, off, s[44:47], 0 offset:32 sc1
    s_waitcnt vmcnt(0)
    v_readfirstlane_b32 s95, v7
    s_nop 0
    s_and_b32 s95, s95, 0xff
    s_cmp_ge_u32 s95, 27
    s_cbranch_scc1 Lwkln_53
    s_sleep 2
    s_branch Lwln_52
Lwkln_53:
    s_waitcnt vmcnt(0)
    s_cmp_eq_u32 s57, 2
    s_cbranch_scc1 LpmV_54
    s_cmp_eq_u32 s57, 3
    s_cbranch_scc1 LpmH_55
    v_lshlrev_b32 v5, 4, v1
    s_mul_i32 s67, s3, 10240
    s_add_u32 s69, s3, s89
    s_and_b32 s69, s69, 3
    s_mul_i32 s69, s69, 10240
    s_sub_u32 s65, s92, 1
    s_mul_i32 s64, s65, s93
    s_add_u32 s64, s64, s90
    s_barrier
    s_mov_b32 s61, s90
    s_mov_b32 s60, 0
    s_min_u32 s65, s61, s64
    s_mul_i32 s66, s65, 40960
    s_add_u32 s66, s66, s69
    s_add_u32 m0, s60, s67
    s_nop 0
    buffer_load_dwordx4 v5, s[32:35], s66 offen offset:0 sc1 lds
    buffer_load_dwordx4 v5, s[32:35], s66 offen offset:1024 sc1 lds
    buffer_load_dwordx4 v5, s[32:35], s66 offen offset:2048 sc1 lds
    buffer_load_dwordx4 v5, s[32:35], s66 offen offset:3072 sc1 lds
    s_add_u32 s66, s66, 4096
    s_add_u32 m0, m0, 4096
    s_nop 0
    buffer_load_dwordx4 v5, s[32:35], s66 offen offset:0 sc1 lds
    buffer_load_dwordx4 v5, s[32:35], s66 offen offset:1024 sc1 lds
    buffer_load_dwordx4 v5, s[32:35], s66 offen offset:2048 sc1 lds
    buffer_load_dwordx4 v5, s[32:35], s66 offen offset:3072 sc1 lds
    s_add_u32 s66, s66, 4096
    s_add_u32 m0, m0, 4096
    s_nop 0
    buffer_load_dwordx4 v5, s[32:35], s66 offen offset:0 sc1 lds
    buffer_load_dwordx4 v5, s[32:35], s66 offen offset:1024 sc1 lds
    s_add_u32 s61, s61, s93
    s_add_u32 s60, s60, 40960
    s_cmp_eq_u32 s60, 122880
    s_cselect_b32 s60, 0, s60
    s_min_u32 s65, s61, s64
    s_mul_i32 s66, s65, 40960
    s_add_u32 s66, s66, s69
    s_add_u32 m0, s60, s67
    s_nop 0
    buffer_load_dwordx4 v5, s[32:35], s66 offen offset:0 sc1 lds
    buffer_load_dwordx4 v5, s[32:35], s66 offen offset:1024 sc1 lds
    buffer_load_dwordx4 v5, s[32:35], s66 offen offset:2048 sc1 lds
    buffer_load_dwordx4 v5, s[32:35], s66 offen offset:3072 sc1 lds
    s_add_u32 s66, s66, 4096
    s_add_u32 m0, m0, 4096
    s_nop 0
    buffer_load_dwordx4 v5, s[32:35], s66 offen offset:0 sc1 lds
    buffer_load_dwordx4 v5, s[32:35], s66 offen offset:1024 sc1 lds
    buffer_load_dwordx4 v5, s[32:35], s66 offen offset:2048 sc1 lds
    buffer_load_dwordx4 v5, s[32:35], s66 offen offset:3072 sc1 lds
    s_add_u32 s66, s66, 4096
    s_add_u32 m0, m0, 4096
    s_nop 0
    buffer_load_dwordx4 v5, s[32:35], s66 offen offset:0 sc1 lds
    buffer_load_dwordx4 v5, s[32:35], s66 offen offset:1024 sc1 lds
    s_add_u32 s61, s61, s93
    s_add_u32 s60, s60, 40960
    s_cmp_eq_u32 s60, 122880
    s_cselect_b32 s60, 0, s60
    s_mov_b32 s58, 0
    s_mov_b32 s59, 0
    s_mov_b32 s62, 0x10000000
    s_mul_i32 s63, s90, s56
    s_add_u32 s63, s63, s55
    s_mul_i32 s68, s93, s56
    v_mov_b32 v6, v5
    s_waitcnt vmcnt(10)
    s_barrier
    ds_read_b128 v[104:107], v6 offset:0
    ds_read_b128 v[108:111], v6 offset:1024
    ds_read_b128 v[112:115], v6 offset:2048
    ds_read_b128 v[116:119], v6 offset:3072
    ds_read_b128 v[120:123], v6 offset:4096
Lprojq_56:
    s_waitcnt lgkmcnt(4)
    v_mfma_f32_32x32x16_bf16 v[128:143], a[0:3], v[104:107], 0
    v_mfma_f32_32x32x16_bf16 v[144:159], a[4:7], v[104:107], 0
    ds_read_b128 v[104:107], v6 offset:5120
    s_waitcnt lgkmcnt(4)
    v_mfma_f32_32x32x16_bf16 v[128:143], a[8:11], v[108:111], v[128:143]
    v_cvt_pk_bf16_f32 v64, v160, v161
    v_cvt_pk_bf16_f32 v65, v162, v163
    v_mfma_f32_32x32x16_bf16 v[144:159], a[12:15], v[108:111], v[144:159]
    ds_read_b128 v[108:111], v6 offset:6144
    v_cvt_pk_bf16_f32 v66, v164, v165
    v_cvt_pk_bf16_f32 v67, v166, v167
    s_waitcnt lgkmcnt(4)
    v_mfma_f32_32x32x16_bf16 v[128:143], a[16:19], v[112:115], v[128:143]
    v_mfma_f32_32x32x16_bf16 v[144:159], a[20:23], v[112:115], v[144:159]
    ds_read_b128 v[112:115], v6 offset:7168
    buffer_store_dwordx4 v[64:67], v5, s[32:35], s62 offen offset:0 sc1
    v_cvt_pk_bf16_f32 v68, v168, v169
    s_waitcnt lgkmcnt(4)
    v_mfma_f32_32x32x16_bf16 v[128:143], a[24:27], v[116:119], v[128:143]
    v_cvt_pk_bf16_f32 v69, v170, v171
    v_cvt_pk_bf16_f32 v70, v172, v173
    v_mfma_f32_32x32x16_bf16 v[144:159], a[28:31], v[116:119], v[144:159]
    ds_read_b128 v[116:119], v6 offset:8192
    v_cvt_pk_bf16_f32 v71, v174, v175
    s_waitcnt lgkmcnt(4)
    v_mfma_f32_32x32x16_bf16 v[128:143], a[32:35], v[120:123], v[128:143]
    buffer_store_dwordx4 v[68:71], v5, s[32:35], s62 offen offset:1024 sc1
    v_mfma_f32_32x32x16_bf16 v[144:159], a[36:39], v[120:123], v[144:159]
    ds_read_b128 v[120:123], v6 offset:9216
    v_cvt_pk_bf16_f32 v64, v176, v177
    v_cvt_pk_bf16_f32 v65, v178, v179
    s_waitcnt lgkmcnt(4)
    v_mfma_f32_32x32x16_bf16 v[128:143], a[40:43], v[104:107], v[128:143]
    v_cvt_pk_bf16_f32 v66, v180, v181
    v_cvt_pk_bf16_f32 v67, v182, v183
    v_mfma_f32_32x32x16_bf16 v[144:159], a[44:47], v[104:107], v[144:159]
    ds_read_b128 v[104:107], v6 offset:10240
    s_waitcnt lgkmcnt(4)
    v_mfma_f32_32x32x16_bf16 v[128:143], a[48:51], v[108:111], v[128:143]
    buffer_store_dwordx4 v[64:67], v5, s[32:35], s62 offen offset:2048 sc1
    v_cvt_pk_bf16_f32 v68, v184, v185
    v_mfma_f32_32x32x16_bf16 v[144:159], a[52:55], v[108:111], v[144:159]
    ds_read_b128 v[108:111], v6 offset:11264
    v_cvt_pk_bf16_f32 v69, v186, v187
    v_cvt_pk_bf16_f32 v70, v188, v189
    s_waitcnt lgkmcnt(4)
    v_mfma_f32_32x32x16_bf16 v[128:143], a[56:59], v[112:115], v[128:143]
    v_cvt_pk_bf16_f32 v71, v190, v191
    v_mfma_f32_32x32x16_bf16 v[144:159], a[60:63], v[112:115], v[144:159]
    ds_read_b128 v[112:115], v6 offset:12288
    buffer_store_dwordx4 v[68:71], v5, s[32:35], s62 offen offset:3072 sc1
    s_waitcnt lgkmcnt(4)
    v_mfma_f32_32x32x16_bf16 v[128:143], a[64:67], v[116:119], v[128:143]
    s_min_u32 s65, s61, s64
    s_mul_i32 s66, s65, 40960
    v_mfma_f32_32x32x16_bf16 v[144:159], a[68:71], v[116:119], v[144:159]
    ds_read_b128 v[116:119], v6 offset:13312
    s_add_u32 s66, s66, s69
    s_add_u32 m0, s60, s67
    s_waitcnt lgkmcnt(4)
    v_mfma_f32_32x32x16_bf16 v[128:143], a[72:75], v[120:123], v[128:143]
    v_mfma_f32_32x32x16_bf16 v[144:159], a[76:79], v[120:123], v[144:159]
    ds_read_b128 v[120:123], v6 offset:14336
    buffer_load_dwordx4 v5, s[32:35], s66 offen offset:0 sc1 lds
    s_waitcnt lgkmcnt(4)
    v_mfma_f32_32x32x16_bf16 v[128:143], a[80:83], v[104:107], v[128:143]
    buffer_load_dwordx4 v5, s[32:35], s66 offen offset:1024 sc1 lds
    v_mfma_f32_32x32x16_bf16 v[144:159], a[84:87], v[104:107], v[144:159]
    ds_read_b128 v[104:107], v6 offset:15360
    s_waitcnt lgkmcnt(4)
    v_mfma_f32_32x32x16_bf16 v[128:143], a[88:91], v[108:111], v[128:143]
    buffer_load_dwordx4 v5, s[32:35], s66 offen offset:2048 sc1 lds
    v_mfma_f32_32x32x16_bf16 v[144:159], a[92:95], v[108:111], v[144:159]
    ds_read_b128 v[108:111], v6 offset:16384
    buffer_load_dwordx4 v5, s[32:35], s66 offen offset:3072 sc1 lds
    s_waitcnt lgkmcnt(4)
    v_mfma_f32_32x32x16_bf16 v[128:143], a[96:99], v[112:115], v[128:143]
    s_add_u32 s66, s66, 4096
    s_add_u32 m0, m0, 4096
    v_mfma_f32_32x32x16_bf16 v[144:159], a[100:103], v[112:115], v[144:159]
    ds_read_b128 v[112:115], v6 offset:17408
    s_waitcnt lgkmcnt(4)
    v_mfma_f32_32x32x16_bf16 v[128:143], a[104:107], v[116:119], v[128:143]
    buffer_load_dwordx4 v5, s[32:35], s66 offen offset:0 sc1 lds
    v_mfma_f32_32x32x16_bf16 v[144:159], a[108:111], v[116:119], v[144:159]
    ds_read_b128 v[116:119], v6 offset:18432
    buffer_load_dwordx4 v5, s[32:35], s66 offen offset:1024 sc1 lds
    s_waitcnt lgkmcnt(4)
    v_mfma_f32_32x32x16_bf16 v[128:143], a[112:115], v[120:123], v[128:143]
    v_mfma_f32_32x32x16_bf16 v[144:159], a[116:119], v[120:123], v[144:159]
    ds_read_b128 v[120:123], v6 offset:19456
    buffer_load_dwordx4 v5, s[32:35], s66 offen offset:2048 sc1 lds
    s_waitcnt lgkmcnt(4)
    v_mfma_f32_32x32x16_bf16 v[128:143], a[120:123], v[104:107], v[128:143]
    buffer_load_dwordx4 v5, s[32:35], s66 offen offset:3072 sc1 lds
    v_mfma_f32_32x32x16_bf16 v[144:159], a[124:127], v[104:107], v[144:159]
    ds_read_b128 v[104:107], v6 offset:20480
    s_add_u32 s66, s66, 4096
    s_add_u32 m0, m0, 4096
    s_waitcnt lgkmcnt(4)
    v_mfma_f32_32x32x16_bf16 v[128:143], a[128:131], v[108:111], v[128:143]
    v_mfma_f32_32x32x16_bf16 v[144:159], a[132:135], v[108:111], v[144:159]
    ds_read_b128 v[108:111], v6 offset:21504
    buffer_load_dwordx4 v5, s[32:35], s66 offen offset:0 sc1 lds
    s_waitcnt lgkmcnt(4)
    v_mfma_f32_32x32x16_bf16 v[128:143], a[136:139], v[112:115], v[128:143]
    buffer_load_dwordx4 v5, s[32:35], s66 offen offset:1024 sc1 lds
    v_mfma_f32_32x32x16_bf16 v[144:159], a[140:143], v[112:115], v[144:159]
    ds_read_b128 v[112:115], v6 offset:22528
    s_add_u32 s61, s61, s93
    s_add_u32 s60, s60, 40960
    s_waitcnt lgkmcnt(4)
    v_mfma_f32_32x32x16_bf16 v[128:143], a[144:147], v[116:119], v[128:143]
    s_cmp_eq_u32 s60, 122880
    s_cselect_b32 s60, 0, s60
    v_mfma_f32_32x32x16_bf16 v[144:159], a[148:151], v[116:119], v[144:159]
    ds_read_b128 v[116:119], v6 offset:23552
    s_waitcnt lgkmcnt(4)
    v_mfma_f32_32x32x16_bf16 v[128:143], a[152:155], v[120:123], v[128:143]
    v_mfma_f32_32x32x16_bf16 v[144:159], a[156:159], v[120:123], v[144:159]
    ds_read_b128 v[120:123], v6 offset:24576
    s_waitcnt lgkmcnt(4)
    v_mfma_f32_32x32x16_bf16 v[128:143], a[160:163], v[104:107], v[128:143]
    v_mfma_f32_32x32x16_bf16 v[144:159], a[164:167], v[104:107], v[144:159]
    ds_read_b128 v[104:107], v6 offset:25600
    s_waitcnt lgkmcnt(4)
    v_mfma_f32_32x32x16_bf16 v[128:143], a[168:171], v[108:111], v[128:143]
    v_mfma_f32_32x32x16_bf16 v[144:159], a[172:175], v[108:111], v[144:159]
    ds_read_b128 v[108:111], v6 offset:26624
    s_waitcnt lgkmcnt(4)
    v_mfma_f32_32x32x16_bf16 v[128:143], a[176:179], v[112:115], v[128:143]
    v_mfma_f32_32x32x16_bf16 v[144:159], a[180:183], v[112:115], v[144:159]
    ds_read_b128 v[112:115], v6 offset:27648
    s_waitcnt lgkmcnt(4)
    v_mfma_f32_32x32x16_bf16 v[128:143], a[184:187], v[116:119], v[128:143]
    v_mfma_f32_32x32x16_bf16 v[144:159], a[188:191], v[116:119], v[144:159]
    ds_read_b128 v[116:119], v6 offset:28672
    s_waitcnt lgkmcnt(4)
    v_mfma_f32_32x32x16_bf16 v[128:143], a[192:195], v[120:123], v[128:143]
    v_mfma_f32_32x32x16_bf16 v[144:159], a[196:199], v[120:123], v[144:159]
    ds_read_b128 v[120:123], v6 offset:29696
    s_waitcnt lgkmcnt(4)
    v_mfma_f32_32x32x16_bf16 v[128:143], a[200:203], v[104:107], v[128:143]
    v_mfma_f32_32x32x16_bf16 v[144:159], a[204:207], v[104:107], v[144:159]
    ds_read_b128 v[104:107], v6 offset:30720
    s_waitcnt lgkmcnt(4)
    v_mfma_f32_32x32x16_bf16 v[128:143], a[208:211], v[108:111], v[128:143]
    v_mfma_f32_32x32x16_bf16 v[144:159], a[212:215], v[108:111], v[144:159]
    ds_read_b128 v[108:111], v6 offset:31744
    s_waitcnt lgkmcnt(4)
    v_mfma_f32_32x32x16_bf16 v[128:143], a[216:219], v[112:115], v[128:143]
    v_mfma_f32_32x32x16_bf16 v[144:159], a[220:223], v[112:115], v[144:159]
    ds_read_b128 v[112:115], v6 offset:32768
    s_waitcnt lgkmcnt(4)
    v_mfma_f32_32x32x16_bf16 v[128:143], a[224:227], v[116:119], v[128:143]
    v_mfma_f32_32x32x16_bf16 v[144:159], a[228:231], v[116:119], v[144:159]
    ds_read_b128 v[116:119], v6 offset:33792
    s_waitcnt lgkmcnt(4)
    v_mfma_f32_32x32x16_bf16 v[128:143], a[232:235], v[120:123], v[128:143]
    v_mfma_f32_32x32x16_bf16 v[144:159], a[236:239], v[120:123], v[144:159]
    ds_read_b128 v[120:123], v6 offset:34816
    s_waitcnt lgkmcnt(4)
    v_mfma_f32_32x32x16_bf16 v[128:143], a[240:243], v[104:107], v[128:143]
    v_mfma_f32_32x32x16_bf16 v[144:159], a[244:247], v[104:107], v[144:159]
    ds_read_b128 v[104:107], v6 offset:35840
    s_waitcnt lgkmcnt(4)
    v_mfma_f32_32x32x16_bf16 v[128:143], a[248:251], v[108:111], v[128:143]
    v_mfma_f32_32x32x16_bf16 v[144:159], a[252:255], v[108:111], v[144:159]
    ds_read_b128 v[108:111], v6 offset:36864
    s_waitcnt lgkmcnt(4)
    v_mfma_f32_32x32x16_bf16 v[128:143], v[192:195], v[112:115], v[128:143]
    v_mfma_f32_32x32x16_bf16 v[144:159], v[196:199], v[112:115], v[144:159]
    ds_read_b128 v[112:115], v6 offset:37888
    s_waitcnt lgkmcnt(4)
    v_mfma_f32_32x32x16_bf16 v[128:143], v[200:203], v[116:119], v[128:143]
    v_mfma_f32_32x32x16_bf16 v[144:159], v[204:207], v[116:119], v[144:159]
    ds_read_b128 v[116:119], v6 offset:38912
    s_waitcnt lgkmcnt(4)
    v_mfma_f32_32x32x16_bf16 v[128:143], v[208:211], v[120:123], v[128:143]
    v_mfma_f32_32x32x16_bf16 v[144:159], v[212:215], v[120:123], v[144:159]
    ds_read_b128 v[120:123], v6 offset:39936
    s_waitcnt lgkmcnt(4)
    v_mfma_f32_32x32x16_bf16 v[128:143], v[216:219], v[104:107], v[128:143]
    v_mfma_f32_32x32x16_bf16 v[144:159], v[220:223], v[104:107], v[144:159]
    s_waitcnt lgkmcnt(3)
    v_mfma_f32_32x32x16_bf16 v[128:143], v[224:227], v[108:111], v[128:143]
    v_mfma_f32_32x32x16_bf16 v[144:159], v[228:231], v[108:111], v[144:159]
    s_add_u32 s59, s59, 40960
    s_cmp_eq_u32 s59, 122880
    s_cselect_b32 s59, 0, s59
    v_add_u32 v6, s59, v5
    s_waitcnt vmcnt(10) lgkmcnt(0)
    s_cmp_lg_u32 s58, 6
    s_cbranch_scc1 Lnb_60
    s_cmp_lg_u32 s3, 0
    s_cbranch_scc1 Lwklb_62
Lwlb_61:
    s_sub_u32 s100, s100, 1
    s_cselect_b32 s100, 0, s100
    s_cbranch_scc1 Lwklb_62
    buffer_load_dword v7, off, s[44:47], 0 offset:32 sc1
    s_waitcnt vmcnt(0)
    v_readfirstlane_b32 s95, v7
    s_nop 0
    s_bfe_u32 s95, s95, 0x80008
    s_cmp_ge_u32 s95, 27
    s_cbranch_scc1 Lwklb_62
    s_sleep 4
    s_branch Lwlb_61
Lwklb_62:
    s_waitcnt vmcnt(0)
Lnb_60:
    s_barrier
    ds_read_b128 v[104:107], v6 offset:0
    ds_read_b128 v[108:111], v6 offset:1024
    v_mov_b32 v7, s58
    s_mov_b64 exec, 1
    buffer_store_dword v7, off, s[32:35], s94 sc1
    s_mov_b64 exec, -1
    v_mfma_f32_32x32x16_bf16 v[128:143], v[232:235], v[112:115], v[128:143]
    v_mfma_f32_32x32x16_bf16 v[144:159], v[236:239], v[112:115], v[144:159]
    ds_read_b128 v[112:115], v6 offset:2048
    v_mfma_f32_32x32x16_bf16 v[128:143], v[240:243], v[116:119], v[128:143]
    v_mfma_f32_32x32x16_bf16 v[144:159], v[244:247], v[116:119], v[144:159]
    ds_read_b128 v[116:119], v6 offset:3072
    v_mfma_f32_32x32x16_bf16 v[128:143], v[248:251], v[120:123], v[128:143]
    v_mfma_f32_32x32x16_bf16 v[144:159], v[252:255], v[120:123], v[144:159]
    ds_read_b128 v[120:123], v6 offset:4096
    s_mov_b32 s62, s63
    s_add_u32 s63, s63, s68
    s_add_u32 s58, s58, 1
    s_cmp_ge_u32 s58, s92
    s_cbranch_scc1 Lprojendq_57
    s_waitcnt lgkmcnt(4)
    v_mfma_f32_32x32x16_bf16 v[160:175], a[0:3], v[104:107], 0
    v_mfma_f32_32x32x16_bf16 v[176:191], a[4:7], v[104:107], 0
    ds_read_b128 v[104:107], v6 offset:5120
    s_waitcnt lgkmcnt(4)
    v_mfma_f32_32x32x16_bf16 v[160:175], a[8:11], v[108:111], v[160:175]
    v_cvt_pk_bf16_f32 v64, v128, v129
    v_cvt_pk_bf16_f32 v65, v130, v131
    v_mfma_f32_32x32x16_bf16 v[176:191], a[12:15], v[108:111], v[176:191]
    ds_read_b128 v[108:111], v6 offset:6144
    v_cvt_pk_bf16_f32 v66, v132, v133
    v_cvt_pk_bf16_f32 v67, v134, v135
    s_waitcnt lgkmcnt(4)
    v_mfma_f32_32x32x16_bf16 v[160:175], a[16:19], v[112:115], v[160:175]
    v_mfma_f32_32x32x16_bf16 v[176:191], a[20:23], v[112:115], v[176:191]
    ds_read_b128 v[112:115], v6 offset:7168
    buffer_store_dwordx4 v[64:67], v5, s[32:35], s62 offen offset:0 sc1
    v_cvt_pk_bf16_f32 v68, v136, v137
    s_waitcnt lgkmcnt(4)
    v_mfma_f32_32x32x16_bf16 v[160:175], a[24:27], v[116:119], v[160:175]
    v_cvt_pk_bf16_f32 v69, v138, v139
    v_cvt_pk_bf16_f32 v70, v140, v141
    v_mfma_f32_32x32x16_bf16 v[176:191], a[28:31], v[116:119], v[176:191]
    ds_read_b128 v[116:119], v6 offset:8192
    v_cvt_pk_bf16_f32 v71, v142, v143
    s_waitcnt lgkmcnt(4)
    v_mfma_f32_32x32x16_bf16 v[160:175], a[32:35], v[120:123], v[160:175]
    buffer_store_dwordx4 v[68:71], v5, s[32:35], s62 offen offset:1024 sc1
    v_mfma_f32_32x32x16_bf16 v[176:191], a[36:39], v[120:123], v[176:191]
    ds_read_b128 v[120:123], v6 offset:9216
    v_cvt_pk_bf16_f32 v64, v144, v145
    v_cvt_pk_bf16_f32 v65, v146, v147
    s_waitcnt lgkmcnt(4)
    v_mfma_f32_32x32x16_bf16 v[160:175], a[40:43], v[104:107], v[160:175]
    v_cvt_pk_bf16_f32 v66, v148, v149
    v_cvt_pk_bf16_f32 v67, v150, v151
    v_mfma_f32_32x32x16_bf16 v[176:191], a[44:47], v[104:107], v[176:191]
    ds_read_b128 v[104:107], v6 offset:10240
    s_waitcnt lgkmcnt(4)
    v_mfma_f32_32x32x16_bf16 v[160:175], a[48:51], v[108:111], v[160:175]
    buffer_store_dwordx4 v[64:67], v5, s[32:35], s62 offen offset:2048 sc1
    v_cvt_pk_bf16_f32 v68, v152, v153
    v_mfma_f32_32x32x16_bf16 v[176:191], a[52:55], v[108:111], v[176:191]
    ds_read_b128 v[108:111], v6 offset:11264
    v_cvt_pk_bf16_f32 v69, v154, v155
    v_cvt_pk_bf16_f32 v70, v156, v157
    s_waitcnt lgkmcnt(4)
    v_mfma_f32_32x32x16_bf16 v[160:175], a[56:59], v[112:115], v[160:175]
    v_cvt_pk_bf16_f32 v71, v158, v159
    v_mfma_f32_32x32x16_bf16 v[176:191], a[60:63], v[112:115], v[176:191]
    ds_read_b128 v[112:115], v6 offset:12288
    buffer_store_dwordx4 v[68:71], v5, s[32:35], s62 offen offset:3072 sc1
    s_waitcnt lgkmcnt(4)
    v_mfma_f32_32x32x16_bf16 v[160:175], a[64:67], v[116:119], v[160:175]
    s_min_u32 s65, s61, s64
    s_mul_i32 s66, s65, 40960
    v_mfma_f32_32x32x16_bf16 v[176:191], a[68:71], v[116:119], v[176:191]
    ds_read_b128 v[116:119], v6 offset:13312
    s_add_u32 s66, s66, s69
    s_add_u32 m0, s60, s67
    s_waitcnt lgkmcnt(4)
    v_mfma_f32_32x32x16_bf16 v[160:175], a[72:75], v[120:123], v[160:175]
    v_mfma_f32_32x32x16_bf16 v[176:191], a[76:79], v[120:123], v[176:191]
    ds_read_b128 v[120:123], v6 offset:14336
    buffer_load_dwordx4 v5, s[32:35], s66 offen offset:0 sc1 lds
    s_waitcnt lgkmcnt(4)
    v_mfma_f32_32x32x16_bf16 v[160:175], a[80:83], v[104:107], v[160:175]
    buffer_load_dwordx4 v5, s[32:35], s66 offen offset:1024 sc1 lds
    v_mfma_f32_32x32x16_bf16 v[176:191], a[84:87], v[104:107], v[176:191]
    ds_read_b128 v[104:107], v6 offset:15360
    s_waitcnt lgkmcnt(4)
    v_mfma_f32_32x32x16_bf16 v[160:175], a[88:91], v[108:111], v[160:175]
    buffer_load_dwordx4 v5, s[32:35], s66 offen offset:2048 sc1 lds
    v_mfma_f32_32x32x16_bf16 v[176:191], a[92:95], v[108:111], v[176:191]
    ds_read_b128 v[108:111], v6 offset:16384
    buffer_load_dwordx4 v5, s[32:35], s66 offen offset:3072 sc1 lds
    s_waitcnt lgkmcnt(4)
    v_mfma_f32_32x32x16_bf16 v[160:175], a[96:99], v[112:115], v[160:175]
    s_add_u32 s66, s66, 4096
    s_add_u32 m0, m0, 4096
    v_mfma_f32_32x32x16_bf16 v[176:191], a[100:103], v[112:115], v[176:191]
    ds_read_b128 v[112:115], v6 offset:17408
    s_waitcnt lgkmcnt(4)
    v_mfma_f32_32x32x16_bf16 v[160:175], a[104:107], v[116:119], v[160:175]
    buffer_load_dwordx4 v5, s[32:35], s66 offen offset:0 sc1 lds
    v_mfma_f32_32x32x16_bf16 v[176:191], a[108:111], v[116:119], v[176:191]
    ds_read_b128 v[116:119], v6 offset:18432
    buffer_load_dwordx4 v5, s[32:35], s66 offen offset:1024 sc1 lds
    s_waitcnt lgkmcnt(4)
    v_mfma_f32_32x32x16_bf16 v[160:175], a[112:115], v[120:123], v[160:175]
    v_mfma_f32_32x32x16_bf16 v[176:191], a[116:119], v[120:123], v[176:191]
    ds_read_b128 v[120:123], v6 offset:19456
    buffer_load_dwordx4 v5, s[32:35], s66 offen offset:2048 sc1 lds
    s_waitcnt lgkmcnt(4)
    v_mfma_f32_32x32x16_bf16 v[160:175], a[120:123], v[104:107], v[160:175]
    buffer_load_dwordx4 v5, s[32:35], s66 offen offset:3072 sc1 lds
    v_mfma_f32_32x32x16_bf16 v[176:191], a[124:127], v[104:107], v[176:191]
    ds_read_b128 v[104:107], v6 offset:20480
    s_add_u32 s66, s66, 4096
    s_add_u32 m0, m0, 4096
    s_waitcnt lgkmcnt(4)
    v_mfma_f32_32x32x16_bf16 v[160:175], a[128:131], v[108:111], v[160:175]
    v_mfma_f32_32x32x16_bf16 v[176:191], a[132:135], v[108:111], v[176:191]
    ds_read_b128 v[108:111], v6 offset:21504
    buffer_load_dwordx4 v5, s[32:35], s66 offen offset:0 sc1 lds
    s_waitcnt lgkmcnt(4)
    v_mfma_f32_32x32x16_bf16 v[160:175], a[136:139], v[112:115], v[160:175]
    buffer_load_dwordx4 v5, s[32:35], s66 offen offset:1024 sc1 lds
    v_mfma_f32_32x32x16_bf16 v[176:191], a[140:143], v[112:115], v[176:191]
    ds_read_b128 v[112:115], v6 offset:22528
    s_add_u32 s61, s61, s93
    s_add_u32 s60, s60, 40960
    s_waitcnt lgkmcnt(4)
    v_mfma_f32_32x32x16_bf16 v[160:175], a[144:147], v[116:119], v[160:175]
    s_cmp_eq_u32 s60, 122880
    s_cselect_b32 s60, 0, s60
    v_mfma_f32_32x32x16_bf16 v[176:191], a[148:151], v[116:119], v[176:191]
    ds_read_b128 v[116:119], v6 offset:23552
    s_waitcnt lgkmcnt(4)
    v_mfma_f32_32x32x16_bf16 v[160:175], a[152:155], v[120:123], v[160:175]
    v_mfma_f32_32x32x16_bf16 v[176:191], a[156:159], v[120:123], v[176:191]
    ds_read_b128 v[120:123], v6 offset:24576
    s_waitcnt lgkmcnt(4)
    v_mfma_f32_32x32x16_bf16 v[160:175], a[160:163], v[104:107], v[160:175]
    v_mfma_f32_32x32x16_bf16 v[176:191], a[164:167], v[104:107], v[176:191]
    ds_read_b128 v[104:107], v6 offset:25600
    s_waitcnt lgkmcnt(4)
    v_mfma_f32_32x32x16_bf16 v[160:175], a[168:171], v[108:111], v[160:175]
    v_mfma_f32_32x32x16_bf16 v[176:191], a[172:175], v[108:111], v[176:191]
    ds_read_b128 v[108:111], v6 offset:26624
    s_waitcnt lgkmcnt(4)
    v_mfma_f32_32x32x16_bf16 v[160:175], a[176:179], v[112:115], v[160:175]
    v_mfma_f32_32x32x16_bf16 v[176:191], a[180:183], v[112:115], v[176:191]
    ds_read_b128 v[112:115], v6 offset:27648
    s_waitcnt lgkmcnt(4)
    v_mfma_f32_32x32x16_bf16 v[160:175], a[184:187], v[116:119], v[160:175]
    v_mfma_f32_32x32x16_bf16 v[176:191], a[188:191], v[116:119], v[176:191]
    ds_read_b128 v[116:119], v6 offset:28672
    s_waitcnt lgkmcnt(4)
    v_mfma_f32_32x32x16_bf16 v[160:175], a[192:195], v[120:123], v[160:175]
    v_mfma_f32_32x32x16_bf16 v[176:191], a[196:199], v[120:123], v[176:191]
    ds_read_b128 v[120:123], v6 offset:29696
    s_waitcnt lgkmcnt(4)
    v_mfma_f32_32x32x16_bf16 v[160:175], a[200:203], v[104:107], v[160:175]
    v_mfma_f32_32x32x16_bf16 v[176:191], a[204:207], v[104:107], v[176:191]
    ds_read_b128 v[104:107], v6 offset:30720
    s_waitcnt lgkmcnt(4)
    v_mfma_f32_32x32x16_bf16 v[160:175], a[208:211], v[108:111], v[160:175]
    v_mfma_f32_32x32x16_bf16 v[176:191], a[212:215], v[108:111], v[176:191]
    ds_read_b128 v[108:111], v6 offset:31744
    s_waitcnt lgkmcnt(4)
    v_mfma_f32_32x32x16_bf16 v[160:175], a[216:219], v[112:115], v[160:175]
    v_mfma_f32_32x32x16_bf16 v[176:191], a[220:223], v[112:115], v[176:191]
    ds_read_b128 v[112:115], v6 offset:32768
    s_waitcnt lgkmcnt(4)
    v_mfma_f32_32x32x16_bf16 v[160:175], a[224:227], v[116:119], v[160:175]
    v_mfma_f32_32x32x16_bf16 v[176:191], a[228:231], v[116:119], v[176:191]
    ds_read_b128 v[116:119], v6 offset:33792
    s_waitcnt lgkmcnt(4)
    v_mfma_f32_32x32x16_bf16 v[160:175], a[232:235], v[120:123], v[160:175]
    v_mfma_f32_32x32x16_bf16 v[176:191], a[236:239], v[120:123], v[176:191]
    ds_read_b128 v[120:123], v6 offset:34816
    s_waitcnt lgkmcnt(4)
    v_mfma_f32_32x32x16_bf16 v[160:175], a[240:243], v[104:107], v[160:175]
    v_mfma_f32_32x32x16_bf16 v[176:191], a[244:247], v[104:107], v[176:191]
    ds_read_b128 v[104:107], v6 offset:35840
    s_waitcnt lgkmcnt(4)
    v_mfma_f32_32x32x16_bf16 v[160:175], a[248:251], v[108:111], v[160:175]
    v_mfma_f32_32x32x16_bf16 v[176:191], a[252:255], v[108:111], v[176:191]
    ds_read_b128 v[108:111], v6 offset:36864
    s_waitcnt lgkmcnt(4)
    v_mfma_f32_32x32x16_bf16 v[160:175], v[192:195], v[112:115], v[160:175]
    v_mfma_f32_32x32x16_bf16 v[176:191], v[196:199], v[112:115], v[176:191]
    ds_read_b128 v[112:115], v6 offset:37888
    s_waitcnt lgkmcnt(4)
    v_mfma_f32_32x32x16_bf16 v[160:175], v[200:203], v[116:119], v[160:175]
    v_mfma_f32_32x32x16_bf16 v[176:191], v[204:207], v[116:119], v[176:191]
    ds_read_b128 v[116:119], v6 offset:38912
    s_waitcnt lgkmcnt(4)
    v_mfma_f32_32x32x16_bf16 v[160:175], v[208:211], v[120:123], v[160:175]
    v_mfma_f32_32x32x16_bf16 v[176:191], v[212:215], v[120:123], v[176:191]
    ds_read_b128 v[120:123], v6 offset:39936
    s_waitcnt lgkmcnt(4)
    v_mfma_f32_32x32x16_bf16 v[160:175], v[216:219], v[104:107], v[160:175]
    v_mfma_f32_32x32x16_bf16 v[176:191], v[220:223], v[104:107], v[176:191]
    s_waitcnt lgkmcnt(3)
    v_mfma_f32_32x32x16_bf16 v[160:175], v[224:227], v[108:111], v[160:175]
    v_mfma_f32_32x32x16_bf16 v[176:191], v[228:231], v[108:111], v[176:191]
    s_add_u32 s59, s59, 40960
    s_cmp_eq_u32 s59, 122880
    s_cselect_b32 s59, 0, s59
    v_add_u32 v6, s59, v5
    s_waitcnt vmcnt(10) lgkmcnt(0)
    s_barrier
    ds_read_b128 v[104:107], v6 offset:0
    ds_read_b128 v[108:111], v6 offset:1024
    v_mov_b32 v7, s58
    s_mov_b64 exec, 1
    buffer_store_dword v7, off, s[32:35], s94 sc1
    s_mov_b64 exec, -1
    v_mfma_f32_32x32x16_bf16 v[160:175], v[232:235], v[112:115], v[160:175]
    v_mfma_f32_32x32x16_bf16 v[176:191], v[236:239], v[112:115], v[176:191]
    ds_read_b128 v[112:115], v6 offset:2048
    v_mfma_f32_32x32x16_bf16 v[160:175], v[240:243], v[116:119], v[160:175]
    v_mfma_f32_32x32x16_bf16 v[176:191], v[244:247], v[116:119], v[176:191]
    ds_read_b128 v[116:119], v6 offset:3072
    v_mfma_f32_32x32x16_bf16 v[160:175], v[248:251], v[120:123], v[160:175]
    v_mfma_f32_32x32x16_bf16 v[176:191], v[252:255], v[120:123], v[176:191]
    ds_read_b128 v[120:123], v6 offset:4096
    s_mov_b32 s62, s63
    s_add_u32 s63, s63, s68
    s_add_u32 s58, s58, 1
    s_cmp_ge_u32 s58, s92
    s_cbranch_scc1 Lprojendq_58
    s_branch Lprojq_56
Lprojendq_57:
    s_waitcnt lgkmcnt(0)
    s_nop 7
    v_cvt_pk_bf16_f32 v64, v128, v129
    v_cvt_pk_bf16_f32 v65, v130, v131
    v_cvt_pk_bf16_f32 v66, v132, v133
    v_cvt_pk_bf16_f32 v67, v134, v135
    buffer_store_dwordx4 v[64:67], v5, s[32:35], s62 offen offset:0 sc1
    v_cvt_pk_bf16_f32 v68, v136, v137
    v_cvt_pk_bf16_f32 v69, v138, v139
    v_cvt_pk_bf16_f32 v70, v140, v141
    v_cvt_pk_bf16_f32 v71, v142, v143
    buffer_store_dwordx4 v[68:71], v5, s[32:35], s62 offen offset:1024 sc1
    v_cvt_pk_bf16_f32 v64, v144, v145
    v_cvt_pk_bf16_f32 v65, v146, v147
    v_cvt_pk_bf16_f32 v66, v148, v149
    v_cvt_pk_bf16_f32 v67, v150, v151
    buffer_store_dwordx4 v[64:67], v5, s[32:35], s62 offen offset:2048 sc1
    v_cvt_pk_bf16_f32 v68, v152, v153
    v_cvt_pk_bf16_f32 v69, v154, v155
    v_cvt_pk_bf16_f32 v70, v156, v157
    v_cvt_pk_bf16_f32 v71, v158, v159
    buffer_store_dwordx4 v[68:71], v5, s[32:35], s62 offen offset:3072 sc1
    s_branch Lprojdoneq_59
Lprojendq_58:
    s_waitcnt lgkmcnt(0)
    s_nop 7
    v_cvt_pk_bf16_f32 v64, v160, v161
    v_cvt_pk_bf16_f32 v65, v162, v163
    v_cvt_pk_bf16_f32 v66, v164, v165
    v_cvt_pk_bf16_f32 v67, v166, v167
    buffer_store_dwordx4 v[64:67], v5, s[32:35], s62 offen offset:0 sc1
    v_cvt_pk_bf16_f32 v68, v168, v169
    v_cvt_pk_bf16_f32 v69, v170, v171
    v_cvt_pk_bf16_f32 v70, v172, v173
    v_cvt_pk_bf16_f32 v71, v174, v175
    buffer_store_dwordx4 v[68:71], v5, s[32:35], s62 offen offset:1024 sc1
    v_cvt_pk_bf16_f32 v64, v176, v177
    v_cvt_pk_bf16_f32 v65, v178, v179
    v_cvt_pk_bf16_f32 v66, v180, v181
    v_cvt_pk_bf16_f32 v67, v182, v183
    buffer_store_dwordx4 v[64:67], v5, s[32:35], s62 offen offset:2048 sc1
    v_cvt_pk_bf16_f32 v68, v184, v185
    v_cvt_pk_bf16_f32 v69, v186, v187
    v_cvt_pk_bf16_f32 v70, v188, v189
    v_cvt_pk_bf16_f32 v71, v190, v191
    buffer_store_dwordx4 v[68:71], v5, s[32:35], s62 offen offset:3072 sc1
Lprojdoneq_59:
    s_branch LpD_30
LpmV_54:
    v_lshlrev_b32 v5, 4, v1
    s_mul_i32 s67, s3, 10240
    s_add_u32 s69, s3, s89
    s_and_b32 s69, s69, 3
    s_mul_i32 s69, s69, 10240
    s_sub_u32 s65, s92, 1
    s_mul_i32 s64, s65, s93
    s_add_u32 s64, s64, s90
    s_barrier
    s_mov_b32 s61, s90
    s_mov_b32 s60, 0
    s_min_u32 s65, s61, s64
    s_mul_i32 s66, s65, 40960
    s_add_u32 s66, s66, s69
    s_add_u32 m0, s60, s67
    s_nop 0
    buffer_load_dwordx4 v5, s[32:35], s66 offen offset:0 sc1 lds
    buffer_load_dwordx4 v5, s[32:35], s66 offen offset:1024 sc1 lds
    buffer_load_dwordx4 v5, s[32:35], s66 offen offset:2048 sc1 lds
    buffer_load_dwordx4 v5, s[32:35], s66 offen offset:3072 sc1 lds
    s_add_u32 s66, s66, 4096
    s_add_u32 m0, m0, 4096
    s_nop 0
    buffer_load_dwordx4 v5, s[32:35], s66 offen offset:0 sc1 lds
    buffer_load_dwordx4 v5, s[32:35], s66 offen offset:1024 sc1 lds
    buffer_load_dwordx4 v5, s[32:35], s66 offen offset:2048 sc1 lds
    buffer_load_dwordx4 v5, s[32:35], s66 offen offset:3072 sc1 lds
    s_add_u32 s66, s66, 4096
    s_add_u32 m0, m0, 4096
    s_nop 0
    buffer_load_dwordx4 v5, s[32:35], s66 offen offset:0 sc1 lds
    buffer_load_dwordx4 v5, s[32:35], s66 offen offset:1024 sc1 lds
    s_add_u32 s61, s61, s93
    s_add_u32 s60, s60, 40960
    s_cmp_eq_u32 s60, 122880
    s_cselect_b32 s60, 0, s60
    s_min_u32 s65, s61, s64
    s_mul_i32 s66, s65, 40960
    s_add_u32 s66, s66, s69
    s_add_u32 m0, s60, s67
    s_nop 0
    buffer_load_dwordx4 v5, s[32:35], s66 offen offset:0 sc1 lds
    buffer_load_dwordx4 v5, s[32:35], s66 offen offset:1024 sc1 lds
    buffer_load_dwordx4 v5, s[32:35], s66 offen offset:2048 sc1 lds
    buffer_load_dwordx4 v5, s[32:35], s66 offen offset:3072 sc1 lds
    s_add_u32 s66, s66, 4096
    s_add_u32 m0, m0, 4096
    s_nop 0
    buffer_load_dwordx4 v5, s[32:35], s66 offen offset:0 sc1 lds
    buffer_load_dwordx4 v5, s[32:35], s66 offen offset:1024 sc1 lds
    buffer_load_dwordx4 v5, s[32:35], s66 offen offset:2048 sc1 lds
    buffer_load_dwordx4 v5, s[32:35], s66 offen offset:3072 sc1 lds
    s_add_u32 s66, s66, 4096
    s_add_u32 m0, m0, 4096
    s_nop 0
    buffer_load_dwordx4 v5, s[32:35], s66 offen offset:0 sc1 lds
    buffer_load_dwordx4 v5, s[32:35], s66 offen offset:1024 sc1 lds
    s_add_u32 s61, s61, s93
    s_add_u32 s60, s60, 40960
    s_cmp_eq_u32 s60, 122880
    s_cselect_b32 s60, 0, s60
    s_mov_b32 s58, 0
    s_mov_b32 s59, 0
    s_mov_b32 s62, 0x10000000
    s_mul_i32 s63, s90, s56
    s_add_u32 s63, s63, s55
    s_mul_i32 s68, s93, s56
    v_mov_b32 v6, v5
    s_waitcnt vmcnt(10)
    s_barrier
    ds_read_b128 v[104:107], v6 offset:0
    ds_read_b128 v[108:111], v6 offset:1024
    ds_read_b128 v[112:115], v6 offset:2048
    ds_read_b128 v[116:119], v6 offset:3072
    ds_read_b128 v[120:123], v6 offset:4096
Lprojv_63:
    s_waitcnt lgkmcnt(4)
    v_mfma_f32_32x32x16_bf16 v[128:143], v[104:107], a[0:3], 0
    v_mfma_f32_32x32x16_bf16 v[144:159], v[104:107], a[4:7], 0
    ds_read_b128 v[104:107], v6 offset:5120
    s_waitcnt lgkmcnt(4)
    v_mfma_f32_32x32x16_bf16 v[128:143], v[108:111], a[8:11], v[128:143]
    v_cvt_pk_bf16_f32 v64, v160, v161
    v_cvt_pk_bf16_f32 v65, v162, v163
    v_mfma_f32_32x32x16_bf16 v[144:159], v[108:111], a[12:15], v[144:159]
    ds_read_b128 v[108:111], v6 offset:6144
    v_cvt_pk_bf16_f32 v66, v164, v165
    v_cvt_pk_bf16_f32 v67, v166, v167
    s_waitcnt lgkmcnt(4)
    v_mfma_f32_32x32x16_bf16 v[128:143], v[112:115], a[16:19], v[128:143]
    v_mfma_f32_32x32x16_bf16 v[144:159], v[112:115], a[20:23], v[144:159]
    ds_read_b128 v[112:115], v6 offset:7168
    buffer_store_dwordx4 v[64:67], v5, s[32:35], s62 offen offset:0 sc1
    v_cvt_pk_bf16_f32 v68, v168, v169
    s_waitcnt lgkmcnt(4)
    v_mfma_f32_32x32x16_bf16 v[128:143], v[116:119], a[24:27], v[128:143]
    v_cvt_pk_bf16_f32 v69, v170, v171
    v_cvt_pk_bf16_f32 v70, v172, v173
    v_mfma_f32_32x32x16_bf16 v[144:159], v[116:119], a[28:31], v[144:159]
    ds_read_b128 v[116:119], v6 offset:8192
    v_cvt_pk_bf16_f32 v71, v174, v175
    s_waitcnt lgkmcnt(4)
    v_mfma_f32_32x32x16_bf16 v[128:143], v[120:123], a[32:35], v[128:143]
    buffer_store_dwordx4 v[68:71], v5, s[32:35], s62 offen offset:1024 sc1
    v_mfma_f32_32x32x16_bf16 v[144:159], v[120:123], a[36:39], v[144:159]
    ds_read_b128 v[120:123], v6 offset:9216
    v_cvt_pk_bf16_f32 v64, v176, v177
    v_cvt_pk_bf16_f32 v65, v178, v179
    s_waitcnt lgkmcnt(4)
    v_mfma_f32_32x32x16_bf16 v[128:143], v[104:107], a[40:43], v[128:143]
    v_cvt_pk_bf16_f32 v66, v180, v181
    v_cvt_pk_bf16_f32 v67, v182, v183
    v_mfma_f32_32x32x16_bf16 v[144:159], v[104:107], a[44:47], v[144:159]
    ds_read_b128 v[104:107], v6 offset:10240
    s_waitcnt lgkmcnt(4)
    v_mfma_f32_32x32x16_bf16 v[128:143], v[108:111], a[48:51], v[128:143]
    buffer_store_dwordx4 v[64:67], v5, s[32:35], s62 offen offset:2048 sc1
    v_cvt_pk_bf16_f32 v68, v184, v185
    v_mfma_f32_32x32x16_bf16 v[144:159], v[108:111], a[52:55], v[144:159]
    ds_read_b128 v[108:111], v6 offset:11264
    v_cvt_pk_bf16_f32 v69, v186, v187
    v_cvt_pk_bf16_f32 v70, v188, v189
    s_waitcnt lgkmcnt(4)
    v_mfma_f32_32x32x16_bf16 v[128:143], v[112:115], a[56:59], v[128:143]
    v_cvt_pk_bf16_f32 v71, v190, v191
    v_mfma_f32_32x32x16_bf16 v[144:159], v[112:115], a[60:63], v[144:159]
    ds_read_b128 v[112:115], v6 offset:12288
    buffer_store_dwordx4 v[68:71], v5, s[32:35], s62 offen offset:3072 sc1
    s_waitcnt lgkmcnt(4)
    v_mfma_f32_32x32x16_bf16 v[128:143], v[116:119], a[64:67], v[128:143]
    s_min_u32 s65, s61, s64
    s_mul_i32 s66, s65, 40960
    v_mfma_f32_32x32x16_bf16 v[144:159], v[116:119], a[68:71], v[144:159]
    ds_read_b128 v[116:119], v6 offset:13312
    s_add_u32 s66, s66, s69
    s_add_u32 m0, s60, s67
    s_waitcnt lgkmcnt(4)
    v_mfma_f32_32x32x16_bf16 v[128:143], v[120:123], a[72:75], v[128:143]
    v_mfma_f32_32x32x16_bf16 v[144:159], v[120:123], a[76:79], v[144:159]
    ds_read_b128 v[120:123], v6 offset:14336
    buffer_load_dwordx4 v5, s[32:35], s66 offen offset:0 sc1 lds
    s_waitcnt lgkmcnt(4)
    v_mfma_f32_32x32x16_bf16 v[128:143], v[104:107], a[80:83], v[128:143]
    buffer_load_dwordx4 v5, s[32:35], s66 offen offset:1024 sc1 lds
    v_mfma_f32_32x32x16_bf16 v[144:159], v[104:107], a[84:87], v[144:159]
    ds_read_b128 v[104:107], v6 offset:15360
    s_waitcnt lgkmcnt(4)
    v_mfma_f32_32x32x16_bf16 v[128:143], v[108:111], a[88:91], v[128:143]
    buffer_load_dwordx4 v5, s[32:35], s66 offen offset:2048 sc1 lds
    v_mfma_f32_32x32x16_bf16 v[144:159], v[108:111], a[92:95], v[144:159]
    ds_read_b128 v[108:111], v6 offset:16384
    buffer_load_dwordx4 v5, s[32:35], s66 offen offset:3072 sc1 lds
    s_waitcnt lgkmcnt(4)
    v_mfma_f32_32x32x16_bf16 v[128:143], v[112:115], a[96:99], v[128:143]
    s_add_u32 s66, s66, 4096
    s_add_u32 m0, m0, 4096
    v_mfma_f32_32x32x16_bf16 v[144:159], v[112:115], a[100:103], v[144:159]
    ds_read_b128 v[112:115], v6 offset:17408
    s_waitcnt lgkmcnt(4)
    v_mfma_f32_32x32x16_bf16 v[128:143], v[116:119], a[104:107], v[128:143]
    buffer_load_dwordx4 v5, s[32:35], s66 offen offset:0 sc1 lds
    v_mfma_f32_32x32x16_bf16 v[144:159], v[116:119], a[108:111], v[144:159]
    ds_read_b128 v[116:119], v6 offset:18432
    buffer_load_dwordx4 v5, s[32:35], s66 offen offset:1024 sc1 lds
    s_waitcnt lgkmcnt(4)
    v_mfma_f32_32x32x16_bf16 v[128:143], v[120:123], a[112:115], v[128:143]
    v_mfma_f32_32x32x16_bf16 v[144:159], v[120:123], a[116:119], v[144:159]
    ds_read_b128 v[120:123], v6 offset:19456
    buffer_load_dwordx4 v5, s[32:35], s66 offen offset:2048 sc1 lds
    s_waitcnt lgkmcnt(4)
    v_mfma_f32_32x32x16_bf16 v[128:143], v[104:107], a[120:123], v[128:143]
    buffer_load_dwordx4 v5, s[32:35], s66 offen offset:3072 sc1 lds
    v_mfma_f32_32x32x16_bf16 v[144:159], v[104:107], a[124:127], v[144:159]
    ds_read_b128 v[104:107], v6 offset:20480
    s_add_u32 s66, s66, 4096
    s_add_u32 m0, m0, 4096
    s_waitcnt lgkmcnt(4)
    v_mfma_f32_32x32x16_bf16 v[128:143], v[108:111], a[128:131], v[128:143]
    v_mfma_f32_32x32x16_bf16 v[144:159], v[108:111], a[132:135], v[144:159]
    ds_read_b128 v[108:111], v6 offset:21504
    buffer_load_dwordx4 v5, s[32:35], s66 offen offset:0 sc1 lds
    s_waitcnt lgkmcnt(4)
    v_mfma_f32_32x32x16_bf16 v[128:143], v[112:115], a[136:139], v[128:143]
    buffer_load_dwordx4 v5, s[32:35], s66 offen offset:1024 sc1 lds
    v_mfma_f32_32x32x16_bf16 v[144:159], v[112:115], a[140:143], v[144:159]
    ds_read_b128 v[112:115], v6 offset:22528
    s_add_u32 s61, s61, s93
    s_add_u32 s60, s60, 40960
    s_waitcnt lgkmcnt(4)
    v_mfma_f32_32x32x16_bf16 v[128:143], v[116:119], a[144:147], v[128:143]
    s_cmp_eq_u32 s60, 122880
    s_cselect_b32 s60, 0, s60
    v_mfma_f32_32x32x16_bf16 v[144:159], v[116:119], a[148:151], v[144:159]
    ds_read_b128 v[116:119], v6 offset:23552
    s_waitcnt lgkmcnt(4)
    v_mfma_f32_32x32x16_bf16 v[128:143], v[120:123], a[152:155], v[128:143]
    v_mfma_f32_32x32x16_bf16 v[144:159], v[120:123], a[156:159], v[144:159]
    ds_read_b128 v[120:123], v6 offset:24576
    s_waitcnt lgkmcnt(4)
    v_mfma_f32_32x32x16_bf16 v[128:143], v[104:107], a[160:163], v[128:143]
    v_mfma_f32_32x32x16_bf16 v[144:159], v[104:107], a[164:167], v[144:159]
    ds_read_b128 v[104:107], v6 offset:25600
    s_waitcnt lgkmcnt(4)
    v_mfma_f32_32x32x16_bf16 v[128:143], v[108:111], a[168:171], v[128:143]
    v_mfma_f32_32x32x16_bf16 v[144:159], v[108:111], a[172:175], v[144:159]
    ds_read_b128 v[108:111], v6 offset:26624
    s_waitcnt lgkmcnt(4)
    v_mfma_f32_32x32x16_bf16 v[128:143], v[112:115], a[176:179], v[128:143]
    v_mfma_f32_32x32x16_bf16 v[144:159], v[112:115], a[180:183], v[144:159]
    ds_read_b128 v[112:115], v6 offset:27648
    s_waitcnt lgkmcnt(4)
    v_mfma_f32_32x32x16_bf16 v[128:143], v[116:119], a[184:187], v[128:143]
    v_mfma_f32_32x32x16_bf16 v[144:159], v[116:119], a[188:191], v[144:159]
    ds_read_b128 v[116:119], v6 offset:28672
    s_waitcnt lgkmcnt(4)
    v_mfma_f32_32x32x16_bf16 v[128:143], v[120:123], a[192:195], v[128:143]
    v_mfma_f32_32x32x16_bf16 v[144:159], v[120:123], a[196:199], v[144:159]
    ds_read_b128 v[120:123], v6 offset:29696
    s_waitcnt lgkmcnt(4)
    v_mfma_f32_32x32x16_bf16 v[128:143], v[104:107], a[200:203], v[128:143]
    v_mfma_f32_32x32x16_bf16 v[144:159], v[104:107], a[204:207], v[144:159]
    ds_read_b128 v[104:107], v6 offset:30720
    s_waitcnt lgkmcnt(4)
    v_mfma_f32_32x32x16_bf16 v[128:143], v[108:111], a[208:211], v[128:143]
    v_mfma_f32_32x32x16_bf16 v[144:159], v[108:111], a[212:215], v[144:159]
    ds_read_b128 v[108:111], v6 offset:31744
    s_waitcnt lgkmcnt(4)
    v_mfma_f32_32x32x16_bf16 v[128:143], v[112:115], a[216:219], v[128:143]
    v_mfma_f32_32x32x16_bf16 v[144:159], v[112:115], a[220:223], v[144:159]
    ds_read_b128 v[112:115], v6 offset:32768
    s_waitcnt lgkmcnt(4)
    v_mfma_f32_32x32x16_bf16 v[128:143], v[116:119], a[224:227], v[128:143]
    v_mfma_f32_32x32x16_bf16 v[144:159], v[116:119], a[228:231], v[144:159]
    ds_read_b128 v[116:119], v6 offset:33792
    s_waitcnt lgkmcnt(4)
    v_mfma_f32_32x32x16_bf16 v[128:143], v[120:123], a[232:235], v[128:143]
    v_mfma_f32_32x32x16_bf16 v[144:159], v[120:123], a[236:239], v[144:159]
    ds_read_b128 v[120:123], v6 offset:34816
    s_waitcnt lgkmcnt(4)
    v_mfma_f32_32x32x16_bf16 v[128:143], v[104:107], a[240:243], v[128:143]
    v_mfma_f32_32x32x16_bf16 v[144:159], v[104:107], a[244:247], v[144:159]
    ds_read_b128 v[104:107], v6 offset:35840
    s_waitcnt lgkmcnt(4)
    v_mfma_f32_32x32x16_bf16 v[128:143], v[108:111], a[248:251], v[128:143]
    v_mfma_f32_32x32x16_bf16 v[144:159], v[108:111], a[252:255], v[144:159]
    ds_read_b128 v[108:111], v6 offset:36864
    s_waitcnt lgkmcnt(4)
    v_mfma_f32_32x32x16_bf16 v[128:143], v[112:115], v[192:195], v[128:143]
    v_mfma_f32_32x32x16_bf16 v[144:159], v[112:115], v[196:199], v[144:159]
    ds_read_b128 v[112:115], v6 offset:37888
    s_waitcnt lgkmcnt(4)
    v_mfma_f32_32x32x16_bf16 v[128:143], v[116:119], v[200:203], v[128:143]
    v_mfma_f32_32x32x16_bf16 v[144:159], v[116:119], v[204:207], v[144:159]
    ds_read_b128 v[116:119], v6 offset:38912
    s_waitcnt lgkmcnt(4)
    v_mfma_f32_32x32x16_bf16 v[128:143], v[120:123], v[208:211], v[128:143]
    v_mfma_f32_32x32x16_bf16 v[144:159], v[120:123], v[212:215], v[144:159]
    ds_read_b128 v[120:123], v6 offset:39936
    s_waitcnt lgkmcnt(4)
    v_mfma_f32_32x32x16_bf16 v[128:143], v[104:107], v[216:219], v[128:143]
    v_mfma_f32_32x32x16_bf16 v[144:159], v[104:107], v[220:223], v[144:159]
    s_waitcnt lgkmcnt(3)
    v_mfma_f32_32x32x16_bf16 v[128:143], v[108:111], v[224:227], v[128:143]
    v_mfma_f32_32x32x16_bf16 v[144:159], v[108:111], v[228:231], v[144:159]
    s_add_u32 s59, s59, 40960
    s_cmp_eq_u32 s59, 122880
    s_cselect_b32 s59, 0, s59
    v_add_u32 v6, s59, v5
    s_waitcnt vmcnt(10) lgkmcnt(0)
    s_cmp_lg_u32 s58, 6
    s_cbranch_scc1 Lnb_67
    s_cmp_lg_u32 s3, 0
    s_cbranch_scc1 Lwklb_69
Lwlb_68:
    s_sub_u32 s100, s100, 1
    s_cselect_b32 s100, 0, s100
    s_cbranch_scc1 Lwklb_69
    buffer_load_dword v7, off, s[44:47], 0 offset:32 sc1
    s_waitcnt vmcnt(0)
    v_readfirstlane_b32 s95, v7
    s_nop 0
    s_bfe_u32 s95, s95, 0x80008
    s_cmp_ge_u32 s95, 27
    s_cbranch_scc1 Lwklb_69
    s_sleep 4
    s_branch Lwlb_68
Lwklb_69:
    s_waitcnt vmcnt(0)
Lnb_67:
    s_barrier
    ds_read_b128 v[104:107], v6 offset:0
    ds_read_b128 v[108:111], v6 offset:1024
    v_mov_b32 v7, s58
    s_mov_b64 exec, 1
    buffer_store_dword v7, off, s[32:35], s94 sc1
    s_mov_b64 exec, -1
    v_mfma_f32_32x32x16_bf16 v[128:143], v[112:115], v[232:235], v[128:143]
    v_mfma_f32_32x32x16_bf16 v[144:159], v[112:115], v[236:239], v[144:159]
    ds_read_b128 v[112:115], v6 offset:2048
    v_mfma_f32_32x32x16_bf16 v[128:143], v[116:119], v[240:243], v[128:143]
    v_mfma_f32_32x32x16_bf16 v[144:159], v[116:119], v[244:247], v[144:159]
    ds_read_b128 v[116:119], v6 offset:3072
    v_mfma_f32_32x32x16_bf16 v[128:143], v[120:123], v[248:251], v[128:143]
    v_mfma_f32_32x32x16_bf16 v[144:159], v[120:123], v[252:255], v[144:159]
    ds_read_b128 v[120:123], v6 offset:4096
    s_mov_b32 s62, s63
    s_add_u32 s63, s63, s68
    s_add_u32 s58, s58, 1
    s_cmp_ge_u32 s58, s92
    s_cbranch_scc1 Lprojendv_64
    s_waitcnt lgkmcnt(4)
    v_mfma_f32_32x32x16_bf16 v[160:175], v[104:107], a[0:3], 0
    v_mfma_f32_32x32x16_bf16 v[176:191], v[104:107], a[4:7], 0
    ds_read_b128 v[104:107], v6 offset:5120
    s_waitcnt lgkmcnt(4)
    v_mfma_f32_32x32x16_bf16 v[160:175], v[108:111], a[8:11], v[160:175]
    v_cvt_pk_bf16_f32 v64, v128, v129
    v_cvt_pk_bf16_f32 v65, v130, v131
    v_mfma_f32_32x32x16_bf16 v[176:191], v[108:111], a[12:15], v[176:191]
    ds_read_b128 v[108:111], v6 offset:6144
    v_cvt_pk_bf16_f32 v66, v132, v133
    v_cvt_pk_bf16_f32 v67, v134, v135
    s_waitcnt lgkmcnt(4)
    v_mfma_f32_32x32x16_bf16 v[160:175], v[112:115], a[16:19], v[160:175]
    v_mfma_f32_32x32x16_bf16 v[176:191], v[112:115], a[20:23], v[176:191]
    ds_read_b128 v[112:115], v6 offset:7168
    buffer_store_dwordx4 v[64:67], v5, s[32:35], s62 offen offset:0 sc1
    v_cvt_pk_bf16_f32 v68, v136, v137
    s_waitcnt lgkmcnt(4)
    v_mfma_f32_32x32x16_bf16 v[160:175], v[116:119], a[24:27], v[160:175]
    v_cvt_pk_bf16_f32 v69, v138, v139
    v_cvt_pk_bf16_f32 v70, v140, v141
    v_mfma_f32_32x32x16_bf16 v[176:191], v[116:119], a[28:31], v[176:191]
    ds_read_b128 v[116:119], v6 offset:8192
    v_cvt_pk_bf16_f32 v71, v142, v143
    s_waitcnt lgkmcnt(4)
    v_mfma_f32_32x32x16_bf16 v[160:175], v[120:123], a[32:35], v[160:175]
    buffer_store_dwordx4 v[68:71], v5, s[32:35], s62 offen offset:1024 sc1
    v_mfma_f32_32x32x16_bf16 v[176:191], v[120:123], a[36:39], v[176:191]
    ds_read_b128 v[120:123], v6 offset:9216
    v_cvt_pk_bf16_f32 v64, v144, v145
    v_cvt_pk_bf16_f32 v65, v146, v147
    s_waitcnt lgkmcnt(4)
    v_mfma_f32_32x32x16_bf16 v[160:175], v[104:107], a[40:43], v[160:175]
    v_cvt_pk_bf16_f32 v66, v148, v149
    v_cvt_pk_bf16_f32 v67, v150, v151
    v_mfma_f32_32x32x16_bf16 v[176:191], v[104:107], a[44:47], v[176:191]
    ds_read_b128 v[104:107], v6 offset:10240
    s_waitcnt lgkmcnt(4)
    v_mfma_f32_32x32x16_bf16 v[160:175], v[108:111], a[48:51], v[160:175]
    buffer_store_dwordx4 v[64:67], v5, s[32:35], s62 offen offset:2048 sc1
    v_cvt_pk_bf16_f32 v68, v152, v153
    v_mfma_f32_32x32x16_bf16 v[176:191], v[108:111], a[52:55], v[176:191]
    ds_read_b128 v[108:111], v6 offset:11264
    v_cvt_pk_bf16_f32 v69, v154, v155
    v_cvt_pk_bf16_f32 v70, v156, v157
    s_waitcnt lgkmcnt(4)
    v_mfma_f32_32x32x16_bf16 v[160:175], v[112:115], a[56:59], v[160:175]
    v_cvt_pk_bf16_f32 v71, v158, v159
    v_mfma_f32_32x32x16_bf16 v[176:191], v[112:115], a[60:63], v[176:191]
    ds_read_b128 v[112:115], v6 offset:12288
    buffer_store_dwordx4 v[68:71], v5, s[32:35], s62 offen offset:3072 sc1
    s_waitcnt lgkmcnt(4)
    v_mfma_f32_32x32x16_bf16 v[160:175], v[116:119], a[64:67], v[160:175]
    s_min_u32 s65, s61, s64
    s_mul_i32 s66, s65, 40960
    v_mfma_f32_32x32x16_bf16 v[176:191], v[116:119], a[68:71], v[176:191]
    ds_read_b128 v[116:119], v6 offset:13312
    s_add_u32 s66, s66, s69
    s_add_u32 m0, s60, s67
    s_waitcnt lgkmcnt(4)
    v_mfma_f32_32x32x16_bf16 v[160:175], v[120:123], a[72:75], v[160:175]
    v_mfma_f32_32x32x16_bf16 v[176:191], v[120:123], a[76:79], v[176:191]
    ds_read_b128 v[120:123], v6 offset:14336
    buffer_load_dwordx4 v5, s[32:35], s66 offen offset:0 sc1 lds
    s_waitcnt lgkmcnt(4)
    v_mfma_f32_32x32x16_bf16 v[160:175], v[104:107], a[80:83], v[160:175]
    buffer_load_dwordx4 v5, s[32:35], s66 offen offset:1024 sc1 lds
    v_mfma_f32_32x32x16_bf16 v[176:191], v[104:107], a[84:87], v[176:191]
    ds_read_b128 v[104:107], v6 offset:15360
    s_waitcnt lgkmcnt(4)
    v_mfma_f32_32x32x16_bf16 v[160:175], v[108:111], a[88:91], v[160:175]
    buffer_load_dwordx4 v5, s[32:35], s66 offen offset:2048 sc1 lds
    v_mfma_f32_32x32x16_bf16 v[176:191], v[108:111], a[92:95], v[176:191]
    ds_read_b128 v[108:111], v6 offset:16384
    buffer_load_dwordx4 v5, s[32:35], s66 offen offset:3072 sc1 lds
    s_waitcnt lgkmcnt(4)
    v_mfma_f32_32x32x16_bf16 v[160:175], v[112:115], a[96:99], v[160:175]
    s_add_u32 s66, s66, 4096
    s_add_u32 m0, m0, 4096
    v_mfma_f32_32x32x16_bf16 v[176:191], v[112:115], a[100:103], v[176:191]
    ds_read_b128 v[112:115], v6 offset:17408
    s_waitcnt lgkmcnt(4)
    v_mfma_f32_32x32x16_bf16 v[160:175], v[116:119], a[104:107], v[160:175]
    buffer_load_dwordx4 v5, s[32:35], s66 offen offset:0 sc1 lds
    v_mfma_f32_32x32x16_bf16 v[176:191], v[116:119], a[108:111], v[176:191]
    ds_read_b128 v[116:119], v6 offset:18432
    buffer_load_dwordx4 v5, s[32:35], s66 offen offset:1024 sc1 lds
    s_waitcnt lgkmcnt(4)
    v_mfma_f32_32x32x16_bf16 v[160:175], v[120:123], a[112:115], v[160:175]
    v_mfma_f32_32x32x16_bf16 v[176:191], v[120:123], a[116:119], v[176:191]
    ds_read_b128 v[120:123], v6 offset:19456
    buffer_load_dwordx4 v5, s[32:35], s66 offen offset:2048 sc1 lds
    s_waitcnt lgkmcnt(4)
    v_mfma_f32_32x32x16_bf16 v[160:175], v[104:107], a[120:123], v[160:175]
    buffer_load_dwordx4 v5, s[32:35], s66 offen offset:3072 sc1 lds
    v_mfma_f32_32x32x16_bf16 v[176:191], v[104:107], a[124:127], v[176:191]
    ds_read_b128 v[104:107], v6 offset:20480
    s_add_u32 s66, s66, 4096
    s_add_u32 m0, m0, 4096
    s_waitcnt lgkmcnt(4)
    v_mfma_f32_32x32x16_bf16 v[160:175], v[108:111], a[128:131], v[160:175]
    v_mfma_f32_32x32x16_bf16 v[176:191], v[108:111], a[132:135], v[176:191]
    ds_read_b128 v[108:111], v6 offset:21504
    buffer_load_dwordx4 v5, s[32:35], s66 offen offset:0 sc1 lds
    s_waitcnt lgkmcnt(4)
    v_mfma_f32_32x32x16_bf16 v[160:175], v[112:115], a[136:139], v[160:175]
    buffer_load_dwordx4 v5, s[32:35], s66 offen offset:1024 sc1 lds
    v_mfma_f32_32x32x16_bf16 v[176:191], v[112:115], a[140:143], v[176:191]
    ds_read_b128 v[112:115], v6 offset:22528
    s_add_u32 s61, s61, s93
    s_add_u32 s60, s60, 40960
    s_waitcnt lgkmcnt(4)
    v_mfma_f32_32x32x16_bf16 v[160:175], v[116:119], a[144:147], v[160:175]
    s_cmp_eq_u32 s60, 122880
    s_cselect_b32 s60, 0, s60
    v_mfma_f32_32x32x16_bf16 v[176:191], v[116:119], a[148:151], v[176:191]
    ds_read_b128 v[116:119], v6 offset:23552
    s_waitcnt lgkmcnt(4)
    v_mfma_f32_32x32x16_bf16 v[160:175], v[120:123], a[152:155], v[160:175]
    v_mfma_f32_32x32x16_bf16 v[176:191], v[120:123], a[156:159], v[176:191]
    ds_read_b128 v[120:123], v6 offset:24576
    s_waitcnt lgkmcnt(4)
    v_mfma_f32_32x32x16_bf16 v[160:175], v[104:107], a[160:163], v[160:175]
    v_mfma_f32_32x32x16_bf16 v[176:191], v[104:107], a[164:167], v[176:191]
    ds_read_b128 v[104:107], v6 offset:25600
    s_waitcnt lgkmcnt(4)
    v_mfma_f32_32x32x16_bf16 v[160:175], v[108:111], a[168:171], v[160:175]
    v_mfma_f32_32x32x16_bf16 v[176:191], v[108:111], a[172:175], v[176:191]
    ds_read_b128 v[108:111], v6 offset:26624
    s_waitcnt lgkmcnt(4)
    v_mfma_f32_32x32x16_bf16 v[160:175], v[112:115], a[176:179], v[160:175]
    v_mfma_f32_32x32x16_bf16 v[176:191], v[112:115], a[180:183], v[176:191]
    ds_read_b128 v[112:115], v6 offset:27648
    s_waitcnt lgkmcnt(4)
    v_mfma_f32_32x32x16_bf16 v[160:175], v[116:119], a[184:187], v[160:175]
    v_mfma_f32_32x32x16_bf16 v[176:191], v[116:119], a[188:191], v[176:191]
    ds_read_b128 v[116:119], v6 offset:28672
    s_waitcnt lgkmcnt(4)
    v_mfma_f32_32x32x16_bf16 v[160:175], v[120:123], a[192:195], v[160:175]
    v_mfma_f32_32x32x16_bf16 v[176:191], v[120:123], a[196:199], v[176:191]
    ds_read_b128 v[120:123], v6 offset:29696
    s_waitcnt lgkmcnt(4)
    v_mfma_f32_32x32x16_bf16 v[160:175], v[104:107], a[200:203], v[160:175]
    v_mfma_f32_32x32x16_bf16 v[176:191], v[104:107], a[204:207], v[176:191]
    ds_read_b128 v[104:107], v6 offset:30720
    s_waitcnt lgkmcnt(4)
    v_mfma_f32_32x32x16_bf16 v[160:175], v[108:111], a[208:211], v[160:175]
    v_mfma_f32_32x32x16_bf16 v[176:191], v[108:111], a[212:215], v[176:191]
    ds_read_b128 v[108:111], v6 offset:31744
    s_waitcnt lgkmcnt(4)
    v_mfma_f32_32x32x16_bf16 v[160:175], v[112:115], a[216:219], v[160:175]
    v_mfma_f32_32x32x16_bf16 v[176:191], v[112:115], a[220:223], v[176:191]
    ds_read_b128 v[112:115], v6 offset:32768
    s_waitcnt lgkmcnt(4)
    v_mfma_f32_32x32x16_bf16 v[160:175], v[116:119], a[224:227], v[160:175]
    v_mfma_f32_32x32x16_bf16 v[176:191], v[116:119], a[228:231], v[176:191]
    ds_read_b128 v[116:119], v6 offset:33792
    s_waitcnt lgkmcnt(4)
    v_mfma_f32_32x32x16_bf16 v[160:175], v[120:123], a[232:235], v[160:175]
    v_mfma_f32_32x32x16_bf16 v[176:191], v[120:123], a[236:239], v[176:191]
    ds_read_b128 v[120:123], v6 offset:34816
    s_waitcnt lgkmcnt(4)
    v_mfma_f32_32x32x16_bf16 v[160:175], v[104:107], a[240:243], v[160:175]
    v_mfma_f32_32x32x16_bf16 v[176:191], v[104:107], a[244:247], v[176:191]
    ds_read_b128 v[104:107], v6 offset:35840
    s_waitcnt lgkmcnt(4)
    v_mfma_f32_32x32x16_bf16 v[160:175], v[108:111], a[248:251], v[160:175]
    v_mfma_f32_32x32x16_bf16 v[176:191], v[108:111], a[252:255], v[176:191]
    ds_read_b128 v[108:111], v6 offset:36864
    s_waitcnt lgkmcnt(4)
    v_mfma_f32_32x32x16_bf16 v[160:175], v[112:115], v[192:195], v[160:175]
    v_mfma_f32_32x32x16_bf16 v[176:191], v[112:115], v[196:199], v[176:191]
    ds_read_b128 v[112:115], v6 offset:37888
    s_waitcnt lgkmcnt(4)
    v_mfma_f32_32x32x16_bf16 v[160:175], v[116:119], v[200:203], v[160:175]
    v_mfma_f32_32x32x16_bf16 v[176:191], v[116:119], v[204:207], v[176:191]
    ds_read_b128 v[116:119], v6 offset:38912
    s_waitcnt lgkmcnt(4)
    v_mfma_f32_32x32x16_bf16 v[160:175], v[120:123], v[208:211], v[160:175]
    v_mfma_f32_32x32x16_bf16 v[176:191], v[120:123], v[212:215], v[176:191]
    ds_read_b128 v[120:123], v6 offset:39936
    s_waitcnt lgkmcnt(4)
    v_mfma_f32_32x32x16_bf16 v[160:175], v[104:107], v[216:219], v[160:175]
    v_mfma_f32_32x32x16_bf16 v[176:191], v[104:107], v[220:223], v[176:191]
    s_waitcnt lgkmcnt(3)
    v_mfma_f32_32x32x16_bf16 v[160:175], v[108:111], v[224:227], v[160:175]
    v_mfma_f32_32x32x16_bf16 v[176:191], v[108:111], v[228:231], v[176:191]
    s_add_u32 s59, s59, 40960
    s_cmp_eq_u32 s59, 122880
    s_cselect_b32 s59, 0, s59
    v_add_u32 v6, s59, v5
    s_waitcnt vmcnt(10) lgkmcnt(0)
    s_barrier
    ds_read_b128 v[104:107], v6 offset:0
    ds_read_b128 v[108:111], v6 offset:1024
    v_mov_b32 v7, s58
    s_mov_b64 exec, 1
    buffer_store_dword v7, off, s[32:35], s94 sc1
    s_mov_b64 exec, -1
    v_mfma_f32_32x32x16_bf16 v[160:175], v[112:115], v[232:235], v[160:175]
    v_mfma_f32_32x32x16_bf16 v[176:191], v[112:115], v[236:239], v[176:191]
    ds_read_b128 v[112:115], v6 offset:2048
    v_mfma_f32_32x32x16_bf16 v[160:175], v[116:119], v[240:243], v[160:175]
    v_mfma_f32_32x32x16_bf16 v[176:191], v[116:119], v[244:247], v[176:191]
    ds_read_b128 v[116:119], v6 offset:3072
    v_mfma_f32_32x32x16_bf16 v[160:175], v[120:123], v[248:251], v[160:175]
    v_mfma_f32_32x32x16_bf16 v[176:191], v[120:123], v[252:255], v[176:191]
    ds_read_b128 v[120:123], v6 offset:4096
    s_mov_b32 s62, s63
    s_add_u32 s63, s63, s68
    s_add_u32 s58, s58, 1
    s_cmp_ge_u32 s58, s92
    s_cbranch_scc1 Lprojendv_65
    s_branch Lprojv_63
Lprojendv_64:
    s_waitcnt lgkmcnt(0)
    s_nop 7
    v_cvt_pk_bf16_f32 v64, v128, v129
    v_cvt_pk_bf16_f32 v65, v130, v131
    v_cvt_pk_bf16_f32 v66, v132, v133
    v_cvt_pk_bf16_f32 v67, v134, v135
    buffer_store_dwordx4 v[64:67], v5, s[32:35], s62 offen offset:0 sc1
    v_cvt_pk_bf16_f32 v68, v136, v137
    v_cvt_pk_bf16_f32 v69, v138, v139
    v_cvt_pk_bf16_f32 v70, v140, v141
    v_cvt_pk_bf16_f32 v71, v142, v143
    buffer_store_dwordx4 v[68:71], v5, s[32:35], s62 offen offset:1024 sc1
    v_cvt_pk_bf16_f32 v64, v144, v145
    v_cvt_pk_bf16_f32 v65, v146, v147
    v_cvt_pk_bf16_f32 v66, v148, v149
    v_cvt_pk_bf16_f32 v67, v150, v151
    buffer_store_dwordx4 v[64:67], v5, s[32:35], s62 offen offset:2048 sc1
    v_cvt_pk_bf16_f32 v68, v152, v153
    v_cvt_pk_bf16_f32 v69, v154, v155
    v_cvt_pk_bf16_f32 v70, v156, v157
    v_cvt_pk_bf16_f32 v71, v158, v159
    buffer_store_dwordx4 v[68:71], v5, s[32:35], s62 offen offset:3072 sc1
    s_branch Lprojdonev_66
Lprojendv_65:
    s_waitcnt lgkmcnt(0)
    s_nop 7
    v_cvt_pk_bf16_f32 v64, v160, v161
    v_cvt_pk_bf16_f32 v65, v162, v163
    v_cvt_pk_bf16_f32 v66, v164, v165
    v_cvt_pk_bf16_f32 v67, v166, v167
    buffer_store_dwordx4 v[64:67], v5, s[32:35], s62 offen offset:0 sc1
    v_cvt_pk_bf16_f32 v68, v168, v169
    v_cvt_pk_bf16_f32 v69, v170, v171
    v_cvt_pk_bf16_f32 v70, v172, v173
    v_cvt_pk_bf16_f32 v71, v174, v175
    buffer_store_dwordx4 v[68:71], v5, s[32:35], s62 offen offset:1024 sc1
    v_cvt_pk_bf16_f32 v64, v176, v177
    v_cvt_pk_bf16_f32 v65, v178, v179
    v_cvt_pk_bf16_f32 v66, v180, v181
    v_cvt_pk_bf16_f32 v67, v182, v183
    buffer_store_dwordx4 v[64:67], v5, s[32:35], s62 offen offset:2048 sc1
    v_cvt_pk_bf16_f32 v68, v184, v185
    v_cvt_pk_bf16_f32 v69, v186, v187
    v_cvt_pk_bf16_f32 v70, v188, v189
    v_cvt_pk_bf16_f32 v71, v190, v191
    buffer_store_dwordx4 v[68:71], v5, s[32:35], s62 offen offset:3072 sc1
Lprojdonev_66:
    s_branch LpD_30
LpmH_55:
    v_lshlrev_b32 v5, 4, v1
    s_mul_i32 s67, s3, 10240
    s_add_u32 s69, s3, s89
    s_and_b32 s69, s69, 3
    s_mul_i32 s69, s69, 10240
    s_sub_u32 s65, s92, 1
    s_mul_i32 s64, s65, s93
    s_add_u32 s64, s64, s90
    s_barrier
    s_mov_b32 s61, s90
    s_mov_b32 s60, 0
    s_min_u32 s65, s61, s64
    s_mul_i32 s66, s65, 40960
    s_add_u32 s66, s66, s69
    s_add_u32 m0, s60, s67
    s_nop 0
    buffer_load_dwordx4 v5, s[32:35], s66 offen offset:0 sc1 lds
    buffer_load_dwordx4 v5, s[32:35], s66 offen offset:1024 sc1 lds
    buffer_load_dwordx4 v5, s[32:35], s66 offen offset:2048 sc1 lds
    buffer_load_dwordx4 v5, s[32:35], s66 offen offset:3072 sc1 lds
    s_add_u32 s66, s66, 4096
    s_add_u32 m0, m0, 4096
    s_nop 0
    buffer_load_dwordx4 v5, s[32:35], s66 offen offset:0 sc1 lds
    buffer_load_dwordx4 v5, s[32:35], s66 offen offset:1024 sc1 lds
    buffer_load_dwordx4 v5, s[32:35], s66 offen offset:2048 sc1 lds
    buffer_load_dwordx4 v5, s[32:35], s66 offen offset:3072 sc1 lds
    s_add_u32 s66, s66, 4096
    s_add_u32 m0, m0, 4096
    s_nop 0
    buffer_load_dwordx4 v5, s[32:35], s66 offen offset:0 sc1 lds
    buffer_load_dwordx4 v5, s[32:35], s66 offen offset:1024 sc1 lds
    s_add_u32 s61, s61, s93
    s_add_u32 s60, s60, 40960
    s_cmp_eq_u32 s60, 122880
    s_cselect_b32 s60, 0, s60
    s_min_u32 s65, s61, s64
    s_mul_i32 s66, s65, 40960
    s_add_u32 s66, s66, s69
    s_add_u32 m0, s60, s67
    s_nop 0
    buffer_load_dwordx4 v5, s[32:35], s66 offen offset:0 sc1 lds
    buffer_load_dwordx4 v5, s[32:35], s66 offen offset:1024 sc1 lds
    buffer_load_dwordx4 v5, s[32:35], s66 offen offset:2048 sc1 lds
    buffer_load_dwordx4 v5, s[32:35], s66 offen offset:3072 sc1 lds
    s_add_u32 s66, s66, 4096
    s_add_u32 m0, m0, 4096
    s_nop 0
    buffer_load_dwordx4 v5, s[32:35], s66 offen offset:0 sc1 lds
    buffer_load_dwordx4 v5, s[32:35], s66 offen offset:1024 sc1 lds
    buffer_load_dwordx4 v5, s[32:35], s66 offen offset:2048 sc1 lds
    buffer_load_dwordx4 v5, s[32:35], s66 offen offset:3072 sc1 lds
    s_add_u32 s66, s66, 4096
    s_add_u32 m0, m0, 4096
    s_nop 0
    buffer_load_dwordx4 v5, s[32:35], s66 offen offset:0 sc1 lds
    buffer_load_dwordx4 v5, s[32:35], s66 offen offset:1024 sc1 lds
    s_add_u32 s61, s61, s93
    s_add_u32 s60, s60, 40960
    s_cmp_eq_u32 s60, 122880
    s_cselect_b32 s60, 0, s60
    s_mov_b32 s58, 0
    s_mov_b32 s59, 0
    s_mov_b32 s62, 0x10000000
    s_mul_i32 s63, s90, s56
    s_add_u32 s63, s63, s55
    s_mul_i32 s68, s93, s56
    v_mov_b32 v6, v5
    s_waitcnt vmcnt(10)
    s_barrier
    ds_read_b128 v[104:107], v6 offset:0
    ds_read_b128 v[108:111], v6 offset:1024
    ds_read_b128 v[112:115], v6 offset:2048
    ds_read_b128 v[116:119], v6 offset:3072
    ds_read_b128 v[120:123], v6 offset:4096
Lprojh_70:
    s_waitcnt lgkmcnt(4)
    v_mfma_f32_32x32x16_bf16 v[128:143], a[0:3], v[104:107], v[32:47]
    v_mfma_f32_32x32x16_bf16 v[144:159], a[4:7], v[104:107], v[48:63]
    ds_read_b128 v[104:107], v6 offset:5120
    s_waitcnt lgkmcnt(4)
    v_mfma_f32_32x32x16_bf16 v[128:143], a[8:11], v[108:111], v[128:143]
    s_min_u32 s65, s61, s64
    s_mul_i32 s66, s65, 40960
    s_add_u32 s66, s66, s69
    s_add_u32 m0, s60, s67
    v_mfma_f32_32x32x16_bf16 v[144:159], a[12:15], v[108:111], v[144:159]
    ds_read_b128 v[108:111], v6 offset:6144
    buffer_load_dwordx4 v5, s[32:35], s66 offen offset:0 sc1 lds
    buffer_load_dwordx4 v5, s[32:35], s66 offen offset:1024 sc1 lds
    s_waitcnt lgkmcnt(4)
    v_mfma_f32_32x32x16_bf16 v[128:143], a[16:19], v[112:115], v[128:143]
    buffer_load_dwordx4 v5, s[32:35], s66 offen offset:2048 sc1 lds
    buffer_load_dwordx4 v5, s[32:35], s66 offen offset:3072 sc1 lds
    s_add_u32 s66, s66, 4096
    s_add_u32 m0, m0, 4096
    v_mfma_f32_32x32x16_bf16 v[144:159], a[20:23], v[112:115], v[144:159]
    ds_read_b128 v[112:115], v6 offset:7168
    buffer_load_dwordx4 v5, s[32:35], s66 offen offset:0 sc1 lds
    buffer_load_dwordx4 v5, s[32:35], s66 offen offset:1024 sc1 lds
    s_waitcnt lgkmcnt(4)
    v_mfma_f32_32x32x16_bf16 v[128:143], a[24:27], v[116:119], v[128:143]
    buffer_load_dwordx4 v5, s[32:35], s66 offen offset:2048 sc1 lds
    buffer_load_dwordx4 v5, s[32:35], s66 offen offset:3072 sc1 lds
    v_mfma_f32_32x32x16_bf16 v[144:159], a[28:31], v[116:119], v[144:159]
    ds_read_b128 v[116:119], v6 offset:8192
    s_add_u32 s66, s66, 4096
    s_add_u32 m0, m0, 4096
    s_nop 0
    buffer_load_dwordx4 v5, s[32:35], s66 offen offset:0 sc1 lds
    s_waitcnt lgkmcnt(4)
    v_mfma_f32_32x32x16_bf16 v[128:143], a[32:35], v[120:123], v[128:143]
    buffer_load_dwordx4 v5, s[32:35], s66 offen offset:1024 sc1 lds
    s_add_u32 s61, s61, s93
    s_add_u32 s60, s60, 40960
    s_cmp_eq_u32 s60, 122880
    s_cselect_b32 s60, 0, s60
    v_mfma_f32_32x32x16_bf16 v[144:159], a[36:39], v[120:123], v[144:159]
    ds_read_b128 v[120:123], v6 offset:9216
    v_mul_f32 v72, 1.4426950408889634, v160
    v_mul_f32 v73, 1.4426950408889634, v161
    v_mul_f32 v74, 1.4426950408889634, v162
    v_mul_f32 v75, 1.4426950408889634, v163
    v_mul_f32 v76, 1.4426950408889634, v164
    v_mul_f32 v77, 1.4426950408889634, v165
    s_waitcnt lgkmcnt(4)
    v_mfma_f32_32x32x16_bf16 v[128:143], a[40:43], v[104:107], v[128:143]
    v_mul_f32 v78, 1.4426950408889634, v166
    v_mul_f32 v79, 1.4426950408889634, v167
    v_min_f32 v72, 0x41f00000, v72
    v_min_f32 v73, 0x41f00000, v73
    v_min_f32 v74, 0x41f00000, v74
    v_min_f32 v75, 0x41f00000, v75
    v_mfma_f32_32x32x16_bf16 v[144:159], a[44:47], v[104:107], v[144:159]
    ds_read_b128 v[104:107], v6 offset:10240
    v_min_f32 v76, 0x41f00000, v76
    v_min_f32 v77, 0x41f00000, v77
    v_min_f32 v78, 0x41f00000, v78
    v_min_f32 v79, 0x41f00000, v79
    v_exp_f32 v72, v72
    s_waitcnt lgkmcnt(4)
    v_mfma_f32_32x32x16_bf16 v[128:143], a[48:51], v[108:111], v[128:143]
    v_exp_f32 v73, v73
    v_exp_f32 v74, v74
    v_exp_f32 v75, v75
    v_mfma_f32_32x32x16_bf16 v[144:159], a[52:55], v[108:111], v[144:159]
    ds_read_b128 v[108:111], v6 offset:11264
    v_exp_f32 v76, v76
    v_exp_f32 v77, v77
    v_exp_f32 v78, v78
    s_waitcnt lgkmcnt(4)
    v_mfma_f32_32x32x16_bf16 v[128:143], a[56:59], v[112:115], v[128:143]
    v_exp_f32 v79, v79
    v_add_f32 v80, 2.0, v72
    v_add_f32 v81, 2.0, v73
    v_add_f32 v82, 2.0, v74
    v_add_f32 v83, 2.0, v75
    v_mfma_f32_32x32x16_bf16 v[144:159], a[60:63], v[112:115], v[144:159]
    ds_read_b128 v[112:115], v6 offset:12288
    v_add_f32 v84, 2.0, v76
    v_add_f32 v85, 2.0, v77
    v_add_f32 v86, 2.0, v78
    v_add_f32 v87, 2.0, v79
    v_mul_f32 v80, v80, v72
    v_mul_f32 v81, v81, v73
    s_waitcnt lgkmcnt(4)
    v_mfma_f32_32x32x16_bf16 v[128:143], a[64:67], v[116:119], v[128:143]
    v_mul_f32 v82, v82, v74
    v_mul_f32 v83, v83, v75
    v_mul_f32 v84, v84, v76
    v_mul_f32 v85, v85, v77
    v_mul_f32 v86, v86, v78
    v_mul_f32 v87, v87, v79
    v_mfma_f32_32x32x16_bf16 v[144:159], a[68:71], v[116:119], v[144:159]
    ds_read_b128 v[116:119], v6 offset:13312
    v_add_f32 v72, 2.0, v80
    v_add_f32 v73, 2.0, v81
    v_add_f32 v74, 2.0, v82
    v_add_f32 v75, 2.0, v83
    v_add_f32 v76, 2.0, v84
    v_add_f32 v77, 2.0, v85
    s_waitcnt lgkmcnt(4)
    v_mfma_f32_32x32x16_bf16 v[128:143], a[72:75], v[120:123], v[128:143]
    v_add_f32 v78, 2.0, v86
    v_add_f32 v79, 2.0, v87
    v_rcp_f32 v72, v72
    v_rcp_f32 v73, v73
    v_mfma_f32_32x32x16_bf16 v[144:159], a[76:79], v[120:123], v[144:159]
    ds_read_b128 v[120:123], v6 offset:14336
    v_rcp_f32 v74, v74
    v_rcp_f32 v75, v75
    v_rcp_f32 v76, v76
    s_waitcnt lgkmcnt(4)
    v_mfma_f32_32x32x16_bf16 v[128:143], a[80:83], v[104:107], v[128:143]
    v_rcp_f32 v77, v77
    v_rcp_f32 v78, v78
    v_rcp_f32 v79, v79
    v_mfma_f32_32x32x16_bf16 v[144:159], a[84:87], v[104:107], v[144:159]
    ds_read_b128 v[104:107], v6 offset:15360
    v_mul_f32 v80, v80, v160
    v_mul_f32 v81, v81, v161
    v_mul_f32 v82, v82, v162
    v_mul_f32 v83, v83, v163
    v_mul_f32 v84, v84, v164
    v_mul_f32 v85, v85, v165
    s_waitcnt lgkmcnt(4)
    v_mfma_f32_32x32x16_bf16 v[128:143], a[88:91], v[108:111], v[128:143]
    v_mul_f32 v86, v86, v166
    v_mul_f32 v87, v87, v167
    v_mul_f32 v80, v80, v72
    v_mul_f32 v81, v81, v73
    v_mul_f32 v82, v82, v74
    v_mul_f32 v83, v83, v75
    v_mfma_f32_32x32x16_bf16 v[144:159], a[92:95], v[108:111], v[144:159]
    ds_read_b128 v[108:111], v6 offset:16384
    v_mul_f32 v84, v84, v76
    v_mul_f32 v85, v85, v77
    v_mul_f32 v86, v86, v78
    v_mul_f32 v87, v87, v79
    v_cvt_pk_bf16_f32 v64, v80, v81
    v_cvt_pk_bf16_f32 v65, v82, v83
    s_waitcnt lgkmcnt(4)
    v_mfma_f32_32x32x16_bf16 v[128:143], a[96:99], v[112:115], v[128:143]
    v_cvt_pk_bf16_f32 v66, v84, v85
    v_cvt_pk_bf16_f32 v67, v86, v87
    buffer_store_dwordx4 v[64:67], v5, s[32:35], s62 offen offset:0 sc1
    v_mul_f32 v88, 1.4426950408889634, v168
    v_mfma_f32_32x32x16_bf16 v[144:159], a[100:103], v[112:115], v[144:159]
    ds_read_b128 v[112:115], v6 offset:17408
    v_mul_f32 v89, 1.4426950408889634, v169
    v_mul_f32 v90, 1.4426950408889634, v170
    v_mul_f32 v91, 1.4426950408889634, v171
    v_mul_f32 v92, 1.4426950408889634, v172
    v_mul_f32 v93, 1.4426950408889634, v173
    v_mul_f32 v94, 1.4426950408889634, v174
    s_waitcnt lgkmcnt(4)
    v_mfma_f32_32x32x16_bf16 v[128:143], a[104:107], v[116:119], v[128:143]
    v_mul_f32 v95, 1.4426950408889634, v175
    v_min_f32 v88, 0x41f00000, v88
    v_min_f32 v89, 0x41f00000, v89
    v_min_f32 v90, 0x41f00000, v90
    v_min_f32 v91, 0x41f00000, v91
    v_min_f32 v92, 0x41f00000, v92
    v_mfma_f32_32x32x16_bf16 v[144:159], a[108:111], v[116:119], v[144:159]
    ds_read_b128 v[116:119], v6 offset:18432
    v_min_f32 v93, 0x41f00000, v93
    v_min_f32 v94, 0x41f00000, v94
    v_min_f32 v95, 0x41f00000, v95
    v_exp_f32 v88, v88
    s_waitcnt lgkmcnt(4)
    v_mfma_f32_32x32x16_bf16 v[128:143], a[112:115], v[120:123], v[128:143]
    v_exp_f32 v89, v89
    v_exp_f32 v90, v90
    v_exp_f32 v91, v91
    v_mfma_f32_32x32x16_bf16 v[144:159], a[116:119], v[120:123], v[144:159]
    ds_read_b128 v[120:123], v6 offset:19456
    v_exp_f32 v92, v92
    v_exp_f32 v93, v93
    v_exp_f32 v94, v94
    s_waitcnt lgkmcnt(4)
    v_mfma_f32_32x32x16_bf16 v[128:143], a[120:123], v[104:107], v[128:143]
    v_exp_f32 v95, v95
    v_add_f32 v96, 2.0, v88
    v_add_f32 v97, 2.0, v89
    v_add_f32 v98, 2.0, v90
    v_add_f32 v99, 2.0, v91
    v_add_f32 v100, 2.0, v92
    v_mfma_f32_32x32x16_bf16 v[144:159], a[124:127], v[104:107], v[144:159]
    ds_read_b128 v[104:107], v6 offset:20480
    v_add_f32 v101, 2.0, v93
    v_add_f32 v102, 2.0, v94
    v_add_f32 v103, 2.0, v95
    v_mul_f32 v96, v96, v88
    v_mul_f32 v97, v97, v89
    v_mul_f32 v98, v98, v90
    s_waitcnt lgkmcnt(4)
    v_mfma_f32_32x32x16_bf16 v[128:143], a[128:131], v[108:111], v[128:143]
    v_mul_f32 v99, v99, v91
    v_mul_f32 v100, v100, v92
    v_mul_f32 v101, v101, v93
    v_mul_f32 v102, v102, v94
    v_mul_f32 v103, v103, v95
    v_add_f32 v88, 2.0, v96
    v_mfma_f32_32x32x16_bf16 v[144:159], a[132:135], v[108:111], v[144:159]
    ds_read_b128 v[108:111], v6 offset:21504
    v_add_f32 v89, 2.0, v97
    v_add_f32 v90, 2.0, v98
    v_add_f32 v91, 2.0, v99
    v_add_f32 v92, 2.0, v100
    v_add_f32 v93, 2.0, v101
    v_add_f32 v94, 2.0, v102
    s_waitcnt lgkmcnt(4)
    v_mfma_f32_32x32x16_bf16 v[128:143], a[136:139], v[112:115], v[128:143]
    v_add_f32 v95, 2.0, v103
    v_rcp_f32 v88, v88
    v_rcp_f32 v89, v89
    v_mfma_f32_32x32x16_bf16 v[144:159], a[140:143], v[112:115], v[144:159]
    ds_read_b128 v[112:115], v6 offset:22528
    v_rcp_f32 v90, v90
    v_rcp_f32 v91, v91
    v_rcp_f32 v92, v92
    s_waitcnt lgkmcnt(4)
    v_mfma_f32_32x32x16_bf16 v[128:143], a[144:147], v[116:119], v[128:143]
    v_rcp_f32 v93, v93
    v_rcp_f32 v94, v94
    v_rcp_f32 v95, v95
    v_mul_f32 v96, v96, v168
    v_mul_f32 v97, v97, v169
    v_mfma_f32_32x32x16_bf16 v[144:159], a[148:151], v[116:119], v[144:159]
    ds_read_b128 v[116:119], v6 offset:23552
    v_mul_f32 v98, v98, v170
    v_mul_f32 v99, v99, v171
    v_mul_f32 v100, v100, v172
    v_mul_f32 v101, v101, v173
    v_mul_f32 v102, v102, v174
    v_mul_f32 v103, v103, v175
    s_waitcnt lgkmcnt(4)
    v_mfma_f32_32x32x16_bf16 v[128:143], a[152:155], v[120:123], v[128:143]
    v_mul_f32 v96, v96, v88
    v_mul_f32 v97, v97, v89
    v_mul_f32 v98, v98, v90
    v_mul_f32 v99, v99, v91
    v_mul_f32 v100, v100, v92
    v_mul_f32 v101, v101, v93
    v_mfma_f32_32x32x16_bf16 v[144:159], a[156:159], v[120:123], v[144:159]
    ds_read_b128 v[120:123], v6 offset:24576
    v_mul_f32 v102, v102, v94
    v_mul_f32 v103, v103, v95
    v_cvt_pk_bf16_f32 v68, v96, v97
    v_cvt_pk_bf16_f32 v69, v98, v99
    v_cvt_pk_bf16_f32 v70, v100, v101
    v_cvt_pk_bf16_f32 v71, v102, v103
    s_waitcnt lgkmcnt(4)
    v_mfma_f32_32x32x16_bf16 v[128:143], a[160:163], v[104:107], v[128:143]
    buffer_store_dwordx4 v[68:71], v5, s[32:35], s62 offen offset:1024 sc1
    v_mul_f32 v72, 1.4426950408889634, v176
    v_mul_f32 v73, 1.4426950408889634, v177
    v_mul_f32 v74, 1.4426950408889634, v178
    v_mfma_f32_32x32x16_bf16 v[144:159], a[164:167], v[104:107], v[144:159]
    ds_read_b128 v[104:107], v6 offset:25600
    v_mul_f32 v75, 1.4426950408889634, v179
    v_mul_f32 v76, 1.4426950408889634, v180
    v_mul_f32 v77, 1.4426950408889634, v181
    v_mul_f32 v78, 1.4426950408889634, v182
    v_mul_f32 v79, 1.4426950408889634, v183
    v_min_f32 v72, 0x41f00000, v72
    s_waitcnt lgkmcnt(4)
    v_mfma_f32_32x32x16_bf16 v[128:143], a[168:171], v[108:111], v[128:143]
    v_min_f32 v73, 0x41f00000, v73
    v_min_f32 v74, 0x41f00000, v74
    v_min_f32 v75, 0x41f00000, v75
    v_min_f32 v76, 0x41f00000, v76
    v_min_f32 v77, 0x41f00000, v77
    v_min_f32 v78, 0x41f00000, v78
    v_mfma_f32_32x32x16_bf16 v[144:159], a[172:175], v[108:111], v[144:159]
    ds_read_b128 v[108:111], v6 offset:26624
    v_min_f32 v79, 0x41f00000, v79
    v_exp_f32 v72, v72
    v_exp_f32 v73, v73
    s_waitcnt lgkmcnt(4)
    v_mfma_f32_32x32x16_bf16 v[128:143], a[176:179], v[112:115], v[128:143]
    v_exp_f32 v74, v74
    v_exp_f32 v75, v75
    v_exp_f32 v76, v76
    v_mfma_f32_32x32x16_bf16 v[144:159], a[180:183], v[112:115], v[144:159]
    ds_read_b128 v[112:115], v6 offset:27648
    v_exp_f32 v77, v77
    v_exp_f32 v78, v78
    v_exp_f32 v79, v79
    v_add_f32 v80, 2.0, v72
    s_waitcnt lgkmcnt(4)
    v_mfma_f32_32x32x16_bf16 v[128:143], a[184:187], v[116:119], v[128:143]
    v_add_f32 v81, 2.0, v73
    v_add_f32 v82, 2.0, v74
    v_add_f32 v83, 2.0, v75
    v_add_f32 v84, 2.0, v76
    v_add_f32 v85, 2.0, v77
    v_add_f32 v86, 2.0, v78
    v_mfma_f32_32x32x16_bf16 v[144:159], a[188:191], v[116:119], v[144:159]
    ds_read_b128 v[116:119], v6 offset:28672
    v_add_f32 v87, 2.0, v79
    v_mul_f32 v80, v80, v72
    v_mul_f32 v81, v81, v73
    v_mul_f32 v82, v82, v74
    v_mul_f32 v83, v83, v75
    v_mul_f32 v84, v84, v76
    s_waitcnt lgkmcnt(4)
    v_mfma_f32_32x32x16_bf16 v[128:143], a[192:195], v[120:123], v[128:143]
    v_mul_f32 v85, v85, v77
    v_mul_f32 v86, v86, v78
    v_mul_f32 v87, v87, v79
    v_add_f32 v72, 2.0, v80
    v_add_f32 v73, 2.0, v81
    v_add_f32 v74, 2.0, v82
    v_mfma_f32_32x32x16_bf16 v[144:159], a[196:199], v[120:123], v[144:159]
    ds_read_b128 v[120:123], v6 offset:29696
    v_add_f32 v75, 2.0, v83
    v_add_f32 v76, 2.0, v84
    v_add_f32 v77, 2.0, v85
    v_add_f32 v78, 2.0, v86
    v_add_f32 v79, 2.0, v87
    s_waitcnt lgkmcnt(4)
    v_mfma_f32_32x32x16_bf16 v[128:143], a[200:203], v[104:107], v[128:143]
    v_rcp_f32 v72, v72
    v_rcp_f32 v73, v73
    v_rcp_f32 v74, v74
    v_mfma_f32_32x32x16_bf16 v[144:159], a[204:207], v[104:107], v[144:159]
    ds_read_b128 v[104:107], v6 offset:30720
    v_rcp_f32 v75, v75
    v_rcp_f32 v76, v76
    v_rcp_f32 v77, v77
    s_waitcnt lgkmcnt(4)
    v_mfma_f32_32x32x16_bf16 v[128:143], a[208:211], v[108:111], v[128:143]
    v_rcp_f32 v78, v78
    v_rcp_f32 v79, v79
    v_mul_f32 v80, v80, v176
    v_mul_f32 v81, v81, v177
    v_mul_f32 v82, v82, v178
    v_mfma_f32_32x32x16_bf16 v[144:159], a[212:215], v[108:111], v[144:159]
    ds_read_b128 v[108:111], v6 offset:31744
    v_mul_f32 v83, v83, v179
    v_mul_f32 v84, v84, v180
    v_mul_f32 v85, v85, v181
    v_mul_f32 v86, v86, v182
    v_mul_f32 v87, v87, v183
    v_mul_f32 v80, v80, v72
    s_waitcnt lgkmcnt(4)
    v_mfma_f32_32x32x16_bf16 v[128:143], a[216:219], v[112:115], v[128:143]
    v_mul_f32 v81, v81, v73
    v_mul_f32 v82, v82, v74
    v_mul_f32 v83, v83, v75
    v_mul_f32 v84, v84, v76
    v_mul_f32 v85, v85, v77
    v_mul_f32 v86, v86, v78
    v_mfma_f32_32x32x16_bf16 v[144:159], a[220:223], v[112:115], v[144:159]
    ds_read_b128 v[112:115], v6 offset:32768
    v_mul_f32 v87, v87, v79
    v_cvt_pk_bf16_f32 v64, v80, v81
    v_cvt_pk_bf16_f32 v65, v82, v83
    v_cvt_pk_bf16_f32 v66, v84, v85
    v_cvt_pk_bf16_f32 v67, v86, v87
    s_waitcnt lgkmcnt(4)
    v_mfma_f32_32x32x16_bf16 v[128:143], a[224:227], v[116:119], v[128:143]
    buffer_store_dwordx4 v[64:67], v5, s[32:35], s62 offen offset:2048 sc1
    v_mul_f32 v88, 1.4426950408889634, v184
    v_mul_f32 v89, 1.4426950408889634, v185
    v_mul_f32 v90, 1.4426950408889634, v186
    v_mul_f32 v91, 1.4426950408889634, v187
    v_mfma_f32_32x32x16_bf16 v[144:159], a[228:231], v[116:119], v[144:159]
    ds_read_b128 v[116:119], v6 offset:33792
    v_mul_f32 v92, 1.4426950408889634, v188
    v_mul_f32 v93, 1.4426950408889634, v189
    v_mul_f32 v94, 1.4426950408889634, v190
    v_mul_f32 v95, 1.4426950408889634, v191
    v_min_f32 v88, 0x41f00000, v88
    v_min_f32 v89, 0x41f00000, v89
    s_waitcnt lgkmcnt(4)
    v_mfma_f32_32x32x16_bf16 v[128:143], a[232:235], v[120:123], v[128:143]
    v_min_f32 v90, 0x41f00000, v90
    v_min_f32 v91, 0x41f00000, v91
    v_min_f32 v92, 0x41f00000, v92
    v_min_f32 v93, 0x41f00000, v93
    v_min_f32 v94, 0x41f00000, v94
    v_min_f32 v95, 0x41f00000, v95
    v_mfma_f32_32x32x16_bf16 v[144:159], a[236:239], v[120:123], v[144:159]
    ds_read_b128 v[120:123], v6 offset:34816
    v_exp_f32 v88, v88
    v_exp_f32 v89, v89
    v_exp_f32 v90, v90
    s_waitcnt lgkmcnt(4)
    v_mfma_f32_32x32x16_bf16 v[128:143], a[240:243], v[104:107], v[128:143]
    v_exp_f32 v91, v91
    v_exp_f32 v92, v92
    v_exp_f32 v93, v93
    v_mfma_f32_32x32x16_bf16 v[144:159], a[244:247], v[104:107], v[144:159]
    ds_read_b128 v[104:107], v6 offset:35840
    v_exp_f32 v94, v94
    v_exp_f32 v95, v95
    v_add_f32 v96, 2.0, v88
    v_add_f32 v97, 2.0, v89
    s_waitcnt lgkmcnt(4)
    v_mfma_f32_32x32x16_bf16 v[128:143], a[248:251], v[108:111], v[128:143]
    v_add_f32 v98, 2.0, v90
    v_add_f32 v99, 2.0, v91
    v_add_f32 v100, 2.0, v92
    v_add_f32 v101, 2.0, v93
    v_add_f32 v102, 2.0, v94
    v_add_f32 v103, 2.0, v95
    v_mfma_f32_32x32x16_bf16 v[144:159], a[252:255], v[108:111], v[144:159]
    ds_read_b128 v[108:111], v6 offset:36864
    v_mul_f32 v96, v96, v88
    v_mul_f32 v97, v97, v89
    v_mul_f32 v98, v98, v90
    v_mul_f32 v99, v99, v91
    v_mul_f32 v100, v100, v92
    v_mul_f32 v101, v101, v93
    s_waitcnt lgkmcnt(4)
    v_mfma_f32_32x32x16_bf16 v[128:143], v[192:195], v[112:115], v[128:143]
    v_mul_f32 v102, v102, v94
    v_mul_f32 v103, v103, v95
    v_add_f32 v88, 2.0, v96
    v_add_f32 v89, 2.0, v97
    v_add_f32 v90, 2.0, v98
    v_add_f32 v91, 2.0, v99
    v_mfma_f32_32x32x16_bf16 v[144:159], v[196:199], v[112:115], v[144:159]
    ds_read_b128 v[112:115], v6 offset:37888
    v_add_f32 v92, 2.0, v100
    v_add_f32 v93, 2.0, v101
    v_add_f32 v94, 2.0, v102
    v_add_f32 v95, 2.0, v103
    v_rcp_f32 v88, v88
    s_waitcnt lgkmcnt(4)
    v_mfma_f32_32x32x16_bf16 v[128:143], v[200:203], v[116:119], v[128:143]
    v_rcp_f32 v89, v89
    v_rcp_f32 v90, v90
    v_rcp_f32 v91, v91
    v_mfma_f32_32x32x16_bf16 v[144:159], v[204:207], v[116:119], v[144:159]
    ds_read_b128 v[116:119], v6 offset:38912
    v_rcp_f32 v92, v92
    v_rcp_f32 v93, v93
    v_rcp_f32 v94, v94
    s_waitcnt lgkmcnt(4)
    v_mfma_f32_32x32x16_bf16 v[128:143], v[208:211], v[120:123], v[128:143]
    v_rcp_f32 v95, v95
    v_mul_f32 v96, v96, v184
    v_mul_f32 v97, v97, v185
    v_mul_f32 v98, v98, v186
    v_mul_f32 v99, v99, v187
    v_mfma_f32_32x32x16_bf16 v[144:159], v[212:215], v[120:123], v[144:159]
    ds_read_b128 v[120:123], v6 offset:39936
    v_mul_f32 v100, v100, v188
    v_mul_f32 v101, v101, v189
    v_mul_f32 v102, v102, v190
    v_mul_f32 v103, v103, v191
    v_mul_f32 v96, v96, v88
    v_mul_f32 v97, v97, v89
    s_waitcnt lgkmcnt(4)
    v_mfma_f32_32x32x16_bf16 v[128:143], v[216:219], v[104:107], v[128:143]
    v_mul_f32 v98, v98, v90
    v_mul_f32 v99, v99, v91
    v_mul_f32 v100, v100, v92
    v_mul_f32 v101, v101, v93
    v_mul_f32 v102, v102, v94
    v_mul_f32 v103, v103, v95
    v_mfma_f32_32x32x16_bf16 v[144:159], v[220:223], v[104:107], v[144:159]
    v_cvt_pk_bf16_f32 v68, v96, v97
    v_cvt_pk_bf16_f32 v69, v98, v99
    v_cvt_pk_bf16_f32 v70, v100, v101
    v_cvt_pk_bf16_f32 v71, v102, v103
    buffer_store_dwordx4 v[68:71], v5, s[32:35], s62 offen offset:3072 sc1
    s_waitcnt lgkmcnt(3)
    v_mfma_f32_32x32x16_bf16 v[128:143], v[224:227], v[108:111], v[128:143]
    v_mfma_f32_32x32x16_bf16 v[144:159], v[228:231], v[108:111], v[144:159]
    s_add_u32 s59, s59, 40960
    s_cmp_eq_u32 s59, 122880
    s_cselect_b32 s59, 0, s59
    v_add_u32 v6, s59, v5
    s_waitcnt vmcnt(14) lgkmcnt(0)
    s_cmp_lg_u32 s58, 6
    s_cbranch_scc1 Lnb_74
    s_cmp_lg_u32 s3, 0
    s_cbranch_scc1 Lwklb_76
Lwlb_75:
    s_sub_u32 s100, s100, 1
    s_cselect_b32 s100, 0, s100
    s_cbranch_scc1 Lwklb_76
    buffer_load_dword v7, off, s[44:47], 0 offset:32 sc1
    s_waitcnt vmcnt(0)
    v_readfirstlane_b32 s95, v7
    s_nop 0
    s_bfe_u32 s95, s95, 0x80008
    s_cmp_ge_u32 s95, 27
    s_cbranch_scc1 Lwklb_76
    s_sleep 4
    s_branch Lwlb_75
Lwklb_76:
    s_waitcnt vmcnt(0)
Lnb_74:
    s_barrier
    ds_read_b128 v[104:107], v6 offset:0
    ds_read_b128 v[108:111], v6 offset:1024
    v_mfma_f32_32x32x16_bf16 v[128:143], v[232:235], v[112:115], v[128:143]
    v_mfma_f32_32x32x16_bf16 v[144:159], v[236:239], v[112:115], v[144:159]
    ds_read_b128 v[112:115], v6 offset:2048
    v_mfma_f32_32x32x16_bf16 v[128:143], v[240:243], v[116:119], v[128:143]
    v_mfma_f32_32x32x16_bf16 v[144:159], v[244:247], v[116:119], v[144:159]
    ds_read_b128 v[116:119], v6 offset:3072
    v_mfma_f32_32x32x16_bf16 v[128:143], v[248:251], v[120:123], v[128:143]
    v_mfma_f32_32x32x16_bf16 v[144:159], v[252:255], v[120:123], v[144:159]
    ds_read_b128 v[120:123], v6 offset:4096
    s_mov_b32 s62, s63
    s_add_u32 s63, s63, s68
    s_add_u32 s58, s58, 1
    s_cmp_ge_u32 s58, s92
    s_cbranch_scc1 Lprojendh_71
    s_waitcnt lgkmcnt(4)
    v_mfma_f32_32x32x16_bf16 v[160:175], a[0:3], v[104:107], v[32:47]
    v_mfma_f32_32x32x16_bf16 v[176:191], a[4:7], v[104:107], v[48:63]
    ds_read_b128 v[104:107], v6 offset:5120
    s_waitcnt lgkmcnt(4)
    v_mfma_f32_32x32x16_bf16 v[160:175], a[8:11], v[108:111], v[160:175]
    s_min_u32 s65, s61, s64
    s_mul_i32 s66, s65, 40960
    s_add_u32 s66, s66, s69
    s_add_u32 m0, s60, s67
    v_mfma_f32_32x32x16_bf16 v[176:191], a[12:15], v[108:111], v[176:191]
    ds_read_b128 v[108:111], v6 offset:6144
    buffer_load_dwordx4 v5, s[32:35], s66 offen offset:0 sc1 lds
    buffer_load_dwordx4 v5, s[32:35], s66 offen offset:1024 sc1 lds
    s_waitcnt lgkmcnt(4)
    v_mfma_f32_32x32x16_bf16 v[160:175], a[16:19], v[112:115], v[160:175]
    buffer_load_dwordx4 v5, s[32:35], s66 offen offset:2048 sc1 lds
    buffer_load_dwordx4 v5, s[32:35], s66 offen offset:3072 sc1 lds
    s_add_u32 s66, s66, 4096
    s_add_u32 m0, m0, 4096
    v_mfma_f32_32x32x16_bf16 v[176:191], a[20:23], v[112:115], v[176:191]
    ds_read_b128 v[112:115], v6 offset:7168
    buffer_load_dwordx4 v5, s[32:35], s66 offen offset:0 sc1 lds
    buffer_load_dwordx4 v5, s[32:35], s66 offen offset:1024 sc1 lds
    s_waitcnt lgkmcnt(4)
    v_mfma_f32_32x32x16_bf16 v[160:175], a[24:27], v[116:119], v[160:175]
    buffer_load_dwordx4 v5, s[32:35], s66 offen offset:2048 sc1 lds
    buffer_load_dwordx4 v5, s[32:35], s66 offen offset:3072 sc1 lds
    v_mfma_f32_32x32x16_bf16 v[176:191], a[28:31], v[116:119], v[176:191]
    ds_read_b128 v[116:119], v6 offset:8192
    s_add_u32 s66, s66, 4096
    s_add_u32 m0, m0, 4096
    s_nop 0
    buffer_load_dwordx4 v5, s[32:35], s66 offen offset:0 sc1 lds
    s_waitcnt lgkmcnt(4)
    v_mfma_f32_32x32x16_bf16 v[160:175], a[32:35], v[120:123], v[160:175]
    buffer_load_dwordx4 v5, s[32:35], s66 offen offset:1024 sc1 lds
    s_add_u32 s61, s61, s93
    s_add_u32 s60, s60, 40960
    s_cmp_eq_u32 s60, 122880
    s_cselect_b32 s60, 0, s60
    v_mfma_f32_32x32x16_bf16 v[176:191], a[36:39], v[120:123], v[176:191]
    ds_read_b128 v[120:123], v6 offset:9216
    v_mul_f32 v72, 1.4426950408889634, v128
    v_mul_f32 v73, 1.4426950408889634, v129
    v_mul_f32 v74, 1.4426950408889634, v130
    v_mul_f32 v75, 1.4426950408889634, v131
    v_mul_f32 v76, 1.4426950408889634, v132
    v_mul_f32 v77, 1.4426950408889634, v133
    s_waitcnt lgkmcnt(4)
    v_mfma_f32_32x32x16_bf16 v[160:175], a[40:43], v[104:107], v[160:175]
    v_mul_f32 v78, 1.4426950408889634, v134
    v_mul_f32 v79, 1.4426950408889634, v135
    v_min_f32 v72, 0x41f00000, v72
    v_min_f32 v73, 0x41f00000, v73
    v_min_f32 v74, 0x41f00000, v74
    v_min_f32 v75, 0x41f00000, v75
    v_mfma_f32_32x32x16_bf16 v[176:191], a[44:47], v[104:107], v[176:191]
    ds_read_b128 v[104:107], v6 offset:10240
    v_min_f32 v76, 0x41f00000, v76
    v_min_f32 v77, 0x41f00000, v77
    v_min_f32 v78, 0x41f00000, v78
    v_min_f32 v79, 0x41f00000, v79
    v_exp_f32 v72, v72
    s_waitcnt lgkmcnt(4)
    v_mfma_f32_32x32x16_bf16 v[160:175], a[48:51], v[108:111], v[160:175]
    v_exp_f32 v73, v73
    v_exp_f32 v74, v74
    v_exp_f32 v75, v75
    v_mfma_f32_32x32x16_bf16 v[176:191], a[52:55], v[108:111], v[176:191]
    ds_read_b128 v[108:111], v6 offset:11264
    v_exp_f32 v76, v76
    v_exp_f32 v77, v77
    v_exp_f32 v78, v78
    s_waitcnt lgkmcnt(4)
    v_mfma_f32_32x32x16_bf16 v[160:175], a[56:59], v[112:115], v[160:175]
    v_exp_f32 v79, v79
    v_add_f32 v80, 2.0, v72
    v_add_f32 v81, 2.0, v73
    v_add_f32 v82, 2.0, v74
    v_add_f32 v83, 2.0, v75
    v_mfma_f32_32x32x16_bf16 v[176:191], a[60:63], v[112:115], v[176:191]
    ds_read_b128 v[112:115], v6 offset:12288
    v_add_f32 v84, 2.0, v76
    v_add_f32 v85, 2.0, v77
    v_add_f32 v86, 2.0, v78
    v_add_f32 v87, 2.0, v79
    v_mul_f32 v80, v80, v72
    v_mul_f32 v81, v81, v73
    s_waitcnt lgkmcnt(4)
    v_mfma_f32_32x32x16_bf16 v[160:175], a[64:67], v[116:119], v[160:175]
    v_mul_f32 v82, v82, v74
    v_mul_f32 v83, v83, v75
    v_mul_f32 v84, v84, v76
    v_mul_f32 v85, v85, v77
    v_mul_f32 v86, v86, v78
    v_mul_f32 v87, v87, v79
    v_mfma_f32_32x32x16_bf16 v[176:191], a[68:71], v[116:119], v[176:191]
    ds_read_b128 v[116:119], v6 offset:13312
    v_add_f32 v72, 2.0, v80
    v_add_f32 v73, 2.0, v81
    v_add_f32 v74, 2.0, v82
    v_add_f32 v75, 2.0, v83
    v_add_f32 v76, 2.0, v84
    v_add_f32 v77, 2.0, v85
    s_waitcnt lgkmcnt(4)
    v_mfma_f32_32x32x16_bf16 v[160:175], a[72:75], v[120:123], v[160:175]
    v_add_f32 v78, 2.0, v86
    v_add_f32 v79, 2.0, v87
    v_rcp_f32 v72, v72
    v_rcp_f32 v73, v73
    v_mfma_f32_32x32x16_bf16 v[176:191], a[76:79], v[120:123], v[176:191]
    ds_read_b128 v[120:123], v6 offset:14336
    v_rcp_f32 v74, v74
    v_rcp_f32 v75, v75
    v_rcp_f32 v76, v76
    s_waitcnt lgkmcnt(4)
    v_mfma_f32_32x32x16_bf16 v[160:175], a[80:83], v[104:107], v[160:175]
    v_rcp_f32 v77, v77
    v_rcp_f32 v78, v78
    v_rcp_f32 v79, v79
    v_mfma_f32_32x32x16_bf16 v[176:191], a[84:87], v[104:107], v[176:191]
    ds_read_b128 v[104:107], v6 offset:15360
    v_mul_f32 v80, v80, v128
    v_mul_f32 v81, v81, v129
    v_mul_f32 v82, v82, v130
    v_mul_f32 v83, v83, v131
    v_mul_f32 v84, v84, v132
    v_mul_f32 v85, v85, v133
    s_waitcnt lgkmcnt(4)
    v_mfma_f32_32x32x16_bf16 v[160:175], a[88:91], v[108:111], v[160:175]
    v_mul_f32 v86, v86, v134
    v_mul_f32 v87, v87, v135
    v_mul_f32 v80, v80, v72
    v_mul_f32 v81, v81, v73
    v_mul_f32 v82, v82, v74
    v_mul_f32 v83, v83, v75
    v_mfma_f32_32x32x16_bf16 v[176:191], a[92:95], v[108:111], v[176:191]
    ds_read_b128 v[108:111], v6 offset:16384
    v_mul_f32 v84, v84, v76
    v_mul_f32 v85, v85, v77
    v_mul_f32 v86, v86, v78
    v_mul_f32 v87, v87, v79
    v_cvt_pk_bf16_f32 v64, v80, v81
    v_cvt_pk_bf16_f32 v65, v82, v83
    s_waitcnt lgkmcnt(4)
    v_mfma_f32_32x32x16_bf16 v[160:175], a[96:99], v[112:115], v[160:175]
    v_cvt_pk_bf16_f32 v66, v84, v85
    v_cvt_pk_bf16_f32 v67, v86, v87
    buffer_store_dwordx4 v[64:67], v5, s[32:35], s62 offen offset:0 sc1
    v_mul_f32 v88, 1.4426950408889634, v136
    v_mfma_f32_32x32x16_bf16 v[176:191], a[100:103], v[112:115], v[176:191]
    ds_read_b128 v[112:115], v6 offset:17408
    v_mul_f32 v89, 1.4426950408889634, v137
    v_mul_f32 v90, 1.4426950408889634, v138
    v_mul_f32 v91, 1.4426950408889634, v139
    v_mul_f32 v92, 1.4426950408889634, v140
    v_mul_f32 v93, 1.4426950408889634, v141
    v_mul_f32 v94, 1.4426950408889634, v142
    s_waitcnt lgkmcnt(4)
    v_mfma_f32_32x32x16_bf16 v[160:175], a[104:107], v[116:119], v[160:175]
    v_mul_f32 v95, 1.4426950408889634, v143
    v_min_f32 v88, 0x41f00000, v88
    v_min_f32 v89, 0x41f00000, v89
    v_min_f32 v90, 0x41f00000, v90
    v_min_f32 v91, 0x41f00000, v91
    v_min_f32 v92, 0x41f00000, v92
    v_mfma_f32_32x32x16_bf16 v[176:191], a[108:111], v[116:119], v[176:191]
    ds_read_b128 v[116:119], v6 offset:18432
    v_min_f32 v93, 0x41f00000, v93
    v_min_f32 v94, 0x41f00000, v94
    v_min_f32 v95, 0x41f00000, v95
    v_exp_f32 v88, v88
    s_waitcnt lgkmcnt(4)
    v_mfma_f32_32x32x16_bf16 v[160:175], a[112:115], v[120:123], v[160:175]
    v_exp_f32 v89, v89
    v_exp_f32 v90, v90
    v_exp_f32 v91, v91
    v_mfma_f32_32x32x16_bf16 v[176:191], a[116:119], v[120:123], v[176:191]
    ds_read_b128 v[120:123], v6 offset:19456
    v_exp_f32 v92, v92
    v_exp_f32 v93, v93
    v_exp_f32 v94, v94
    s_waitcnt lgkmcnt(4)
    v_mfma_f32_32x32x16_bf16 v[160:175], a[120:123], v[104:107], v[160:175]
    v_exp_f32 v95, v95
    v_add_f32 v96, 2.0, v88
    v_add_f32 v97, 2.0, v89
    v_add_f32 v98, 2.0, v90
    v_add_f32 v99, 2.0, v91
    v_add_f32 v100, 2.0, v92
    v_mfma_f32_32x32x16_bf16 v[176:191], a[124:127], v[104:107], v[176:191]
    ds_read_b128 v[104:107], v6 offset:20480
    v_add_f32 v101, 2.0, v93
    v_add_f32 v102, 2.0, v94
    v_add_f32 v103, 2.0, v95
    v_mul_f32 v96, v96, v88
    v_mul_f32 v97, v97, v89
    v_mul_f32 v98, v98, v90
    s_waitcnt lgkmcnt(4)
    v_mfma_f32_32x32x16_bf16 v[160:175], a[128:131], v[108:111], v[160:175]
    v_mul_f32 v99, v99, v91
    v_mul_f32 v100, v100, v92
    v_mul_f32 v101, v101, v93
    v_mul_f32 v102, v102, v94
    v_mul_f32 v103, v103, v95
    v_add_f32 v88, 2.0, v96
    v_mfma_f32_32x32x16_bf16 v[176:191], a[132:135], v[108:111], v[176:191]
    ds_read_b128 v[108:111], v6 offset:21504
    v_add_f32 v89, 2.0, v97
    v_add_f32 v90, 2.0, v98
    v_add_f32 v91, 2.0, v99
    v_add_f32 v92, 2.0, v100
    v_add_f32 v93, 2.0, v101
    v_add_f32 v94, 2.0, v102
    s_waitcnt lgkmcnt(4)
    v_mfma_f32_32x32x16_bf16 v[160:175], a[136:139], v[112:115], v[160:175]
    v_add_f32 v95, 2.0, v103
    v_rcp_f32 v88, v88
    v_rcp_f32 v89, v89
    v_mfma_f32_32x32x16_bf16 v[176:191], a[140:143], v[112:115], v[176:191]
    ds_read_b128 v[112:115], v6 offset:22528
    v_rcp_f32 v90, v90
    v_rcp_f32 v91, v91
    v_rcp_f32 v92, v92
    s_waitcnt lgkmcnt(4)
    v_mfma_f32_32x32x16_bf16 v[160:175], a[144:147], v[116:119], v[160:175]
    v_rcp_f32 v93, v93
    v_rcp_f32 v94, v94
    v_rcp_f32 v95, v95
    v_mul_f32 v96, v96, v136
    v_mul_f32 v97, v97, v137
    v_mfma_f32_32x32x16_bf16 v[176:191], a[148:151], v[116:119], v[176:191]
    ds_read_b128 v[116:119], v6 offset:23552
    v_mul_f32 v98, v98, v138
    v_mul_f32 v99, v99, v139
    v_mul_f32 v100, v100, v140
    v_mul_f32 v101, v101, v141
    v_mul_f32 v102, v102, v142
    v_mul_f32 v103, v103, v143
    s_waitcnt lgkmcnt(4)
    v_mfma_f32_32x32x16_bf16 v[160:175], a[152:155], v[120:123], v[160:175]
    v_mul_f32 v96, v96, v88
    v_mul_f32 v97, v97, v89
    v_mul_f32 v98, v98, v90
    v_mul_f32 v99, v99, v91
    v_mul_f32 v100, v100, v92
    v_mul_f32 v101, v101, v93
    v_mfma_f32_32x32x16_bf16 v[176:191], a[156:159], v[120:123], v[176:191]
    ds_read_b128 v[120:123], v6 offset:24576
    v_mul_f32 v102, v102, v94
    v_mul_f32 v103, v103, v95
    v_cvt_pk_bf16_f32 v68, v96, v97
    v_cvt_pk_bf16_f32 v69, v98, v99
    v_cvt_pk_bf16_f32 v70, v100, v101
    v_cvt_pk_bf16_f32 v71, v102, v103
    s_waitcnt lgkmcnt(4)
    v_mfma_f32_32x32x16_bf16 v[160:175], a[160:163], v[104:107], v[160:175]
    buffer_store_dwordx4 v[68:71], v5, s[32:35], s62 offen offset:1024 sc1
    v_mul_f32 v72, 1.4426950408889634, v144
    v_mul_f32 v73, 1.4426950408889634, v145
    v_mul_f32 v74, 1.4426950408889634, v146
    v_mfma_f32_32x32x16_bf16 v[176:191], a[164:167], v[104:107], v[176:191]
    ds_read_b128 v[104:107], v6 offset:25600
    v_mul_f32 v75, 1.4426950408889634, v147
    v_mul_f32 v76, 1.4426950408889634, v148
    v_mul_f32 v77, 1.4426950408889634, v149
    v_mul_f32 v78, 1.4426950408889634, v150
    v_mul_f32 v79, 1.4426950408889634, v151
    v_min_f32 v72, 0x41f00000, v72
    s_waitcnt lgkmcnt(4)
    v_mfma_f32_32x32x16_bf16 v[160:175], a[168:171], v[108:111], v[160:175]
    v_min_f32 v73, 0x41f00000, v73
    v_min_f32 v74, 0x41f00000, v74
    v_min_f32 v75, 0x41f00000, v75
    v_min_f32 v76, 0x41f00000, v76
    v_min_f32 v77, 0x41f00000, v77
    v_min_f32 v78, 0x41f00000, v78
    v_mfma_f32_32x32x16_bf16 v[176:191], a[172:175], v[108:111], v[176:191]
    ds_read_b128 v[108:111], v6 offset:26624
    v_min_f32 v79, 0x41f00000, v79
    v_exp_f32 v72, v72
    v_exp_f32 v73, v73
    s_waitcnt lgkmcnt(4)
    v_mfma_f32_32x32x16_bf16 v[160:175], a[176:179], v[112:115], v[160:175]
    v_exp_f32 v74, v74
    v_exp_f32 v75, v75
    v_exp_f32 v76, v76
    v_mfma_f32_32x32x16_bf16 v[176:191], a[180:183], v[112:115], v[176:191]
    ds_read_b128 v[112:115], v6 offset:27648
    v_exp_f32 v77, v77
    v_exp_f32 v78, v78
    v_exp_f32 v79, v79
    v_add_f32 v80, 2.0, v72
    s_waitcnt lgkmcnt(4)
    v_mfma_f32_32x32x16_bf16 v[160:175], a[184:187], v[116:119], v[160:175]
    v_add_f32 v81, 2.0, v73
    v_add_f32 v82, 2.0, v74
    v_add_f32 v83, 2.0, v75
    v_add_f32 v84, 2.0, v76
    v_add_f32 v85, 2.0, v77
    v_add_f32 v86, 2.0, v78
    v_mfma_f32_32x32x16_bf16 v[176:191], a[188:191], v[116:119], v[176:191]
    ds_read_b128 v[116:119], v6 offset:28672
    v_add_f32 v87, 2.0, v79
    v_mul_f32 v80, v80, v72
    v_mul_f32 v81, v81, v73
    v_mul_f32 v82, v82, v74
    v_mul_f32 v83, v83, v75
    v_mul_f32 v84, v84, v76
    s_waitcnt lgkmcnt(4)
    v_mfma_f32_32x32x16_bf16 v[160:175], a[192:195], v[120:123], v[160:175]
    v_mul_f32 v85, v85, v77
    v_mul_f32 v86, v86, v78
    v_mul_f32 v87, v87, v79
    v_add_f32 v72, 2.0, v80
    v_add_f32 v73, 2.0, v81
    v_add_f32 v74, 2.0, v82
    v_mfma_f32_32x32x16_bf16 v[176:191], a[196:199], v[120:123], v[176:191]
    ds_read_b128 v[120:123], v6 offset:29696
    v_add_f32 v75, 2.0, v83
    v_add_f32 v76, 2.0, v84
    v_add_f32 v77, 2.0, v85
    v_add_f32 v78, 2.0, v86
    v_add_f32 v79, 2.0, v87
    s_waitcnt lgkmcnt(4)
    v_mfma_f32_32x32x16_bf16 v[160:175], a[200:203], v[104:107], v[160:175]
    v_rcp_f32 v72, v72
    v_rcp_f32 v73, v73
    v_rcp_f32 v74, v74
    v_mfma_f32_32x32x16_bf16 v[176:191], a[204:207], v[104:107], v[176:191]
    ds_read_b128 v[104:107], v6 offset:30720
    v_rcp_f32 v75, v75
    v_rcp_f32 v76, v76
    v_rcp_f32 v77, v77
    s_waitcnt lgkmcnt(4)
    v_mfma_f32_32x32x16_bf16 v[160:175], a[208:211], v[108:111], v[160:175]
    v_rcp_f32 v78, v78
    v_rcp_f32 v79, v79
    v_mul_f32 v80, v80, v144
    v_mul_f32 v81, v81, v145
    v_mul_f32 v82, v82, v146
    v_mfma_f32_32x32x16_bf16 v[176:191], a[212:215], v[108:111], v[176:191]
    ds_read_b128 v[108:111], v6 offset:31744
    v_mul_f32 v83, v83, v147
    v_mul_f32 v84, v84, v148
    v_mul_f32 v85, v85, v149
    v_mul_f32 v86, v86, v150
    v_mul_f32 v87, v87, v151
    v_mul_f32 v80, v80, v72
    s_waitcnt lgkmcnt(4)
    v_mfma_f32_32x32x16_bf16 v[160:175], a[216:219], v[112:115], v[160:175]
    v_mul_f32 v81, v81, v73
    v_mul_f32 v82, v82, v74
    v_mul_f32 v83, v83, v75
    v_mul_f32 v84, v84, v76
    v_mul_f32 v85, v85, v77
    v_mul_f32 v86, v86, v78
    v_mfma_f32_32x32x16_bf16 v[176:191], a[220:223], v[112:115], v[176:191]
    ds_read_b128 v[112:115], v6 offset:32768
    v_mul_f32 v87, v87, v79
    v_cvt_pk_bf16_f32 v64, v80, v81
    v_cvt_pk_bf16_f32 v65, v82, v83
    v_cvt_pk_bf16_f32 v66, v84, v85
    v_cvt_pk_bf16_f32 v67, v86, v87
    s_waitcnt lgkmcnt(4)
    v_mfma_f32_32x32x16_bf16 v[160:175], a[224:227], v[116:119], v[160:175]
    buffer_store_dwordx4 v[64:67], v5, s[32:35], s62 offen offset:2048 sc1
    v_mul_f32 v88, 1.4426950408889634, v152
    v_mul_f32 v89, 1.4426950408889634, v153
    v_mul_f32 v90, 1.4426950408889634, v154
    v_mul_f32 v91, 1.4426950408889634, v155
    v_mfma_f32_32x32x16_bf16 v[176:191], a[228:231], v[116:119], v[176:191]
    ds_read_b128 v[116:119], v6 offset:33792
    v_mul_f32 v92, 1.4426950408889634, v156
    v_mul_f32 v93, 1.4426950408889634, v157
    v_mul_f32 v94, 1.4426950408889634, v158
    v_mul_f32 v95, 1.4426950408889634, v159
    v_min_f32 v88, 0x41f00000, v88
    v_min_f32 v89, 0x41f00000, v89
    s_waitcnt lgkmcnt(4)
    v_mfma_f32_32x32x16_bf16 v[160:175], a[232:235], v[120:123], v[160:175]
    v_min_f32 v90, 0x41f00000, v90
    v_min_f32 v91, 0x41f00000, v91
    v_min_f32 v92, 0x41f00000, v92
    v_min_f32 v93, 0x41f00000, v93
    v_min_f32 v94, 0x41f00000, v94
    v_min_f32 v95, 0x41f00000, v95
    v_mfma_f32_32x32x16_bf16 v[176:191], a[236:239], v[120:123], v[176:191]
    ds_read_b128 v[120:123], v6 offset:34816
    v_exp_f32 v88, v88
    v_exp_f32 v89, v89
    v_exp_f32 v90, v90
    s_waitcnt lgkmcnt(4)
    v_mfma_f32_32x32x16_bf16 v[160:175], a[240:243], v[104:107], v[160:175]
    v_exp_f32 v91, v91
    v_exp_f32 v92, v92
    v_exp_f32 v93, v93
    v_mfma_f32_32x32x16_bf16 v[176:191], a[244:247], v[104:107], v[176:191]
    ds_read_b128 v[104:107], v6 offset:35840
    v_exp_f32 v94, v94
    v_exp_f32 v95, v95
    v_add_f32 v96, 2.0, v88
    v_add_f32 v97, 2.0, v89
    s_waitcnt lgkmcnt(4)
    v_mfma_f32_32x32x16_bf16 v[160:175], a[248:251], v[108:111], v[160:175]
    v_add_f32 v98, 2.0, v90
    v_add_f32 v99, 2.0, v91
    v_add_f32 v100, 2.0, v92
    v_add_f32 v101, 2.0, v93
    v_add_f32 v102, 2.0, v94
    v_add_f32 v103, 2.0, v95
    v_mfma_f32_32x32x16_bf16 v[176:191], a[252:255], v[108:111], v[176:191]
    ds_read_b128 v[108:111], v6 offset:36864
    v_mul_f32 v96, v96, v88
    v_mul_f32 v97, v97, v89
    v_mul_f32 v98, v98, v90
    v_mul_f32 v99, v99, v91
    v_mul_f32 v100, v100, v92
    v_mul_f32 v101, v101, v93
    s_waitcnt lgkmcnt(4)
    v_mfma_f32_32x32x16_bf16 v[160:175], v[192:195], v[112:115], v[160:175]
    v_mul_f32 v102, v102, v94
    v_mul_f32 v103, v103, v95
    v_add_f32 v88, 2.0, v96
    v_add_f32 v89, 2.0, v97
    v_add_f32 v90, 2.0, v98
    v_add_f32 v91, 2.0, v99
    v_mfma_f32_32x32x16_bf16 v[176:191], v[196:199], v[112:115], v[176:191]
    ds_read_b128 v[112:115], v6 offset:37888
    v_add_f32 v92, 2.0, v100
    v_add_f32 v93, 2.0, v101
    v_add_f32 v94, 2.0, v102
    v_add_f32 v95, 2.0, v103
    v_rcp_f32 v88, v88
    s_waitcnt lgkmcnt(4)
    v_mfma_f32_32x32x16_bf16 v[160:175], v[200:203], v[116:119], v[160:175]
    v_rcp_f32 v89, v89
    v_rcp_f32 v90, v90
    v_rcp_f32 v91, v91
    v_mfma_f32_32x32x16_bf16 v[176:191], v[204:207], v[116:119], v[176:191]
    ds_read_b128 v[116:119], v6 offset:38912
    v_rcp_f32 v92, v92
    v_rcp_f32 v93, v93
    v_rcp_f32 v94, v94
    s_waitcnt lgkmcnt(4)
    v_mfma_f32_32x32x16_bf16 v[160:175], v[208:211], v[120:123], v[160:175]
    v_rcp_f32 v95, v95
    v_mul_f32 v96, v96, v152
    v_mul_f32 v97, v97, v153
    v_mul_f32 v98, v98, v154
    v_mul_f32 v99, v99, v155
    v_mfma_f32_32x32x16_bf16 v[176:191], v[212:215], v[120:123], v[176:191]
    ds_read_b128 v[120:123], v6 offset:39936
    v_mul_f32 v100, v100, v156
    v_mul_f32 v101, v101, v157
    v_mul_f32 v102, v102, v158
    v_mul_f32 v103, v103, v159
    v_mul_f32 v96, v96, v88
    v_mul_f32 v97, v97, v89
    s_waitcnt lgkmcnt(4)
    v_mfma_f32_32x32x16_bf16 v[160:175], v[216:219], v[104:107], v[160:175]
    v_mul_f32 v98, v98, v90
    v_mul_f32 v99, v99, v91
    v_mul_f32 v100, v100, v92
    v_mul_f32 v101, v101, v93
    v_mul_f32 v102, v102, v94
    v_mul_f32 v103, v103, v95
    v_mfma_f32_32x32x16_bf16 v[176:191], v[220:223], v[104:107], v[176:191]
    v_cvt_pk_bf16_f32 v68, v96, v97
    v_cvt_pk_bf16_f32 v69, v98, v99
    v_cvt_pk_bf16_f32 v70, v100, v101
    v_cvt_pk_bf16_f32 v71, v102, v103
    buffer_store_dwordx4 v[68:71], v5, s[32:35], s62 offen offset:3072 sc1
    s_waitcnt lgkmcnt(3)
    v_mfma_f32_32x32x16_bf16 v[160:175], v[224:227], v[108:111], v[160:175]
    v_mfma_f32_32x32x16_bf16 v[176:191], v[228:231], v[108:111], v[176:191]
    s_add_u32 s59, s59, 40960
    s_cmp_eq_u32 s59, 122880
    s_cselect_b32 s59, 0, s59
    v_add_u32 v6, s59, v5
    s_waitcnt vmcnt(14) lgkmcnt(0)
    s_barrier
    ds_read_b128 v[104:107], v6 offset:0
    ds_read_b128 v[108:111], v6 offset:1024
    v_mfma_f32_32x32x16_bf16 v[160:175], v[232:235], v[112:115], v[160:175]
    v_mfma_f32_32x32x16_bf16 v[176:191], v[236:239], v[112:115], v[176:191]
    ds_read_b128 v[112:115], v6 offset:2048
    v_mfma_f32_32x32x16_bf16 v[160:175], v[240:243], v[116:119], v[160:175]
    v_mfma_f32_32x32x16_bf16 v[176:191], v[244:247], v[116:119], v[176:191]
    ds_read_b128 v[116:119], v6 offset:3072
    v_mfma_f32_32x32x16_bf16 v[160:175], v[248:251], v[120:123], v[160:175]
    v_mfma_f32_32x32x16_bf16 v[176:191], v[252:255], v[120:123], v[176:191]
    ds_read_b128 v[120:123], v6 offset:4096
    s_mov_b32 s62, s63
    s_add_u32 s63, s63, s68
    s_add_u32 s58, s58, 1
    s_cmp_ge_u32 s58, s92
    s_cbranch_scc1 Lprojendh_72
    s_branch Lprojh_70
Lprojendh_71:
    s_waitcnt lgkmcnt(0)
    s_nop 7
    v_mul_f32 v72, 1.4426950408889634, v128
    v_mul_f32 v73, 1.4426950408889634, v129
    v_mul_f32 v74, 1.4426950408889634, v130
    v_mul_f32 v75, 1.4426950408889634, v131
    v_mul_f32 v76, 1.4426950408889634, v132
    v_mul_f32 v77, 1.4426950408889634, v133
    v_mul_f32 v78, 1.4426950408889634, v134
    v_mul_f32 v79, 1.4426950408889634, v135
    v_min_f32 v72, 0x41f00000, v72
    v_min_f32 v73, 0x41f00000, v73
    v_min_f32 v74, 0x41f00000, v74
    v_min_f32 v75, 0x41f00000, v75
    v_min_f32 v76, 0x41f00000, v76
    v_min_f32 v77, 0x41f00000, v77
    v_min_f32 v78, 0x41f00000, v78
    v_min_f32 v79, 0x41f00000, v79
    v_exp_f32 v72, v72
    v_exp_f32 v73, v73
    v_exp_f32 v74, v74
    v_exp_f32 v75, v75
    v_exp_f32 v76, v76
    v_exp_f32 v77, v77
    v_exp_f32 v78, v78
    v_exp_f32 v79, v79
    v_add_f32 v80, 2.0, v72
    v_add_f32 v81, 2.0, v73
    v_add_f32 v82, 2.0, v74
    v_add_f32 v83, 2.0, v75
    v_add_f32 v84, 2.0, v76
    v_add_f32 v85, 2.0, v77
    v_add_f32 v86, 2.0, v78
    v_add_f32 v87, 2.0, v79
    v_mul_f32 v80, v80, v72
    v_mul_f32 v81, v81, v73
    v_mul_f32 v82, v82, v74
    v_mul_f32 v83, v83, v75
    v_mul_f32 v84, v84, v76
    v_mul_f32 v85, v85, v77
    v_mul_f32 v86, v86, v78
    v_mul_f32 v87, v87, v79
    v_add_f32 v72, 2.0, v80
    v_add_f32 v73, 2.0, v81
    v_add_f32 v74, 2.0, v82
    v_add_f32 v75, 2.0, v83
    v_add_f32 v76, 2.0, v84
    v_add_f32 v77, 2.0, v85
    v_add_f32 v78, 2.0, v86
    v_add_f32 v79, 2.0, v87
    v_rcp_f32 v72, v72
    v_rcp_f32 v73, v73
    v_rcp_f32 v74, v74
    v_rcp_f32 v75, v75
    v_rcp_f32 v76, v76
    v_rcp_f32 v77, v77
    v_rcp_f32 v78, v78
    v_rcp_f32 v79, v79
    v_mul_f32 v80, v80, v128
    v_mul_f32 v81, v81, v129
    v_mul_f32 v82, v82, v130
    v_mul_f32 v83, v83, v131
    v_mul_f32 v84, v84, v132
    v_mul_f32 v85, v85, v133
    v_mul_f32 v86, v86, v134
    v_mul_f32 v87, v87, v135
    v_mul_f32 v80, v80, v72
    v_mul_f32 v81, v81, v73
    v_mul_f32 v82, v82, v74
    v_mul_f32 v83, v83, v75
    v_mul_f32 v84, v84, v76
    v_mul_f32 v85, v85, v77
    v_mul_f32 v86, v86, v78
    v_mul_f32 v87, v87, v79
    v_cvt_pk_bf16_f32 v64, v80, v81
    v_cvt_pk_bf16_f32 v65, v82, v83
    v_cvt_pk_bf16_f32 v66, v84, v85
    v_cvt_pk_bf16_f32 v67, v86, v87
    buffer_store_dwordx4 v[64:67], v5, s[32:35], s62 offen offset:0 sc1
    v_mul_f32 v88, 1.4426950408889634, v136
    v_mul_f32 v89, 1.4426950408889634, v137
    v_mul_f32 v90, 1.4426950408889634, v138
    v_mul_f32 v91, 1.4426950408889634, v139
    v_mul_f32 v92, 1.4426950408889634, v140
    v_mul_f32 v93, 1.4426950408889634, v141
    v_mul_f32 v94, 1.4426950408889634, v142
    v_mul_f32 v95, 1.4426950408889634, v143
    v_min_f32 v88, 0x41f00000, v88
    v_min_f32 v89, 0x41f00000, v89
    v_min_f32 v90, 0x41f00000, v90
    v_min_f32 v91, 0x41f00000, v91
    v_min_f32 v92, 0x41f00000, v92
    v_min_f32 v93, 0x41f00000, v93
    v_min_f32 v94, 0x41f00000, v94
    v_min_f32 v95, 0x41f00000, v95
    v_exp_f32 v88, v88
    v_exp_f32 v89, v89
    v_exp_f32 v90, v90
    v_exp_f32 v91, v91
    v_exp_f32 v92, v92
    v_exp_f32 v93, v93
    v_exp_f32 v94, v94
    v_exp_f32 v95, v95
    v_add_f32 v96, 2.0, v88
    v_add_f32 v97, 2.0, v89
    v_add_f32 v98, 2.0, v90
    v_add_f32 v99, 2.0, v91
    v_add_f32 v100, 2.0, v92
    v_add_f32 v101, 2.0, v93
    v_add_f32 v102, 2.0, v94
    v_add_f32 v103, 2.0, v95
    v_mul_f32 v96, v96, v88
    v_mul_f32 v97, v97, v89
    v_mul_f32 v98, v98, v90
    v_mul_f32 v99, v99, v91
    v_mul_f32 v100, v100, v92
    v_mul_f32 v101, v101, v93
    v_mul_f32 v102, v102, v94
    v_mul_f32 v103, v103, v95
    v_add_f32 v88, 2.0, v96
    v_add_f32 v89, 2.0, v97
    v_add_f32 v90, 2.0, v98
    v_add_f32 v91, 2.0, v99
    v_add_f32 v92, 2.0, v100
    v_add_f32 v93, 2.0, v101
    v_add_f32 v94, 2.0, v102
    v_add_f32 v95, 2.0, v103
    v_rcp_f32 v88, v88
    v_rcp_f32 v89, v89
    v_rcp_f32 v90, v90
    v_rcp_f32 v91, v91
    v_rcp_f32 v92, v92
    v_rcp_f32 v93, v93
    v_rcp_f32 v94, v94
    v_rcp_f32 v95, v95
    v_mul_f32 v96, v96, v136
    v_mul_f32 v97, v97, v137
    v_mul_f32 v98, v98, v138
    v_mul_f32 v99, v99, v139
    v_mul_f32 v100, v100, v140
    v_mul_f32 v101, v101, v141
    v_mul_f32 v102, v102, v142
    v_mul_f32 v103, v103, v143
    v_mul_f32 v96, v96, v88
    v_mul_f32 v97, v97, v89
    v_mul_f32 v98, v98, v90
    v_mul_f32 v99, v99, v91
    v_mul_f32 v100, v100, v92
    v_mul_f32 v101, v101, v93
    v_mul_f32 v102, v102, v94
    v_mul_f32 v103, v103, v95
    v_cvt_pk_bf16_f32 v68, v96, v97
    v_cvt_pk_bf16_f32 v69, v98, v99
    v_cvt_pk_bf16_f32 v70, v100, v101
    v_cvt_pk_bf16_f32 v71, v102, v103
    buffer_store_dwordx4 v[68:71], v5, s[32:35], s62 offen offset:1024 sc1
    v_mul_f32 v72, 1.4426950408889634, v144
    v_mul_f32 v73, 1.4426950408889634, v145
    v_mul_f32 v74, 1.4426950408889634, v146
    v_mul_f32 v75, 1.4426950408889634, v147
    v_mul_f32 v76, 1.4426950408889634, v148
    v_mul_f32 v77, 1.4426950408889634, v149
    v_mul_f32 v78, 1.4426950408889634, v150
    v_mul_f32 v79, 1.4426950408889634, v151
    v_min_f32 v72, 0x41f00000, v72
    v_min_f32 v73, 0x41f00000, v73
    v_min_f32 v74, 0x41f00000, v74
    v_min_f32 v75, 0x41f00000, v75
    v_min_f32 v76, 0x41f00000, v76
    v_min_f32 v77, 0x41f00000, v77
    v_min_f32 v78, 0x41f00000, v78
    v_min_f32 v79, 0x41f00000, v79
    v_exp_f32 v72, v72
    v_exp_f32 v73, v73
    v_exp_f32 v74, v74
    v_exp_f32 v75, v75
    v_exp_f32 v76, v76
    v_exp_f32 v77, v77
    v_exp_f32 v78, v78
    v_exp_f32 v79, v79
    v_add_f32 v80, 2.0, v72
    v_add_f32 v81, 2.0, v73
    v_add_f32 v82, 2.0, v74
    v_add_f32 v83, 2.0, v75
    v_add_f32 v84, 2.0, v76
    v_add_f32 v85, 2.0, v77
    v_add_f32 v86, 2.0, v78
    v_add_f32 v87, 2.0, v79
    v_mul_f32 v80, v80, v72
    v_mul_f32 v81, v81, v73
    v_mul_f32 v82, v82, v74
    v_mul_f32 v83, v83, v75
    v_mul_f32 v84, v84, v76
    v_mul_f32 v85, v85, v77
    v_mul_f32 v86, v86, v78
    v_mul_f32 v87, v87, v79
    v_add_f32 v72, 2.0, v80
    v_add_f32 v73, 2.0, v81
    v_add_f32 v74, 2.0, v82
    v_add_f32 v75, 2.0, v83
    v_add_f32 v76, 2.0, v84
    v_add_f32 v77, 2.0, v85
    v_add_f32 v78, 2.0, v86
    v_add_f32 v79, 2.0, v87
    v_rcp_f32 v72, v72
    v_rcp_f32 v73, v73
    v_rcp_f32 v74, v74
    v_rcp_f32 v75, v75
    v_rcp_f32 v76, v76
    v_rcp_f32 v77, v77
    v_rcp_f32 v78, v78
    v_rcp_f32 v79, v79
    v_mul_f32 v80, v80, v144
    v_mul_f32 v81, v81, v145
    v_mul_f32 v82, v82, v146
    v_mul_f32 v83, v83, v147
    v_mul_f32 v84, v84, v148
    v_mul_f32 v85, v85, v149
    v_mul_f32 v86, v86, v150
    v_mul_f32 v87, v87, v151
    v_mul_f32 v80, v80, v72
    v_mul_f32 v81, v81, v73
    v_mul_f32 v82, v82, v74
    v_mul_f32 v83, v83, v75
    v_mul_f32 v84, v84, v76
    v_mul_f32 v85, v85, v77
    v_mul_f32 v86, v86, v78
    v_mul_f32 v87, v87, v79
    v_cvt_pk_bf16_f32 v64, v80, v81
    v_cvt_pk_bf16_f32 v65, v82, v83
    v_cvt_pk_bf16_f32 v66, v84, v85
    v_cvt_pk_bf16_f32 v67, v86, v87
    buffer_store_dwordx4 v[64:67], v5, s[32:35], s62 offen offset:2048 sc1
    v_mul_f32 v88, 1.4426950408889634, v152
    v_mul_f32 v89, 1.4426950408889634, v153
    v_mul_f32 v90, 1.4426950408889634, v154
    v_mul_f32 v91, 1.4426950408889634, v155
    v_mul_f32 v92, 1.4426950408889634, v156
    v_mul_f32 v93, 1.4426950408889634, v157
    v_mul_f32 v94, 1.4426950408889634, v158
    v_mul_f32 v95, 1.4426950408889634, v159
    v_min_f32 v88, 0x41f00000, v88
    v_min_f32 v89, 0x41f00000, v89
    v_min_f32 v90, 0x41f00000, v90
    v_min_f32 v91, 0x41f00000, v91
    v_min_f32 v92, 0x41f00000, v92
    v_min_f32 v93, 0x41f00000, v93
    v_min_f32 v94, 0x41f00000, v94
    v_min_f32 v95, 0x41f00000, v95
    v_exp_f32 v88, v88
    v_exp_f32 v89, v89
    v_exp_f32 v90, v90
    v_exp_f32 v91, v91
    v_exp_f32 v92, v92
    v_exp_f32 v93, v93
    v_exp_f32 v94, v94
    v_exp_f32 v95, v95
    v_add_f32 v96, 2.0, v88
    v_add_f32 v97, 2.0, v89
    v_add_f32 v98, 2.0, v90
    v_add_f32 v99, 2.0, v91
    v_add_f32 v100, 2.0, v92
    v_add_f32 v101, 2.0, v93
    v_add_f32 v102, 2.0, v94
    v_add_f32 v103, 2.0, v95
    v_mul_f32 v96, v96, v88
    v_mul_f32 v97, v97, v89
    v_mul_f32 v98, v98, v90
    v_mul_f32 v99, v99, v91
    v_mul_f32 v100, v100, v92
    v_mul_f32 v101, v101, v93
    v_mul_f32 v102, v102, v94
    v_mul_f32 v103, v103, v95
    v_add_f32 v88, 2.0, v96
    v_add_f32 v89, 2.0, v97
    v_add_f32 v90, 2.0, v98
    v_add_f32 v91, 2.0, v99
    v_add_f32 v92, 2.0, v100
    v_add_f32 v93, 2.0, v101
    v_add_f32 v94, 2.0, v102
    v_add_f32 v95, 2.0, v103
    v_rcp_f32 v88, v88
    v_rcp_f32 v89, v89
    v_rcp_f32 v90, v90
    v_rcp_f32 v91, v91
    v_rcp_f32 v92, v92
    v_rcp_f32 v93, v93
    v_rcp_f32 v94, v94
    v_rcp_f32 v95, v95
    v_mul_f32 v96, v96, v152
    v_mul_f32 v97, v97, v153
    v_mul_f32 v98, v98, v154
    v_mul_f32 v99, v99, v155
    v_mul_f32 v100, v100, v156
    v_mul_f32 v101, v101, v157
    v_mul_f32 v102, v102, v158
    v_mul_f32 v103, v103, v159
    v_mul_f32 v96, v96, v88
    v_mul_f32 v97, v97, v89
    v_mul_f32 v98, v98, v90
    v_mul_f32 v99, v99, v91
    v_mul_f32 v100, v100, v92
    v_mul_f32 v101, v101, v93
    v_mul_f32 v102, v102, v94
    v_mul_f32 v103, v103, v95
    v_cvt_pk_bf16_f32 v68, v96, v97
    v_cvt_pk_bf16_f32 v69, v98, v99
    v_cvt_pk_bf16_f32 v70, v100, v101
    v_cvt_pk_bf16_f32 v71, v102, v103
    buffer_store_dwordx4 v[68:71], v5, s[32:35], s62 offen offset:3072 sc1
    s_branch Lprojdoneh_73
Lprojendh_72:
    s_waitcnt lgkmcnt(0)
    s_nop 7
    v_mul_f32 v72, 1.4426950408889634, v160
    v_mul_f32 v73, 1.4426950408889634, v161
    v_mul_f32 v74, 1.4426950408889634, v162
    v_mul_f32 v75, 1.4426950408889634, v163
    v_mul_f32 v76, 1.4426950408889634, v164
    v_mul_f32 v77, 1.4426950408889634, v165
    v_mul_f32 v78, 1.4426950408889634, v166
    v_mul_f32 v79, 1.4426950408889634, v167
    v_min_f32 v72, 0x41f00000, v72
    v_min_f32 v73, 0x41f00000, v73
    v_min_f32 v74, 0x41f00000, v74
    v_min_f32 v75, 0x41f00000, v75
    v_min_f32 v76, 0x41f00000, v76
    v_min_f32 v77, 0x41f00000, v77
    v_min_f32 v78, 0x41f00000, v78
    v_min_f32 v79, 0x41f00000, v79
    v_exp_f32 v72, v72
    v_exp_f32 v73, v73
    v_exp_f32 v74, v74
    v_exp_f32 v75, v75
    v_exp_f32 v76, v76
    v_exp_f32 v77, v77
    v_exp_f32 v78, v78
    v_exp_f32 v79, v79
    v_add_f32 v80, 2.0, v72
    v_add_f32 v81, 2.0, v73
    v_add_f32 v82, 2.0, v74
    v_add_f32 v83, 2.0, v75
    v_add_f32 v84, 2.0, v76
    v_add_f32 v85, 2.0, v77
    v_add_f32 v86, 2.0, v78
    v_add_f32 v87, 2.0, v79
    v_mul_f32 v80, v80, v72
    v_mul_f32 v81, v81, v73
    v_mul_f32 v82, v82, v74
    v_mul_f32 v83, v83, v75
    v_mul_f32 v84, v84, v76
    v_mul_f32 v85, v85, v77
    v_mul_f32 v86, v86, v78
    v_mul_f32 v87, v87, v79
    v_add_f32 v72, 2.0, v80
    v_add_f32 v73, 2.0, v81
    v_add_f32 v74, 2.0, v82
    v_add_f32 v75, 2.0, v83
    v_add_f32 v76, 2.0, v84
    v_add_f32 v77, 2.0, v85
    v_add_f32 v78, 2.0, v86
    v_add_f32 v79, 2.0, v87
    v_rcp_f32 v72, v72
    v_rcp_f32 v73, v73
    v_rcp_f32 v74, v74
    v_rcp_f32 v75, v75
    v_rcp_f32 v76, v76
    v_rcp_f32 v77, v77
    v_rcp_f32 v78, v78
    v_rcp_f32 v79, v79
    v_mul_f32 v80, v80, v160
    v_mul_f32 v81, v81, v161
    v_mul_f32 v82, v82, v162
    v_mul_f32 v83, v83, v163
    v_mul_f32 v84, v84, v164
    v_mul_f32 v85, v85, v165
    v_mul_f32 v86, v86, v166
    v_mul_f32 v87, v87, v167
    v_mul_f32 v80, v80, v72
    v_mul_f32 v81, v81, v73
    v_mul_f32 v82, v82, v74
    v_mul_f32 v83, v83, v75
    v_mul_f32 v84, v84, v76
    v_mul_f32 v85, v85, v77
    v_mul_f32 v86, v86, v78
    v_mul_f32 v87, v87, v79
    v_cvt_pk_bf16_f32 v64, v80, v81
    v_cvt_pk_bf16_f32 v65, v82, v83
    v_cvt_pk_bf16_f32 v66, v84, v85
    v_cvt_pk_bf16_f32 v67, v86, v87
    buffer_store_dwordx4 v[64:67], v5, s[32:35], s62 offen offset:0 sc1
    v_mul_f32 v88, 1.4426950408889634, v168
    v_mul_f32 v89, 1.4426950408889634, v169
    v_mul_f32 v90, 1.4426950408889634, v170
    v_mul_f32 v91, 1.4426950408889634, v171
    v_mul_f32 v92, 1.4426950408889634, v172
    v_mul_f32 v93, 1.4426950408889634, v173
    v_mul_f32 v94, 1.4426950408889634, v174
    v_mul_f32 v95, 1.4426950408889634, v175
    v_min_f32 v88, 0x41f00000, v88
    v_min_f32 v89, 0x41f00000, v89
    v_min_f32 v90, 0x41f00000, v90
    v_min_f32 v91, 0x41f00000, v91
    v_min_f32 v92, 0x41f00000, v92
    v_min_f32 v93, 0x41f00000, v93
    v_min_f32 v94, 0x41f00000, v94
    v_min_f32 v95, 0x41f00000, v95
    v_exp_f32 v88, v88
    v_exp_f32 v89, v89
    v_exp_f32 v90, v90
    v_exp_f32 v91, v91
    v_exp_f32 v92, v92
    v_exp_f32 v93, v93
    v_exp_f32 v94, v94
    v_exp_f32 v95, v95
    v_add_f32 v96, 2.0, v88
    v_add_f32 v97, 2.0, v89
    v_add_f32 v98, 2.0, v90
    v_add_f32 v99, 2.0, v91
    v_add_f32 v100, 2.0, v92
    v_add_f32 v101, 2.0, v93
    v_add_f32 v102, 2.0, v94
    v_add_f32 v103, 2.0, v95
    v_mul_f32 v96, v96, v88
    v_mul_f32 v97, v97, v89
    v_mul_f32 v98, v98, v90
    v_mul_f32 v99, v99, v91
    v_mul_f32 v100, v100, v92
    v_mul_f32 v101, v101, v93
    v_mul_f32 v102, v102, v94
    v_mul_f32 v103, v103, v95
    v_add_f32 v88, 2.0, v96
    v_add_f32 v89, 2.0, v97
    v_add_f32 v90, 2.0, v98
    v_add_f32 v91, 2.0, v99
    v_add_f32 v92, 2.0, v100
    v_add_f32 v93, 2.0, v101
    v_add_f32 v94, 2.0, v102
    v_add_f32 v95, 2.0, v103
    v_rcp_f32 v88, v88
    v_rcp_f32 v89, v89
    v_rcp_f32 v90, v90
    v_rcp_f32 v91, v91
    v_rcp_f32 v92, v92
    v_rcp_f32 v93, v93
    v_rcp_f32 v94, v94
    v_rcp_f32 v95, v95
    v_mul_f32 v96, v96, v168
    v_mul_f32 v97, v97, v169
    v_mul_f32 v98, v98, v170
    v_mul_f32 v99, v99, v171
    v_mul_f32 v100, v100, v172
    v_mul_f32 v101, v101, v173
    v_mul_f32 v102, v102, v174
    v_mul_f32 v103, v103, v175
    v_mul_f32 v96, v96, v88
    v_mul_f32 v97, v97, v89
    v_mul_f32 v98, v98, v90
    v_mul_f32 v99, v99, v91
    v_mul_f32 v100, v100, v92
    v_mul_f32 v101, v101, v93
    v_mul_f32 v102, v102, v94
    v_mul_f32 v103, v103, v95
    v_cvt_pk_bf16_f32 v68, v96, v97
    v_cvt_pk_bf16_f32 v69, v98, v99
    v_cvt_pk_bf16_f32 v70, v100, v101
    v_cvt_pk_bf16_f32 v71, v102, v103
    buffer_store_dwordx4 v[68:71], v5, s[32:35], s62 offen offset:1024 sc1
    v_mul_f32 v72, 1.4426950408889634, v176
    v_mul_f32 v73, 1.4426950408889634, v177
    v_mul_f32 v74, 1.4426950408889634, v178
    v_mul_f32 v75, 1.4426950408889634, v179
    v_mul_f32 v76, 1.4426950408889634, v180
    v_mul_f32 v77, 1.4426950408889634, v181
    v_mul_f32 v78, 1.4426950408889634, v182
    v_mul_f32 v79, 1.4426950408889634, v183
    v_min_f32 v72, 0x41f00000, v72
    v_min_f32 v73, 0x41f00000, v73
    v_min_f32 v74, 0x41f00000, v74
    v_min_f32 v75, 0x41f00000, v75
    v_min_f32 v76, 0x41f00000, v76
    v_min_f32 v77, 0x41f00000, v77
    v_min_f32 v78, 0x41f00000, v78
    v_min_f32 v79, 0x41f00000, v79
    v_exp_f32 v72, v72
    v_exp_f32 v73, v73
    v_exp_f32 v74, v74
    v_exp_f32 v75, v75
    v_exp_f32 v76, v76
    v_exp_f32 v77, v77
    v_exp_f32 v78, v78
    v_exp_f32 v79, v79
    v_add_f32 v80, 2.0, v72
    v_add_f32 v81, 2.0, v73
    v_add_f32 v82, 2.0, v74
    v_add_f32 v83, 2.0, v75
    v_add_f32 v84, 2.0, v76
    v_add_f32 v85, 2.0, v77
    v_add_f32 v86, 2.0, v78
    v_add_f32 v87, 2.0, v79
    v_mul_f32 v80, v80, v72
    v_mul_f32 v81, v81, v73
    v_mul_f32 v82, v82, v74
    v_mul_f32 v83, v83, v75
    v_mul_f32 v84, v84, v76
    v_mul_f32 v85, v85, v77
    v_mul_f32 v86, v86, v78
    v_mul_f32 v87, v87, v79
    v_add_f32 v72, 2.0, v80
    v_add_f32 v73, 2.0, v81
    v_add_f32 v74, 2.0, v82
    v_add_f32 v75, 2.0, v83
    v_add_f32 v76, 2.0, v84
    v_add_f32 v77, 2.0, v85
    v_add_f32 v78, 2.0, v86
    v_add_f32 v79, 2.0, v87
    v_rcp_f32 v72, v72
    v_rcp_f32 v73, v73
    v_rcp_f32 v74, v74
    v_rcp_f32 v75, v75
    v_rcp_f32 v76, v76
    v_rcp_f32 v77, v77
    v_rcp_f32 v78, v78
    v_rcp_f32 v79, v79
    v_mul_f32 v80, v80, v176
    v_mul_f32 v81, v81, v177
    v_mul_f32 v82, v82, v178
    v_mul_f32 v83, v83, v179
    v_mul_f32 v84, v84, v180
    v_mul_f32 v85, v85, v181
    v_mul_f32 v86, v86, v182
    v_mul_f32 v87, v87, v183
    v_mul_f32 v80, v80, v72
    v_mul_f32 v81, v81, v73
    v_mul_f32 v82, v82, v74
    v_mul_f32 v83, v83, v75
    v_mul_f32 v84, v84, v76
    v_mul_f32 v85, v85, v77
    v_mul_f32 v86, v86, v78
    v_mul_f32 v87, v87, v79
    v_cvt_pk_bf16_f32 v64, v80, v81
    v_cvt_pk_bf16_f32 v65, v82, v83
    v_cvt_pk_bf16_f32 v66, v84, v85
    v_cvt_pk_bf16_f32 v67, v86, v87
    buffer_store_dwordx4 v[64:67], v5, s[32:35], s62 offen offset:2048 sc1
    v_mul_f32 v88, 1.4426950408889634, v184
    v_mul_f32 v89, 1.4426950408889634, v185
    v_mul_f32 v90, 1.4426950408889634, v186
    v_mul_f32 v91, 1.4426950408889634, v187
    v_mul_f32 v92, 1.4426950408889634, v188
    v_mul_f32 v93, 1.4426950408889634, v189
    v_mul_f32 v94, 1.4426950408889634, v190
    v_mul_f32 v95, 1.4426950408889634, v191
    v_min_f32 v88, 0x41f00000, v88
    v_min_f32 v89, 0x41f00000, v89
    v_min_f32 v90, 0x41f00000, v90
    v_min_f32 v91, 0x41f00000, v91
    v_min_f32 v92, 0x41f00000, v92
    v_min_f32 v93, 0x41f00000, v93
    v_min_f32 v94, 0x41f00000, v94
    v_min_f32 v95, 0x41f00000, v95
    v_exp_f32 v88, v88
    v_exp_f32 v89, v89
    v_exp_f32 v90, v90
    v_exp_f32 v91, v91
    v_exp_f32 v92, v92
    v_exp_f32 v93, v93
    v_exp_f32 v94, v94
    v_exp_f32 v95, v95
    v_add_f32 v96, 2.0, v88
    v_add_f32 v97, 2.0, v89
    v_add_f32 v98, 2.0, v90
    v_add_f32 v99, 2.0, v91
    v_add_f32 v100, 2.0, v92
    v_add_f32 v101, 2.0, v93
    v_add_f32 v102, 2.0, v94
    v_add_f32 v103, 2.0, v95
    v_mul_f32 v96, v96, v88
    v_mul_f32 v97, v97, v89
    v_mul_f32 v98, v98, v90
    v_mul_f32 v99, v99, v91
    v_mul_f32 v100, v100, v92
    v_mul_f32 v101, v101, v93
    v_mul_f32 v102, v102, v94
    v_mul_f32 v103, v103, v95
    v_add_f32 v88, 2.0, v96
    v_add_f32 v89, 2.0, v97
    v_add_f32 v90, 2.0, v98
    v_add_f32 v91, 2.0, v99
    v_add_f32 v92, 2.0, v100
    v_add_f32 v93, 2.0, v101
    v_add_f32 v94, 2.0, v102
    v_add_f32 v95, 2.0, v103
    v_rcp_f32 v88, v88
    v_rcp_f32 v89, v89
    v_rcp_f32 v90, v90
    v_rcp_f32 v91, v91
    v_rcp_f32 v92, v92
    v_rcp_f32 v93, v93
    v_rcp_f32 v94, v94
    v_rcp_f32 v95, v95
    v_mul_f32 v96, v96, v184
    v_mul_f32 v97, v97, v185
    v_mul_f32 v98, v98, v186
    v_mul_f32 v99, v99, v187
    v_mul_f32 v100, v100, v188
    v_mul_f32 v101, v101, v189
    v_mul_f32 v102, v102, v190
    v_mul_f32 v103, v103, v191
    v_mul_f32 v96, v96, v88
    v_mul_f32 v97, v97, v89
    v_mul_f32 v98, v98, v90
    v_mul_f32 v99, v99, v91
    v_mul_f32 v100, v100, v92
    v_mul_f32 v101, v101, v93
    v_mul_f32 v102, v102, v94
    v_mul_f32 v103, v103, v95
    v_cvt_pk_bf16_f32 v68, v96, v97
    v_cvt_pk_bf16_f32 v69, v98, v99
    v_cvt_pk_bf16_f32 v70, v100, v101
    v_cvt_pk_bf16_f32 v71, v102, v103
    buffer_store_dwordx4 v[68:71], v5, s[32:35], s62 offen offset:3072 sc1
Lprojdoneh_73:
LpD_30:
    s_waitcnt vmcnt(0)
    s_barrier
    s_cmp_lg_u32 s3, 0
    s_cbranch_scc1 Lsgpj_77
    s_mov_b64 exec, 1
    v_mov_b32 v8, 65536
    buffer_atomic_add v8, off, s[44:47], 0 offset:32 sc1
    s_mov_b64 exec, -1
Lsgpj_77:
    v_mov_b32 v7, 255
    s_mov_b64 exec, 1
    buffer_store_dword v7, off, s[32:35], s94 sc1
    s_mov_b64 exec, -1
    s_cmp_ge_u32 s101, 160
    s_cbranch_scc1 Lend
    s_mul_hi_u32 s90, s101, 0x0ccccccd
    s_mul_i32 s91, s90, 20
    s_sub_u32 s91, s101, s91
    s_mov_b32 s92, 8
    s_cmp_lt_u32 s90, 5
    s_cselect_b32 s92, 8, 7
    s_and_b32 s88, s90, 3
    s_lshr_b32 s89, s90, 2
    s_add_u32 s89, s89, 61
    s_mov_b32 s93, 8
    s_mov_b32 s36, s24
    s_and_b32 s37, s25, 0xffff
    s_mov_b32 s38, 0x21c000
    s_mov_b32 s39, 0x00020000
    s_mov_b32 s40, s14
    s_and_b32 s41, s15, 0xffff
    s_mov_b32 s42, 0x500000
    s_mov_b32 s43, 0x00020000
    v_lshrrev_b32 v2, 2, v1
    v_mul_u32_u24 v2, 1280, v2
    v_and_b32 v3, 3, v1
    v_lshl_add_u32 v2, v3, 4, v2
    v_lshlrev_b32 v3, 3, v3
    v_lshrrev_b32 v4, 5, v1
    v_lshl_add_u32 v3, v4, 8, v3
    v_bfe_u32 v4, v1, 2, 2
    v_lshl_add_u32 v3, v4, 6, v3
    v_bfe_u32 v4, v1, 4, 1
    v_lshl_add_u32 v3, v4, 5, v3
    s_mul_i32 s52, s3, 40960
    v_add_u32 v3, s52, v3
    s_lshl_b32 s55, s91, 6
    s_mul_i32 s53, s3, 552960
    s_add_u32 s53, s53, s55
    s_mul_i32 s54, s3, 1310720
    s_add_u32 s54, s54, s55
    s_add_u32 m0, s52, 0
    s_add_u32 s55, s53, 0
    buffer_load_dwordx4 v2, s[36:39], s55 offen lds
    s_add_u32 m0, s52, 1024
    s_add_u32 s55, s53, 20480
    buffer_load_dwordx4 v2, s[36:39], s55 offen lds
    s_add_u32 m0, s52, 2048
    s_add_u32 s55, s53, 40960
    buffer_load_dwordx4 v2, s[36:39], s55 offen lds
    s_add_u32 m0, s52, 3072
    s_add_u32 s55, s53, 61440
    buffer_load_dwordx4 v2, s[36:39], s55 offen lds
    s_add_u32 m0, s52, 4096
    s_add_u32 s55, s53, 81920
    buffer_load_dwordx4 v2, s[36:39], s55 offen lds
    s_add_u32 m0, s52, 5120
    s_add_u32 s55, s53, 102400
    buffer_load_dwordx4 v2, s[36:39], s55 offen lds
    s_add_u32 m0, s52, 6144
    s_add_u32 s55, s53, 122880
    buffer_load_dwordx4 v2, s[36:39], s55 offen lds
    s_add_u32 m0, s52, 7168
    s_add_u32 s55, s53, 143360
    buffer_load_dwordx4 v2, s[36:39], s55 offen lds
    s_add_u32 m0, s52, 8192
    s_add_u32 s55, s53, 163840
    buffer_load_dwordx4 v2, s[36:39], s55 offen lds
    s_add_u32 m0, s52, 9216
    s_add_u32 s55, s53, 184320
    buffer_load_dwordx4 v2, s[36:39], s55 offen lds
    s_add_u32 m0, s52, 10240
    s_add_u32 s55, s53, 204800
    buffer_load_dwordx4 v2, s[36:39], s55 offen lds
    s_add_u32 m0, s52, 11264
    s_add_u32 s55, s53, 225280
    buffer_load_dwordx4 v2, s[36:39], s55 offen lds
    s_add_u32 m0, s52, 12288
    s_add_u32 s55, s53, 245760
    buffer_load_dwordx4 v2, s[36:39], s55 offen lds
    s_add_u32 m0, s52, 13312
    s_add_u32 s55, s53, 266240
    buffer_load_dwordx4 v2, s[36:39], s55 offen lds
    s_add_u32 m0, s52, 14336
    s_add_u32 s55, s53, 286720
    buffer_load_dwordx4 v2, s[36:39], s55 offen lds
    s_add_u32 m0, s52, 15360
    s_add_u32 s55, s53, 307200
    buffer_load_dwordx4 v2, s[36:39], s55 offen lds
    s_add_u32 m0, s52, 16384
    s_add_u32 s55, s53, 327680
    buffer_load_dwordx4 v2, s[36:39], s55 offen lds
    s_add_u32 m0, s52, 17408
    s_add_u32 s55, s53, 348160
    buffer_load_dwordx4 v2, s[36:39], s55 offen lds
    s_add_u32 m0, s52, 18432
    s_add_u32 s55, s53, 368640
    buffer_load_dwordx4 v2, s[36:39], s55 offen lds
    s_add_u32 m0, s52, 19456
    s_add_u32 s55, s53, 389120
    buffer_load_dwordx4 v2, s[36:39], s55 offen lds
    s_add_u32 m0, s52, 20480
    s_add_u32 s55, s53, 409600
    buffer_load_dwordx4 v2, s[36:39], s55 offen lds
    s_add_u32 m0, s52, 21504
    s_add_u32 s55, s53, 430080
    buffer_load_dwordx4 v2, s[36:39], s55 offen lds
    s_add_u32 m0, s52, 22528
    s_add_u32 s55, s53, 450560
    buffer_load_dwordx4 v2, s[36:39], s55 offen lds
    s_add_u32 m0, s52, 23552
    s_add_u32 s55, s53, 471040
    buffer_load_dwordx4 v2, s[36:39], s55 offen lds
    s_add_u32 m0, s52, 24576
    s_add_u32 s55, s53, 491520
    buffer_load_dwordx4 v2, s[36:39], s55 offen lds
    s_add_u32 m0, s52, 25600
    s_add_u32 s55, s53, 512000
    buffer_load_dwordx4 v2, s[36:39], s55 offen lds
    s_add_u32 m0, s52, 26624
    s_add_u32 s55, s53, 532480
    buffer_load_dwordx4 v2, s[36:39], s55 offen lds
    s_add_u32 m0, s52, 27648
    s_add_u32 s55, s54, 0
    buffer_load_dwordx4 v2, s[40:43], s55 offen lds
    s_add_u32 m0, s52, 28672
    s_add_u32 s55, s54, 20480
    buffer_load_dwordx4 v2, s[40:43], s55 offen lds
    s_add_u32 m0, s52, 29696
    s_add_u32 s55, s54, 40960
    buffer_load_dwordx4 v2, s[40:43], s55 offen lds
    s_add_u32 m0, s52, 30720
    s_add_u32 s55, s54, 61440
    buffer_load_dwordx4 v2, s[40:43], s55 offen lds
    s_add_u32 m0, s52, 31744
    s_add_u32 s55, s54, 81920
    buffer_load_dwordx4 v2, s[40:43], s55 offen lds
    s_add_u32 m0, s52, 32768
    s_add_u32 s55, s54, 102400
    buffer_load_dwordx4 v2, s[40:43], s55 offen lds
    s_add_u32 m0, s52, 33792
    s_add_u32 s55, s54, 122880
    buffer_load_dwordx4 v2, s[40:43], s55 offen lds
    s_add_u32 m0, s52, 34816
    s_add_u32 s55, s54, 143360
    buffer_load_dwordx4 v2, s[40:43], s55 offen lds
    s_add_u32 m0, s52, 35840
    s_add_u32 s55, s54, 163840
    buffer_load_dwordx4 v2, s[40:43], s55 offen lds
    s_add_u32 m0, s52, 36864
    s_add_u32 s55, s54, 184320
    buffer_load_dwordx4 v2, s[40:43], s55 offen lds
    s_add_u32 m0, s52, 37888
    s_add_u32 s55, s54, 204800
    buffer_load_dwordx4 v2, s[40:43], s55 offen lds
    s_add_u32 m0, s52, 38912
    s_add_u32 s55, s54, 225280
    buffer_load_dwordx4 v2, s[40:43], s55 offen lds
    s_add_u32 m0, s52, 39936
    s_add_u32 s55, s54, 245760
    buffer_load_dwordx4 v2, s[40:43], s55 offen lds
    s_waitcnt vmcnt(36)
    ds_read_b64_tr_b16 v[148:149], v3 offset:0
    ds_read_b64_tr_b16 v[150:151], v3 offset:512
    ds_read_b64_tr_b16 v[152:153], v3 offset:1024
    ds_read_b64_tr_b16 v[154:155], v3 offset:1536
    ds_read_b64_tr_b16 v[156:157], v3 offset:2048
    ds_read_b64_tr_b16 v[158:159], v3 offset:2560
    ds_read_b64_tr_b16 v[160:161], v3 offset:3072
    ds_read_b64_tr_b16 v[162:163], v3 offset:3584
    s_waitcnt lgkmcnt(0)
    s_add_u32 m0, s52, 0
    s_add_u32 s55, s54, 266240
    buffer_load_dwordx4 v2, s[40:43], s55 offen lds
    s_add_u32 m0, s52, 1024
    s_add_u32 s55, s54, 286720
    buffer_load_dwordx4 v2, s[40:43], s55 offen lds
    s_add_u32 m0, s52, 2048
    s_add_u32 s55, s54, 307200
    buffer_load_dwordx4 v2, s[40:43], s55 offen lds
    s_add_u32 m0, s52, 3072
    s_add_u32 s55, s54, 327680
    buffer_load_dwordx4 v2, s[40:43], s55 offen lds
    s_waitcnt vmcnt(36)
    ds_read_b64_tr_b16 v[164:165], v3 offset:4096
    ds_read_b64_tr_b16 v[166:167], v3 offset:4608
    ds_read_b64_tr_b16 v[168:169], v3 offset:5120
    ds_read_b64_tr_b16 v[170:171], v3 offset:5632
    ds_read_b64_tr_b16 v[172:173], v3 offset:6144
    ds_read_b64_tr_b16 v[174:175], v3 offset:6656
    ds_read_b64_tr_b16 v[176:177], v3 offset:7168
    ds_read_b64_tr_b16 v[178:179], v3 offset:7680
    s_waitcnt lgkmcnt(0)
    s_add_u32 m0, s52, 4096
    s_add_u32 s55, s54, 348160
    buffer_load_dwordx4 v2, s[40:43], s55 offen lds
    s_add_u32 m0, s52, 5120
    s_add_u32 s55, s54, 368640
    buffer_load_dwordx4 v2, s[40:43], s55 offen lds
    s_add_u32 m0, s52, 6144
    s_add_u32 s55, s54, 389120
    buffer_load_dwordx4 v2, s[40:43], s55 offen lds
    s_add_u32 m0, s52, 7168
    s_add_u32 s55, s54, 409600
    buffer_load_dwordx4 v2, s[40:43], s55 offen lds
    s_waitcnt vmcnt(36)
    ds_read_b64_tr_b16 v[180:181], v3 offset:8192
    ds_read_b64_tr_b16 v[182:183], v3 offset:8704
    ds_read_b64_tr_b16 v[184:185], v3 offset:9216
    ds_read_b64_tr_b16 v[186:187], v3 offset:9728
    ds_read_b64_tr_b16 v[188:189], v3 offset:10240
    ds_read_b64_tr_b16 v[190:191], v3 offset:10752
    ds_read_b64_tr_b16 v[192:193], v3 offset:11264
    ds_read_b64_tr_b16 v[194:195], v3 offset:11776
    s_waitcnt lgkmcnt(0)
    s_add_u32 m0, s52, 8192
    s_add_u32 s55, s54, 430080
    buffer_load_dwordx4 v2, s[40:43], s55 offen lds
    s_add_u32 m0, s52, 9216
    s_add_u32 s55, s54, 450560
    buffer_load_dwordx4 v2, s[40:43], s55 offen lds
    s_add_u32 m0, s52, 10240
    s_add_u32 s55, s54, 471040
    buffer_load_dwordx4 v2, s[40:43], s55 offen lds
    s_add_u32 m0, s52, 11264
    s_add_u32 s55, s54, 491520
    buffer_load_dwordx4 v2, s[40:43], s55 offen lds
    s_waitcnt vmcnt(36)
    ds_read_b64_tr_b16 v[196:197], v3 offset:12288
    ds_read_b64_tr_b16 v[198:199], v3 offset:12800
    ds_read_b64_tr_b16 v[200:201], v3 offset:13312
    ds_read_b64_tr_b16 v[202:203], v3 offset:13824
    ds_read_b64_tr_b16 v[204:205], v3 offset:14336
    ds_read_b64_tr_b16 v[206:207], v3 offset:14848
    ds_read_b64_tr_b16 v[208:209], v3 offset:15360
    ds_read_b64_tr_b16 v[210:211], v3 offset:15872
    s_waitcnt lgkmcnt(0)
    s_add_u32 m0, s52, 12288
    s_add_u32 s55, s54, 512000
    buffer_load_dwordx4 v2, s[40:43], s55 offen lds
    s_add_u32 m0, s52, 13312
    s_add_u32 s55, s54, 532480
    buffer_load_dwordx4 v2, s[40:43], s55 offen lds
    s_add_u32 m0, s52, 14336
    s_add_u32 s55, s54, 552960
    buffer_load_dwordx4 v2, s[40:43], s55 offen lds
    s_add_u32 m0, s52, 15360
    s_add_u32 s55, s54, 573440
    buffer_load_dwordx4 v2, s[40:43], s55 offen lds
    s_waitcnt vmcnt(36)
    ds_read_b64_tr_b16 v[212:213], v3 offset:16384
    ds_read_b64_tr_b16 v[214:215], v3 offset:16896
    ds_read_b64_tr_b16 v[216:217], v3 offset:17408
    ds_read_b64_tr_b16 v[218:219], v3 offset:17920
    ds_read_b64_tr_b16 v[220:221], v3 offset:18432
    ds_read_b64_tr_b16 v[222:223], v3 offset:18944
    ds_read_b64_tr_b16 v[224:225], v3 offset:19456
    ds_read_b64_tr_b16 v[226:227], v3 offset:19968
    s_waitcnt lgkmcnt(0)
    s_add_u32 m0, s52, 16384
    s_add_u32 s55, s54, 593920
    buffer_load_dwordx4 v2, s[40:43], s55 offen lds
    s_add_u32 m0, s52, 17408
    s_add_u32 s55, s54, 614400
    buffer_load_dwordx4 v2, s[40:43], s55 offen lds
    s_add_u32 m0, s52, 18432
    s_add_u32 s55, s54, 634880
    buffer_load_dwordx4 v2, s[40:43], s55 offen lds
    s_add_u32 m0, s52, 19456
    s_add_u32 s55, s54, 655360
    buffer_load_dwordx4 v2, s[40:43], s55 offen lds
    s_waitcnt vmcnt(36)
    ds_read_b64_tr_b16 v[228:229], v3 offset:20480
    ds_read_b64_tr_b16 v[230:231], v3 offset:20992
    ds_read_b64_tr_b16 v[232:233], v3 offset:21504
    ds_read_b64_tr_b16 v[234:235], v3 offset:22016
    ds_read_b64_tr_b16 v[236:237], v3 offset:22528
    ds_read_b64_tr_b16 v[238:239], v3 offset:23040
    ds_read_b64_tr_b16 v[240:241], v3 offset:23552
    ds_read_b64_tr_b16 v[242:243], v3 offset:24064
    s_waitcnt lgkmcnt(0)
    s_add_u32 m0, s52, 20480
    s_add_u32 s55, s54, 675840
    buffer_load_dwordx4 v2, s[40:43], s55 offen lds
    s_add_u32 m0, s52, 21504
    s_add_u32 s55, s54, 696320
    buffer_load_dwordx4 v2, s[40:43], s55 offen lds
    s_add_u32 m0, s52, 22528
    s_add_u32 s55, s54, 716800
    buffer_load_dwordx4 v2, s[40:43], s55 offen lds
    s_add_u32 m0, s52, 23552
    s_add_u32 s55, s54, 737280
    buffer_load_dwordx4 v2, s[40:43], s55 offen lds
    s_waitcnt vmcnt(36)
    ds_read_b64_tr_b16 v[244:245], v3 offset:24576
    ds_read_b64_tr_b16 v[246:247], v3 offset:25088
    ds_read_b64_tr_b16 v[248:249], v3 offset:25600
    ds_read_b64_tr_b16 v[250:251], v3 offset:26112
    ds_read_b64_tr_b16 v[252:253], v3 offset:26624
    ds_read_b64_tr_b16 v[254:255], v3 offset:27136
    ds_read_b64_tr_b16 a[0:1], v3 offset:27648
    ds_read_b64_tr_b16 a[2:3], v3 offset:28160
    s_waitcnt lgkmcnt(0)
    s_add_u32 m0, s52, 24576
    s_add_u32 s55, s54, 757760
    buffer_load_dwordx4 v2, s[40:43], s55 offen lds
    s_add_u32 m0, s52, 25600
    s_add_u32 s55, s54, 778240
    buffer_load_dwordx4 v2, s[40:43], s55 offen lds
    s_add_u32 m0, s52, 26624
    s_add_u32 s55, s54, 798720
    buffer_load_dwordx4 v2, s[40:43], s55 offen lds
    s_add_u32 m0, s52, 27648
    s_add_u32 s55, s54, 819200
    buffer_load_dwordx4 v2, s[40:43], s55 offen lds
    s_waitcnt vmcnt(36)
    ds_read_b64_tr_b16 a[4:5], v3 offset:28672
    ds_read_b64_tr_b16 a[6:7], v3 offset:29184
    ds_read_b64_tr_b16 a[8:9], v3 offset:29696
    ds_read_b64_tr_b16 a[10:11], v3 offset:30208
    ds_read_b64_tr_b16 a[12:13], v3 offset:30720
    ds_read_b64_tr_b16 a[14:15], v3 offset:31232
    ds_read_b64_tr_b16 a[16:17], v3 offset:31744
    ds_read_b64_tr_b16 a[18:19], v3 offset:32256
    s_waitcnt lgkmcnt(0)
    s_add_u32 m0, s52, 28672
    s_add_u32 s55, s54, 839680
    buffer_load_dwordx4 v2, s[40:43], s55 offen lds
    s_add_u32 m0, s52, 29696
    s_add_u32 s55, s54, 860160
    buffer_load_dwordx4 v2, s[40:43], s55 offen lds
    s_add_u32 m0, s52, 30720
    s_add_u32 s55, s54, 880640
    buffer_load_dwordx4 v2, s[40:43], s55 offen lds
    s_add_u32 m0, s52, 31744
    s_add_u32 s55, s54, 901120
    buffer_load_dwordx4 v2, s[40:43], s55 offen lds
    s_waitcnt vmcnt(36)
    ds_read_b64_tr_b16 a[20:21], v3 offset:32768
    ds_read_b64_tr_b16 a[22:23], v3 offset:33280
    ds_read_b64_tr_b16 a[24:25], v3 offset:33792
    ds_read_b64_tr_b16 a[26:27], v3 offset:34304
    ds_read_b64_tr_b16 a[28:29], v3 offset:34816
    ds_read_b64_tr_b16 a[30:31], v3 offset:35328
    ds_read_b64_tr_b16 a[32:33], v3 offset:35840
    ds_read_b64_tr_b16 a[34:35], v3 offset:36352
    s_waitcnt lgkmcnt(0)
    s_add_u32 m0, s52, 32768
    s_add_u32 s55, s54, 921600
    buffer_load_dwordx4 v2, s[40:43], s55 offen lds
    s_add_u32 m0, s52, 33792
    s_add_u32 s55, s54, 942080
    buffer_load_dwordx4 v2, s[40:43], s55 offen lds
    s_add_u32 m0, s52, 34816
    s_add_u32 s55, s54, 962560
    buffer_load_dwordx4 v2, s[40:43], s55 offen lds
    s_add_u32 m0, s52, 35840
    s_add_u32 s55, s54, 983040
    buffer_load_dwordx4 v2, s[40:43], s55 offen lds
    s_waitcnt vmcnt(36)
    ds_read_b64_tr_b16 a[36:37], v3 offset:36864
    ds_read_b64_tr_b16 a[38:39], v3 offset:37376
    ds_read_b64_tr_b16 a[40:41], v3 offset:37888
    ds_read_b64_tr_b16 a[42:43], v3 offset:38400
    ds_read_b64_tr_b16 a[44:45], v3 offset:38912
    ds_read_b64_tr_b16 a[46:47], v3 offset:39424
    ds_read_b64_tr_b16 a[48:49], v3 offset:39936
    ds_read_b64_tr_b16 a[50:51], v3 offset:40448
    s_waitcnt lgkmcnt(0)
    s_add_u32 m0, s52, 36864
    s_add_u32 s55, s54, 1003520
    buffer_load_dwordx4 v2, s[40:43], s55 offen lds
    s_add_u32 m0, s52, 37888
    s_add_u32 s55, s54, 1024000
    buffer_load_dwordx4 v2, s[40:43], s55 offen lds
    s_add_u32 m0, s52, 38912
    s_add_u32 s55, s54, 1044480
    buffer_load_dwordx4 v2, s[40:43], s55 offen lds
    s_add_u32 m0, s52, 39936
    s_add_u32 s55, s54, 1064960
    buffer_load_dwordx4 v2, s[40:43], s55 offen lds
    s_waitcnt vmcnt(36)
    ds_read_b64_tr_b16 a[52:53], v3 offset:0
    ds_read_b64_tr_b16 a[54:55], v3 offset:512
    ds_read_b64_tr_b16 a[56:57], v3 offset:1024
    ds_read_b64_tr_b16 a[58:59], v3 offset:1536
    ds_read_b64_tr_b16 a[60:61], v3 offset:2048
    ds_read_b64_tr_b16 a[62:63], v3 offset:2560
    ds_read_b64_tr_b16 a[64:65], v3 offset:3072
    ds_read_b64_tr_b16 a[66:67], v3 offset:3584
    s_waitcnt lgkmcnt(0)
    s_add_u32 m0, s52, 0
    s_add_u32 s55, s54, 1085440
    buffer_load_dwordx4 v2, s[40:43], s55 offen lds
    s_add_u32 m0, s52, 1024
    s_add_u32 s55, s54, 1105920
    buffer_load_dwordx4 v2, s[40:43], s55 offen lds
    s_add_u32 m0, s52, 2048
    s_add_u32 s55, s54, 1126400
    buffer_load_dwordx4 v2, s[40:43], s55 offen lds
    s_add_u32 m0, s52, 3072
    s_add_u32 s55, s54, 1146880
    buffer_load_dwordx4 v2, s[40:43], s55 offen lds
    s_waitcnt vmcnt(36)
    ds_read_b64_tr_b16 a[68:69], v3 offset:4096
    ds_read_b64_tr_b16 a[70:71], v3 offset:4608
    ds_read_b64_tr_b16 a[72:73], v3 offset:5120
    ds_read_b64_tr_b16 a[74:75], v3 offset:5632
    ds_read_b64_tr_b16 a[76:77], v3 offset:6144
    ds_read_b64_tr_b16 a[78:79], v3 offset:6656
    ds_read_b64_tr_b16 a[80:81], v3 offset:7168
    ds_read_b64_tr_b16 a[82:83], v3 offset:7680
    s_waitcnt lgkmcnt(0)
    s_add_u32 m0, s52, 4096
    s_add_u32 s55, s54, 1167360
    buffer_load_dwordx4 v2, s[40:43], s55 offen lds
    s_add_u32 m0, s52, 5120
    s_add_u32 s55, s54, 1187840
    buffer_load_dwordx4 v2, s[40:43], s55 offen lds
    s_add_u32 m0, s52, 6144
    s_add_u32 s55, s54, 1208320
    buffer_load_dwordx4 v2, s[40:43], s55 offen lds
    s_add_u32 m0, s52, 7168
    s_add_u32 s55, s54, 1228800
    buffer_load_dwordx4 v2, s[40:43], s55 offen lds
    s_waitcnt vmcnt(36)
    ds_read_b64_tr_b16 a[84:85], v3 offset:8192
    ds_read_b64_tr_b16 a[86:87], v3 offset:8704
    ds_read_b64_tr_b16 a[88:89], v3 offset:9216
    ds_read_b64_tr_b16 a[90:91], v3 offset:9728
    ds_read_b64_tr_b16 a[92:93], v3 offset:10240
    ds_read_b64_tr_b16 a[94:95], v3 offset:10752
    ds_read_b64_tr_b16 a[96:97], v3 offset:11264
    ds_read_b64_tr_b16 a[98:99], v3 offset:11776
    s_waitcnt lgkmcnt(0)
    s_add_u32 m0, s52, 8192
    s_add_u32 s55, s54, 1249280
    buffer_load_dwordx4 v2, s[40:43], s55 offen lds
    s_add_u32 m0, s52, 9216
    s_add_u32 s55, s54, 1269760
    buffer_load_dwordx4 v2, s[40:43], s55 offen lds
    s_add_u32 m0, s52, 10240
    s_add_u32 s55, s54, 1290240
    buffer_load_dwordx4 v2, s[40:43], s55 offen lds
    s_waitcnt vmcnt(35)
    ds_read_b64_tr_b16 a[100:101], v3 offset:12288
    ds_read_b64_tr_b16 a[102:103], v3 offset:12800
    ds_read_b64_tr_b16 a[104:105], v3 offset:13312
    ds_read_b64_tr_b16 a[106:107], v3 offset:13824
    ds_read_b64_tr_b16 a[108:109], v3 offset:14336
    ds_read_b64_tr_b16 a[110:111], v3 offset:14848
    ds_read_b64_tr_b16 a[112:113], v3 offset:15360
    ds_read_b64_tr_b16 a[114:115], v3 offset:15872
    s_waitcnt lgkmcnt(0)
    s_waitcnt vmcnt(31)
    ds_read_b64_tr_b16 a[116:117], v3 offset:16384
    ds_read_b64_tr_b16 a[118:119], v3 offset:16896
    ds_read_b64_tr_b16 a[120:121], v3 offset:17408
    ds_read_b64_tr_b16 a[122:123], v3 offset:17920
    ds_read_b64_tr_b16 a[124:125], v3 offset:18432
    ds_read_b64_tr_b16 a[126:127], v3 offset:18944
    ds_read_b64_tr_b16 a[128:129], v3 offset:19456
    ds_read_b64_tr_b16 a[130:131], v3 offset:19968
    s_waitcnt lgkmcnt(0)
    s_waitcnt vmcnt(27)
    ds_read_b64_tr_b16 a[132:133], v3 offset:20480
    ds_read_b64_tr_b16 a[134:135], v3 offset:20992
    ds_read_b64_tr_b16 a[136:137], v3 offset:21504
    ds_read_b64_tr_b16 a[138:139], v3 offset:22016
    ds_read_b64_tr_b16 a[140:141], v3 offset:22528
    ds_read_b64_tr_b16 a[142:143], v3 offset:23040
    ds_read_b64_tr_b16 a[144:145], v3 offset:23552
    ds_read_b64_tr_b16 a[146:147], v3 offset:24064
    s_waitcnt lgkmcnt(0)
    s_waitcnt vmcnt(23)
    ds_read_b64_tr_b16 a[148:149], v3 offset:24576
    ds_read_b64_tr_b16 a[150:151], v3 offset:25088
    ds_read_b64_tr_b16 a[152:153], v3 offset:25600
    ds_read_b64_tr_b16 a[154:155], v3 offset:26112
    ds_read_b64_tr_b16 a[156:157], v3 offset:26624
    ds_read_b64_tr_b16 a[158:159], v3 offset:27136
    ds_read_b64_tr_b16 a[160:161], v3 offset:27648
    ds_read_b64_tr_b16 a[162:163], v3 offset:28160
    s_waitcnt lgkmcnt(0)
    s_waitcnt vmcnt(19)
    ds_read_b64_tr_b16 a[164:165], v3 offset:28672
    ds_read_b64_tr_b16 a[166:167], v3 offset:29184
    ds_read_b64_tr_b16 a[168:169], v3 offset:29696
    ds_read_b64_tr_b16 a[170:171], v3 offset:30208
    ds_read_b64_tr_b16 a[172:173], v3 offset:30720
    ds_read_b64_tr_b16 a[174:175], v3 offset:31232
    ds_read_b64_tr_b16 a[176:177], v3 offset:31744
    ds_read_b64_tr_b16 a[178:179], v3 offset:32256
    s_waitcnt lgkmcnt(0)
    s_waitcnt vmcnt(15)
    ds_read_b64_tr_b16 a[180:181], v3 offset:32768
    ds_read_b64_tr_b16 a[182:183], v3 offset:33280
    ds_read_b64_tr_b16 a[184:185], v3 offset:33792
    ds_read_b64_tr_b16 a[186:187], v3 offset:34304
    ds_read_b64_tr_b16 a[188:189], v3 offset:34816
    ds_read_b64_tr_b16 a[190:191], v3 offset:35328
    ds_read_b64_tr_b16 a[192:193], v3 offset:35840
    ds_read_b64_tr_b16 a[194:195], v3 offset:36352
    s_waitcnt lgkmcnt(0)
    s_waitcnt vmcnt(11)
    ds_read_b64_tr_b16 a[196:197], v3 offset:36864
    ds_read_b64_tr_b16 a[198:199], v3 offset:37376
    ds_read_b64_tr_b16 a[200:201], v3 offset:37888
    ds_read_b64_tr_b16 a[202:203], v3 offset:38400
    ds_read_b64_tr_b16 a[204:205], v3 offset:38912
    ds_read_b64_tr_b16 a[206:207], v3 offset:39424
    ds_read_b64_tr_b16 a[208:209], v3 offset:39936
    ds_read_b64_tr_b16 a[210:211], v3 offset:40448
    s_waitcnt lgkmcnt(0)
    s_waitcnt vmcnt(7)
    ds_read_b64_tr_b16 a[212:213], v3 offset:0
    ds_read_b64_tr_b16 a[214:215], v3 offset:512
    ds_read_b64_tr_b16 a[216:217], v3 offset:1024
    ds_read_b64_tr_b16 a[218:219], v3 offset:1536
    ds_read_b64_tr_b16 a[220:221], v3 offset:2048
    ds_read_b64_tr_b16 a[222:223], v3 offset:2560
    ds_read_b64_tr_b16 a[224:225], v3 offset:3072
    ds_read_b64_tr_b16 a[226:227], v3 offset:3584
    s_waitcnt lgkmcnt(0)
    s_waitcnt vmcnt(3)
    ds_read_b64_tr_b16 a[228:229], v3 offset:4096
    ds_read_b64_tr_b16 a[230:231], v3 offset:4608
    ds_read_b64_tr_b16 a[232:233], v3 offset:5120
    ds_read_b64_tr_b16 a[234:235], v3 offset:5632
    ds_read_b64_tr_b16 a[236:237], v3 offset:6144
    ds_read_b64_tr_b16 a[238:239], v3 offset:6656
    ds_read_b64_tr_b16 a[240:241], v3 offset:7168
    ds_read_b64_tr_b16 a[242:243], v3 offset:7680
    s_waitcnt lgkmcnt(0)
    s_waitcnt vmcnt(0)
    ds_read_b64_tr_b16 a[244:245], v3 offset:8192
    ds_read_b64_tr_b16 a[246:247], v3 offset:8704
    ds_read_b64_tr_b16 a[248:249], v3 offset:9216
    ds_read_b64_tr_b16 a[250:251], v3 offset:9728
    ds_read_b64_tr_b16 a[252:253], v3 offset:10240
    ds_read_b64_tr_b16 a[254:255], v3 offset:10752
    s_waitcnt lgkmcnt(0)
    s_mov_b32 s36, s4
    s_and_b32 s37, s5, 0xffff
    s_mov_b32 s38, 0x280000
    s_mov_b32 s39, 0x00020000
    s_mov_b32 s40, s26
    s_and_b32 s41, s27, 0xffff
    s_mov_b32 s42, 0x280000
    s_mov_b32 s43, 0x00020000
    v_lshlrev_b32 v2, 4, v1
    v_lshrrev_b32 v4, 5, v1
    v_mul_u32_u24 v3, 640, v4
    v_and_b32 v4, 31, v1
    v_lshl_add_u32 v3, v4, 4, v3
    s_mul_i32 s52, s3, 10240
    v_add_u32 v3, s52, v3
    v_and_b32 v5, 7, v1
    v_mul_u32_u24 v4, 640, v5
    v_lshrrev_b32 v6, 3, v1
    s_lshl_b32 s52, s3, 3
    v_add_u32 v6, s52, v6
    v_lshl_add_u32 v4, v6, 4, v4
    v_mul_u32_u24 v6, 1280, v6
    v_lshl_add_u32 v5, v5, 3, v6
    s_lshl_b32 s52, s91, 6
    v_add_u32 v5, s52, v5
    s_cmp_lg_u32 s3, 0
    s_cbranch_scc1 Lwkpd_79
Lwpd_78:
    s_sub_u32 s100, s100, 1
    s_cselect_b32 s100, 0, s100
    s_cbranch_scc1 Lwkpd_79
    buffer_load_dword v7, off, s[44:47], 0 offset:32 sc1
    s_waitcnt vmcnt(0)
    v_readfirstlane_b32 s95, v7
    s_nop 0
    s_lshr_b32 s95, s95, 16
    s_cmp_ge_u32 s95, 165
    s_cbranch_scc1 Lwkpd_79
    s_sleep 8
    s_branch Lwpd_78
Lwkpd_79:
    s_waitcnt vmcnt(0)
    s_mul_i32 s59, s3, 27648
    s_add_u32 s59, s59, 71303168
    s_lshl_b32 s60, s3, 16
    s_add_u32 s60, s60, 54525952
    s_barrier
    s_mov_b32 s55, 0
    s_mov_b32 s56, 0
    v_bfe_u32 v6, v1, 3, 2
    v_lshlrev_b32 v12, 10, v6
    v_lshrrev_b32 v6, 5, v1
    v_lshl_add_u32 v12, v6, 9, v12
    v_and_b32 v6, 7, v1
    v_lshl_add_u32 v12, v6, 4, v12
    s_lshl_b32 s54, s88, 7
    v_add_u32 v12, s54, v12
    v_mul_u32_u24 v13, 640, v6
    v_lshlrev_b32 v14, 3, v6
    v_lshrrev_b32 v6, 4, v1
    v_lshl_add_u32 v13, v6, 7, v13
    v_lshl_add_u32 v14, v6, 1, v14
    v_bfe_u32 v6, v1, 3, 1
    s_lshl_b32 s54, s3, 1
    v_add_u32 v6, s54, v6
    v_lshl_add_u32 v13, v6, 4, v13
    s_lshl_b32 s54, s88, 3
    v_add_u32 v6, s54, v6
    v_mov_b32 v7, 1280
    v_mad_u32_u24 v14, v6, v7, v14
    s_lshl_b32 s54, s91, 6
    v_add_u32 v14, s54, v14
    s_mov_b32 s57, 63
Lprep_80:
    v_mov_b32 v146, v144
    v_mov_b32 v147, v145
    s_mul_i32 s52, s57, 110592
    s_add_u32 s52, s52, s59
    s_mul_i32 s58, s57, 40960
    buffer_load_ushort v145, v14, s[36:39], s58 offen
    buffer_load_dwordx4 v[48:51], v12, s[32:35], s52 offen sc1
    s_add_u32 s52, s52, 4096
    buffer_load_dwordx4 v[52:55], v12, s[32:35], s52 offen sc1
    s_add_u32 s52, s52, 4096
    buffer_load_dwordx4 v[56:59], v12, s[32:35], s52 offen sc1
    s_add_u32 s52, s52, 4096
    buffer_load_dwordx4 v[60:63], v12, s[32:35], s52 offen sc1
    s_add_u32 s52, s52, 4096
    buffer_load_dwordx4 v[64:67], v12, s[32:35], s52 offen sc1
    s_add_u32 s52, s52, 4096
    buffer_load_dwordx4 v[68:71], v12, s[32:35], s52 offen sc1
    s_add_u32 s52, s52, 4096
    buffer_load_dwordx4 v[72:75], v12, s[32:35], s52 offen sc1
    s_add_u32 s52, s52, 4096
    v_add_u32 v6, s56, v3
    v_add_u32 v7, s56, v13
    s_waitcnt vmcnt(6)
    v_mfma_f32_32x32x16_bf16 v[16:31], v[148:151], v[48:51], 0
    v_mfma_f32_32x32x16_bf16 v[32:47], v[152:155], v[48:51], 0
    v_mfma_f32_32x32x16_bf16 v[112:127], v[156:159], v[48:51], 0
    v_mfma_f32_32x32x16_bf16 v[128:143], v[160:163], v[48:51], 0
    s_waitcnt vmcnt(5)
    v_mfma_f32_32x32x16_bf16 v[16:31], v[164:167], v[52:55], v[16:31]
    v_mfma_f32_32x32x16_bf16 v[32:47], v[168:171], v[52:55], v[32:47]
    v_mfma_f32_32x32x16_bf16 v[112:127], v[172:175], v[52:55], v[112:127]
    v_mfma_f32_32x32x16_bf16 v[128:143], v[176:179], v[52:55], v[128:143]
    s_waitcnt vmcnt(4)
    v_mfma_f32_32x32x16_bf16 v[16:31], v[180:183], v[56:59], v[16:31]
    v_mfma_f32_32x32x16_bf16 v[32:47], v[184:187], v[56:59], v[32:47]
    v_mfma_f32_32x32x16_bf16 v[112:127], v[188:191], v[56:59], v[112:127]
    v_mfma_f32_32x32x16_bf16 v[128:143], v[192:195], v[56:59], v[128:143]
    s_waitcnt vmcnt(3)
    v_mfma_f32_32x32x16_bf16 v[16:31], v[196:199], v[60:63], v[16:31]
    v_mfma_f32_32x32x16_bf16 v[32:47], v[200:203], v[60:63], v[32:47]
    v_mfma_f32_32x32x16_bf16 v[112:127], v[204:207], v[60:63], v[112:127]
    v_mfma_f32_32x32x16_bf16 v[128:143], v[208:211], v[60:63], v[128:143]
    s_waitcnt vmcnt(2)
    v_mfma_f32_32x32x16_bf16 v[16:31], v[212:215], v[64:67], v[16:31]
    v_mfma_f32_32x32x16_bf16 v[32:47], v[216:219], v[64:67], v[32:47]
    v_mfma_f32_32x32x16_bf16 v[112:127], v[220:223], v[64:67], v[112:127]
    v_mfma_f32_32x32x16_bf16 v[128:143], v[224:227], v[64:67], v[128:143]
    s_waitcnt vmcnt(1)
    v_mfma_f32_32x32x16_bf16 v[16:31], v[228:231], v[68:71], v[16:31]
    v_mfma_f32_32x32x16_bf16 v[32:47], v[232:235], v[68:71], v[32:47]
    v_mfma_f32_32x32x16_bf16 v[112:127], v[236:239], v[68:71], v[112:127]
    v_mfma_f32_32x32x16_bf16 v[128:143], v[240:243], v[68:71], v[128:143]
    s_waitcnt vmcnt(0)
    v_mfma_f32_32x32x16_bf16 v[16:31], v[244:247], v[72:75], v[16:31]
    v_mfma_f32_32x32x16_bf16 v[32:47], v[248:251], v[72:75], v[32:47]
    v_mfma_f32_32x32x16_bf16 v[112:127], v[252:255], v[72:75], v[112:127]
    s_xor_b32 s56, s56, 40960
    s_mov_b32 exec_lo, 0xff000000
    s_mov_b32 exec_hi, 0xff000000
    ds_write_b128 v6, v[128:131] offset:0
    ds_write_b128 v6, v[132:135] offset:1280
    ds_write_b128 v6, v[136:139] offset:2560
    ds_write_b128 v6, v[140:143] offset:3840
    s_mov_b32 exec_lo, 0xff
    s_mov_b32 exec_hi, 0xff
    ds_write_b128 v6, v[16:19] offset:0
    ds_write_b128 v6, v[20:23] offset:1280
    ds_write_b128 v6, v[24:27] offset:2560
    ds_write_b128 v6, v[28:31] offset:3840
    s_mov_b32 exec_lo, 0xff00
    s_mov_b32 exec_hi, 0xff00
    ds_write_b128 v6, v[32:35] offset:0
    ds_write_b128 v6, v[36:39] offset:1280
    ds_write_b128 v6, v[40:43] offset:2560
    ds_write_b128 v6, v[44:47] offset:3840
    s_mov_b32 exec_lo, 0xff0000
    s_mov_b32 exec_hi, 0xff0000
    ds_write_b128 v6, v[112:115] offset:0
    ds_write_b128 v6, v[116:119] offset:1280
    ds_write_b128 v6, v[120:123] offset:2560
    ds_write_b128 v6, v[124:127] offset:3840
    s_mov_b64 exec, -1
    s_waitcnt lgkmcnt(0)
    s_barrier
    ds_read_b128 v[16:19], v7 offset:0
    ds_read_b128 v[20:23], v7 offset:10240
    ds_read_b128 v[24:27], v7 offset:20480
    ds_read_b128 v[28:31], v7 offset:30720
    s_waitcnt lgkmcnt(2)
    v_add_f32 v16, v16, v20
    v_add_f32 v17, v17, v21
    v_add_f32 v18, v18, v22
    v_add_f32 v19, v19, v23
    s_waitcnt lgkmcnt(0)
    v_add_f32 v24, v24, v28
    v_add_f32 v25, v25, v29
    v_add_f32 v26, v26, v30
    v_add_f32 v27, v27, v31
    v_add_f32 v16, v16, v24
    v_add_f32 v17, v17, v25
    v_add_f32 v18, v18, v26
    v_add_f32 v19, v19, v27
    s_nop 0
    v_permlane32_swap_b32 v16, v18
    v_permlane32_swap_b32 v17, v19
    v_add_f32 v16, v16, v18
    v_add_f32 v17, v17, v19
    s_nop 1
    v_permlane16_swap_b32 v16, v17
    v_add_f32 v16, v16, v17
    v_cvt_pk_bf16_f32 v16, v16, v16
    v_lshlrev_b32 v16, 16, v16
    v_mul_f32 v17, -1.4426950408889634, v16
    v_exp_f32 v17, v17
    v_lshlrev_b32 v145, 16, v145
    v_add_f32 v17, 1.0, v17
    v_rcp_f32 v17, v17
    s_cmp_eq_u32 s57, 63
    s_mov_b32 s57, s89
    v_mul_f32 v144, v16, v17
    v_cvt_pk_bf16_f32 v144, v144, v144
    v_lshlrev_b32 v144, 16, v144
    s_cbranch_scc1 Lprep_80
    s_mul_i32 s52, s90, 110592
    s_add_u32 s52, s52, s59
    buffer_load_dwordx4 v[48:51], v2, s[32:35], s52 offen offset:0 sc1
    buffer_load_dwordx4 v[52:55], v2, s[32:35], s52 offen offset:1024 sc1
    buffer_load_dwordx4 v[56:59], v2, s[32:35], s52 offen offset:2048 sc1
    buffer_load_dwordx4 v[60:63], v2, s[32:35], s52 offen offset:3072 sc1
    s_add_u32 s52, s52, 4096
    buffer_load_dwordx4 v[64:67], v2, s[32:35], s52 offen offset:0 sc1
    buffer_load_dwordx4 v[68:71], v2, s[32:35], s52 offen offset:1024 sc1
    buffer_load_dwordx4 v[72:75], v2, s[32:35], s52 offen offset:2048 sc1
    buffer_load_dwordx4 v[76:79], v2, s[32:35], s52 offen offset:3072 sc1
    s_add_u32 s52, s52, 4096
    buffer_load_dwordx4 v[80:83], v2, s[32:35], s52 offen offset:0 sc1
    buffer_load_dwordx4 v[84:87], v2, s[32:35], s52 offen offset:1024 sc1
    buffer_load_dwordx4 v[88:91], v2, s[32:35], s52 offen offset:2048 sc1
    buffer_load_dwordx4 v[92:95], v2, s[32:35], s52 offen offset:3072 sc1
    s_add_u32 s52, s52, 4096
    buffer_load_dwordx4 v[96:99], v2, s[32:35], s52 offen offset:0 sc1
    buffer_load_dwordx4 v[100:103], v2, s[32:35], s52 offen offset:1024 sc1
    buffer_load_dwordx4 v[104:107], v2, s[32:35], s52 offen offset:2048 sc1
    buffer_load_dwordx4 v[108:111], v2, s[32:35], s52 offen offset:3072 sc1
    s_add_u32 s52, s52, 4096
    buffer_load_dwordx4 v[112:115], v2, s[32:35], s52 offen offset:0 sc1
    buffer_load_dwordx4 v[116:119], v2, s[32:35], s52 offen offset:1024 sc1
    buffer_load_dwordx4 v[120:123], v2, s[32:35], s52 offen offset:2048 sc1
    buffer_load_dwordx4 v[124:127], v2, s[32:35], s52 offen offset:3072 sc1
    s_add_u32 s52, s52, 4096
    buffer_load_dwordx4 v[128:131], v2, s[32:35], s52 offen offset:0 sc1
    buffer_load_dwordx4 v[132:135], v2, s[32:35], s52 offen offset:1024 sc1
    buffer_load_dwordx4 v[136:139], v2, s[32:35], s52 offen offset:2048 sc1
    buffer_load_dwordx4 v[140:143], v2, s[32:35], s52 offen offset:3072 sc1
Lout_81:
    s_lshl_b32 s94, s90, 7
    s_add_u32 s94, s94, 91228160
    s_cmp_lg_u32 s3, 0
    s_cbranch_scc1 Lwkat_83
Lwat_82:
    s_sub_u32 s100, s100, 1
    s_cselect_b32 s100, 0, s100
    s_cbranch_scc1 Lwkat_83
    buffer_load_dword v7, off, s[32:35], s94 sc1
    s_waitcnt vmcnt(0)
    v_readfirstlane_b32 s95, v7
    s_nop 0
    s_cmp_ge_u32 s95, 32
    s_cbranch_scc1 Lwkat_83
    s_sleep 8
    s_branch Lwat_82
Lwkat_83:
    s_waitcnt vmcnt(0)
    s_barrier
    s_lshl_b32 s53, s90, 18
    s_add_u32 s53, s53, s60
    s_mul_i32 s58, s90, 40960
    s_add_u32 s55, s55, 1
    s_add_u32 s57, s90, s93
    s_cmp_lt_u32 s55, s92
    s_cselect_b32 s57, s57, s90
    v_mfma_f32_32x32x16_bf16 v[32:47], v[148:151], v[48:51], 0
    s_add_u32 s52, s52, 4096
    buffer_load_dwordx4 v[48:51], v2, s[32:35], s52 offen offset:0 sc1
    v_mfma_f32_32x32x16_bf16 v[32:47], v[152:155], v[52:55], v[32:47]
    buffer_load_dwordx4 v[52:55], v2, s[32:35], s52 offen offset:1024 sc1
    v_mfma_f32_32x32x16_bf16 v[32:47], v[156:159], v[56:59], v[32:47]
    buffer_load_dwordx4 v[56:59], v2, s[32:35], s52 offen offset:2048 sc1
    v_mfma_f32_32x32x16_bf16 v[32:47], v[160:163], v[60:63], v[32:47]
    buffer_load_dwordx4 v[60:63], v2, s[32:35], s53 offen offset:0 sc1
    v_mfma_f32_32x32x16_bf16 v[32:47], v[164:167], v[64:67], v[32:47]
    buffer_load_dwordx4 v[64:67], v2, s[32:35], s53 offen offset:1024 sc1
    v_mfma_f32_32x32x16_bf16 v[32:47], v[168:171], v[68:71], v[32:47]
    buffer_load_dwordx4 v[68:71], v2, s[32:35], s53 offen offset:2048 sc1
    v_mfma_f32_32x32x16_bf16 v[32:47], v[172:175], v[72:75], v[32:47]
    buffer_load_dwordx4 v[72:75], v2, s[32:35], s53 offen offset:3072 sc1
    v_mfma_f32_32x32x16_bf16 v[32:47], v[176:179], v[76:79], v[32:47]
    s_add_u32 s53, s53, 4096
    buffer_load_dwordx4 v[76:79], v2, s[32:35], s53 offen offset:0 sc1
    v_mfma_f32_32x32x16_bf16 v[32:47], v[180:183], v[80:83], v[32:47]
    buffer_load_dwordx4 v[80:83], v2, s[32:35], s53 offen offset:1024 sc1
    v_mfma_f32_32x32x16_bf16 v[32:47], v[184:187], v[84:87], v[32:47]
    buffer_load_dwordx4 v[84:87], v2, s[32:35], s53 offen offset:2048 sc1
    v_mfma_f32_32x32x16_bf16 v[32:47], v[188:191], v[88:91], v[32:47]
    buffer_load_dwordx4 v[88:91], v2, s[32:35], s53 offen offset:3072 sc1
    v_mfma_f32_32x32x16_bf16 v[32:47], v[192:195], v[92:95], v[32:47]
    s_add_u32 s53, s53, 4096
    buffer_load_dwordx4 v[92:95], v2, s[32:35], s53 offen offset:0 sc1
    v_mfma_f32_32x32x16_bf16 v[32:47], v[196:199], v[96:99], v[32:47]
    buffer_load_dwordx4 v[96:99], v2, s[32:35], s53 offen offset:1024 sc1
    v_mfma_f32_32x32x16_bf16 v[32:47], v[200:203], v[100:103], v[32:47]
    buffer_load_dwordx4 v[100:103], v2, s[32:35], s53 offen offset:2048 sc1
    v_mfma_f32_32x32x16_bf16 v[32:47], v[204:207], v[104:107], v[32:47]
    buffer_load_dwordx4 v[104:107], v2, s[32:35], s53 offen offset:3072 sc1
    v_mfma_f32_32x32x16_bf16 v[32:47], v[208:211], v[108:111], v[32:47]
    s_add_u32 s53, s53, 4096
    buffer_load_dwordx4 v[108:111], v2, s[32:35], s53 offen offset:0 sc1
    v_mfma_f32_32x32x16_bf16 v[32:47], v[212:215], v[112:115], v[32:47]
    buffer_load_dwordx4 v[112:115], v2, s[32:35], s53 offen offset:1024 sc1
    v_mfma_f32_32x32x16_bf16 v[32:47], v[216:219], v[116:119], v[32:47]
    buffer_load_dwordx4 v[116:119], v2, s[32:35], s53 offen offset:2048 sc1
    v_mfma_f32_32x32x16_bf16 v[32:47], v[220:223], v[120:123], v[32:47]
    buffer_load_dwordx4 v[120:123], v2, s[32:35], s53 offen offset:3072 sc1
    v_mfma_f32_32x32x16_bf16 v[32:47], v[224:227], v[124:127], v[32:47]
    s_add_u32 s53, s53, 4096
    buffer_load_dwordx4 v[124:127], v2, s[32:35], s53 offen offset:0 sc1
    v_mfma_f32_32x32x16_bf16 v[32:47], v[228:231], v[128:131], v[32:47]
    buffer_load_dwordx4 v[128:131], v2, s[32:35], s53 offen offset:1024 sc1
    v_mfma_f32_32x32x16_bf16 v[32:47], v[232:235], v[132:135], v[32:47]
    buffer_load_dwordx4 v[132:135], v2, s[32:35], s53 offen offset:2048 sc1
    v_mfma_f32_32x32x16_bf16 v[32:47], v[236:239], v[136:139], v[32:47]
    buffer_load_dwordx4 v[136:139], v2, s[32:35], s53 offen offset:3072 sc1
    v_mfma_f32_32x32x16_bf16 v[32:47], v[240:243], v[140:143], v[32:47]
    s_add_u32 s53, s53, 4096
    buffer_load_dwordx4 v[140:143], v2, s[32:35], s53 offen offset:0 sc1
    s_waitcnt vmcnt(23)
    v_mfma_f32_32x32x16_bf16 v[32:47], v[244:247], v[48:51], v[32:47]
    buffer_load_dwordx4 v[48:51], v2, s[32:35], s53 offen offset:1024 sc1
    s_waitcnt vmcnt(23)
    v_mfma_f32_32x32x16_bf16 v[32:47], v[248:251], v[52:55], v[32:47]
    buffer_load_dwordx4 v[52:55], v2, s[32:35], s53 offen offset:2048 sc1
    s_waitcnt vmcnt(23)
    v_mfma_f32_32x32x16_bf16 v[32:47], v[252:255], v[56:59], v[32:47]
    buffer_load_dwordx4 v[56:59], v2, s[32:35], s53 offen offset:3072 sc1
    s_waitcnt vmcnt(23)
    v_mfma_f32_32x32x16_bf16 v[16:31], a[0:3], v[60:63], 0
    s_add_u32 s53, s53, 4096
    buffer_load_dwordx4 v[60:63], v2, s[32:35], s53 offen offset:0 sc1
    s_waitcnt vmcnt(23)
    v_mfma_f32_32x32x16_bf16 v[16:31], a[4:7], v[64:67], v[16:31]
    buffer_load_dwordx4 v[64:67], v2, s[32:35], s53 offen offset:1024 sc1
    s_waitcnt vmcnt(23)
    v_mfma_f32_32x32x16_bf16 v[16:31], a[8:11], v[68:71], v[16:31]
    buffer_load_dwordx4 v[68:71], v2, s[32:35], s53 offen offset:2048 sc1
    s_waitcnt vmcnt(23)
    v_mfma_f32_32x32x16_bf16 v[16:31], a[12:15], v[72:75], v[16:31]
    buffer_load_dwordx4 v[72:75], v2, s[32:35], s53 offen offset:3072 sc1
    v_add_u32 v6, s56, v3
    v_add_u32 v7, s56, v4
    ds_write_b128 v6, v[32:35] offset:5120
    ds_write_b128 v6, v[36:39] offset:6400
    ds_write_b128 v6, v[40:43] offset:7680
    ds_write_b128 v6, v[44:47] offset:8960
    s_waitcnt vmcnt(23)
    v_mfma_f32_32x32x16_bf16 v[16:31], a[16:19], v[76:79], v[16:31]
    s_add_u32 s53, s53, 4096
    buffer_load_dwordx4 v[76:79], v2, s[32:35], s53 offen offset:0 sc1
    s_waitcnt vmcnt(23)
    v_mfma_f32_32x32x16_bf16 v[16:31], a[20:23], v[80:83], v[16:31]
    buffer_load_dwordx4 v[80:83], v2, s[32:35], s53 offen offset:1024 sc1
    s_waitcnt vmcnt(23)
    v_mfma_f32_32x32x16_bf16 v[16:31], a[24:27], v[84:87], v[16:31]
    buffer_load_dwordx4 v[84:87], v2, s[32:35], s53 offen offset:2048 sc1
    s_waitcnt vmcnt(23)
    v_mfma_f32_32x32x16_bf16 v[16:31], a[28:31], v[88:91], v[16:31]
    buffer_load_dwordx4 v[88:91], v2, s[32:35], s53 offen offset:3072 sc1
    s_waitcnt vmcnt(23)
    v_mfma_f32_32x32x16_bf16 v[16:31], a[32:35], v[92:95], v[16:31]
    s_add_u32 s53, s53, 4096
    buffer_load_dwordx4 v[92:95], v2, s[32:35], s53 offen offset:0 sc1
    s_waitcnt vmcnt(23)
    v_mfma_f32_32x32x16_bf16 v[16:31], a[36:39], v[96:99], v[16:31]
    buffer_load_dwordx4 v[96:99], v2, s[32:35], s53 offen offset:1024 sc1
    s_waitcnt vmcnt(23)
    v_mfma_f32_32x32x16_bf16 v[16:31], a[40:43], v[100:103], v[16:31]
    buffer_load_dwordx4 v[100:103], v2, s[32:35], s53 offen offset:2048 sc1
    s_waitcnt vmcnt(23)
    v_mfma_f32_32x32x16_bf16 v[16:31], a[44:47], v[104:107], v[16:31]
    buffer_load_dwordx4 v[104:107], v2, s[32:35], s53 offen offset:3072 sc1
    s_waitcnt vmcnt(23)
    v_mfma_f32_32x32x16_bf16 v[16:31], a[48:51], v[108:111], v[16:31]
    s_add_u32 s53, s53, 4096
    buffer_load_dwordx4 v[108:111], v2, s[32:35], s53 offen offset:0 sc1
    s_waitcnt vmcnt(23)
    v_mfma_f32_32x32x16_bf16 v[16:31], a[52:55], v[112:115], v[16:31]
    buffer_load_dwordx4 v[112:115], v2, s[32:35], s53 offen offset:1024 sc1
    s_waitcnt vmcnt(23)
    v_mfma_f32_32x32x16_bf16 v[16:31], a[56:59], v[116:119], v[16:31]
    buffer_load_dwordx4 v[116:119], v2, s[32:35], s53 offen offset:2048 sc1
    s_waitcnt vmcnt(23)
    v_mfma_f32_32x32x16_bf16 v[16:31], a[60:63], v[120:123], v[16:31]
    buffer_load_dwordx4 v[120:123], v2, s[32:35], s53 offen offset:3072 sc1
    s_waitcnt vmcnt(23)
    v_mfma_f32_32x32x16_bf16 v[16:31], a[64:67], v[124:127], v[16:31]
    s_add_u32 s53, s53, 4096
    buffer_load_dwordx4 v[124:127], v2, s[32:35], s53 offen offset:0 sc1
    s_waitcnt vmcnt(23)
    v_mfma_f32_32x32x16_bf16 v[16:31], a[68:71], v[128:131], v[16:31]
    buffer_load_dwordx4 v[128:131], v2, s[32:35], s53 offen offset:1024 sc1
    s_waitcnt vmcnt(23)
    v_mfma_f32_32x32x16_bf16 v[16:31], a[72:75], v[132:135], v[16:31]
    buffer_load_dwordx4 v[132:135], v2, s[32:35], s53 offen offset:2048 sc1
    s_waitcnt vmcnt(23)
    v_mfma_f32_32x32x16_bf16 v[16:31], a[76:79], v[136:139], v[16:31]
    buffer_load_dwordx4 v[136:139], v2, s[32:35], s53 offen offset:3072 sc1
    s_waitcnt vmcnt(23)
    v_mfma_f32_32x32x16_bf16 v[16:31], a[80:83], v[140:143], v[16:31]
    s_add_u32 s53, s53, 4096
    buffer_load_dwordx4 v[140:143], v2, s[32:35], s53 offen offset:0 sc1
    s_waitcnt vmcnt(23)
    v_mfma_f32_32x32x16_bf16 v[16:31], a[84:87], v[48:51], v[16:31]
    buffer_load_dwordx4 v[48:51], v2, s[32:35], s53 offen offset:1024 sc1
    s_waitcnt vmcnt(23)
    v_mfma_f32_32x32x16_bf16 v[16:31], a[88:91], v[52:55], v[16:31]
    buffer_load_dwordx4 v[52:55], v2, s[32:35], s53 offen offset:2048 sc1
    s_waitcnt vmcnt(23)
    v_mfma_f32_32x32x16_bf16 v[16:31], a[92:95], v[56:59], v[16:31]
    buffer_load_dwordx4 v[56:59], v2, s[32:35], s53 offen offset:3072 sc1
    s_waitcnt vmcnt(23)
    v_mfma_f32_32x32x16_bf16 v[16:31], a[96:99], v[60:63], v[16:31]
    s_add_u32 s53, s53, 4096
    buffer_load_dwordx4 v[60:63], v2, s[32:35], s53 offen offset:0 sc1
    s_waitcnt vmcnt(23)
    v_mfma_f32_32x32x16_bf16 v[16:31], a[100:103], v[64:67], v[16:31]
    buffer_load_dwordx4 v[64:67], v2, s[32:35], s53 offen offset:1024 sc1
    s_waitcnt vmcnt(23)
    v_mfma_f32_32x32x16_bf16 v[16:31], a[104:107], v[68:71], v[16:31]
    buffer_load_dwordx4 v[68:71], v2, s[32:35], s53 offen offset:2048 sc1
    s_waitcnt vmcnt(23)
    v_mfma_f32_32x32x16_bf16 v[16:31], a[108:111], v[72:75], v[16:31]
    buffer_load_dwordx4 v[72:75], v2, s[32:35], s53 offen offset:3072 sc1
    s_waitcnt vmcnt(23)
    v_mfma_f32_32x32x16_bf16 v[16:31], a[112:115], v[76:79], v[16:31]
    s_add_u32 s53, s53, 4096
    buffer_load_dwordx4 v[76:79], v2, s[32:35], s53 offen offset:0 sc1
    s_waitcnt vmcnt(23)
    v_mfma_f32_32x32x16_bf16 v[16:31], a[116:119], v[80:83], v[16:31]
    buffer_load_dwordx4 v[80:83], v2, s[32:35], s53 offen offset:1024 sc1
    s_waitcnt vmcnt(23)
    v_mfma_f32_32x32x16_bf16 v[16:31], a[120:123], v[84:87], v[16:31]
    buffer_load_dwordx4 v[84:87], v2, s[32:35], s53 offen offset:2048 sc1
    s_waitcnt vmcnt(23)
    v_mfma_f32_32x32x16_bf16 v[16:31], a[124:127], v[88:91], v[16:31]
    buffer_load_dwordx4 v[88:91], v2, s[32:35], s53 offen offset:3072 sc1
    s_waitcnt vmcnt(23)
    v_mfma_f32_32x32x16_bf16 v[16:31], a[128:131], v[92:95], v[16:31]
    s_add_u32 s53, s53, 4096
    buffer_load_dwordx4 v[92:95], v2, s[32:35], s53 offen offset:0 sc1
    s_waitcnt vmcnt(23)
    v_mfma_f32_32x32x16_bf16 v[16:31], a[132:135], v[96:99], v[16:31]
    buffer_load_dwordx4 v[96:99], v2, s[32:35], s53 offen offset:1024 sc1
    s_waitcnt vmcnt(23)
    v_mfma_f32_32x32x16_bf16 v[16:31], a[136:139], v[100:103], v[16:31]
    buffer_load_dwordx4 v[100:103], v2, s[32:35], s53 offen offset:2048 sc1
    s_waitcnt vmcnt(23)
    v_mfma_f32_32x32x16_bf16 v[16:31], a[140:143], v[104:107], v[16:31]
    buffer_load_dwordx4 v[104:107], v2, s[32:35], s53 offen offset:3072 sc1
    s_waitcnt vmcnt(23)
    v_mfma_f32_32x32x16_bf16 v[16:31], a[144:147], v[108:111], v[16:31]
    s_add_u32 s53, s53, 4096
    buffer_load_dwordx4 v[108:111], v2, s[32:35], s53 offen offset:0 sc1
    s_waitcnt vmcnt(23)
    v_mfma_f32_32x32x16_bf16 v[16:31], a[148:151], v[112:115], v[16:31]
    buffer_load_dwordx4 v[112:115], v2, s[32:35], s53 offen offset:1024 sc1
    s_waitcnt vmcnt(23)
    v_mfma_f32_32x32x16_bf16 v[16:31], a[152:155], v[116:119], v[16:31]
    buffer_load_dwordx4 v[116:119], v2, s[32:35], s53 offen offset:2048 sc1
    s_waitcnt vmcnt(23)
    v_mfma_f32_32x32x16_bf16 v[16:31], a[156:159], v[120:123], v[16:31]
    buffer_load_dwordx4 v[120:123], v2, s[32:35], s53 offen offset:3072 sc1
    s_waitcnt vmcnt(23)
    v_mfma_f32_32x32x16_bf16 v[16:31], a[160:163], v[124:127], v[16:31]
    buffer_load_dwordx2 v[8:9], v5, s[36:39], s58 offen
    s_waitcnt vmcnt(23)
    v_mfma_f32_32x32x16_bf16 v[16:31], a[164:167], v[128:131], v[16:31]
    s_waitcnt vmcnt(22)
    v_mfma_f32_32x32x16_bf16 v[16:31], a[168:171], v[132:135], v[16:31]
    s_waitcnt vmcnt(21)
    v_mfma_f32_32x32x16_bf16 v[16:31], a[172:175], v[136:139], v[16:31]
    s_waitcnt vmcnt(20)
    v_mfma_f32_32x32x16_bf16 v[16:31], a[176:179], v[140:143], v[16:31]
    s_waitcnt vmcnt(19)
    v_mfma_f32_32x32x16_bf16 v[16:31], a[180:183], v[48:51], v[16:31]
    s_mul_i32 s52, s57, 110592
    s_add_u32 s52, s52, s59
    buffer_load_dwordx4 v[48:51], v2, s[32:35], s52 offen offset:0 sc1
    s_waitcnt vmcnt(19)
    v_mfma_f32_32x32x16_bf16 v[16:31], a[184:187], v[52:55], v[16:31]
    buffer_load_dwordx4 v[52:55], v2, s[32:35], s52 offen offset:1024 sc1
    s_waitcnt vmcnt(19)
    v_mfma_f32_32x32x16_bf16 v[16:31], a[188:191], v[56:59], v[16:31]
    buffer_load_dwordx4 v[56:59], v2, s[32:35], s52 offen offset:2048 sc1
    s_waitcnt vmcnt(19)
    v_mfma_f32_32x32x16_bf16 v[16:31], a[192:195], v[60:63], v[16:31]
    buffer_load_dwordx4 v[60:63], v2, s[32:35], s52 offen offset:3072 sc1
    s_waitcnt vmcnt(19)
    v_mfma_f32_32x32x16_bf16 v[16:31], a[196:199], v[64:67], v[16:31]
    s_add_u32 s52, s52, 4096
    buffer_load_dwordx4 v[64:67], v2, s[32:35], s52 offen offset:0 sc1
    s_waitcnt vmcnt(19)
    v_mfma_f32_32x32x16_bf16 v[16:31], a[200:203], v[68:71], v[16:31]
    buffer_load_dwordx4 v[68:71], v2, s[32:35], s52 offen offset:1024 sc1
    s_waitcnt vmcnt(19)
    v_mfma_f32_32x32x16_bf16 v[16:31], a[204:207], v[72:75], v[16:31]
    buffer_load_dwordx4 v[72:75], v2, s[32:35], s52 offen offset:2048 sc1
    s_waitcnt vmcnt(19)
    v_mfma_f32_32x32x16_bf16 v[16:31], a[208:211], v[76:79], v[16:31]
    buffer_load_dwordx4 v[76:79], v2, s[32:35], s52 offen offset:3072 sc1
    s_waitcnt vmcnt(19)
    v_mfma_f32_32x32x16_bf16 v[16:31], a[212:215], v[80:83], v[16:31]
    s_add_u32 s52, s52, 4096
    buffer_load_dwordx4 v[80:83], v2, s[32:35], s52 offen offset:0 sc1
    s_waitcnt vmcnt(19)
    v_mfma_f32_32x32x16_bf16 v[16:31], a[216:219], v[84:87], v[16:31]
    buffer_load_dwordx4 v[84:87], v2, s[32:35], s52 offen offset:1024 sc1
    s_waitcnt vmcnt(19)
    v_mfma_f32_32x32x16_bf16 v[16:31], a[220:223], v[88:91], v[16:31]
    buffer_load_dwordx4 v[88:91], v2, s[32:35], s52 offen offset:2048 sc1
    s_waitcnt vmcnt(19)
    v_mfma_f32_32x32x16_bf16 v[16:31], a[224:227], v[92:95], v[16:31]
    buffer_load_dwordx4 v[92:95], v2, s[32:35], s52 offen offset:3072 sc1
    s_waitcnt vmcnt(19)
    v_mfma_f32_32x32x16_bf16 v[16:31], a[228:231], v[96:99], v[16:31]
    s_add_u32 s52, s52, 4096
    buffer_load_dwordx4 v[96:99], v2, s[32:35], s52 offen offset:0 sc1
    s_waitcnt vmcnt(19)
    v_mfma_f32_32x32x16_bf16 v[16:31], a[232:235], v[100:103], v[16:31]
    buffer_load_dwordx4 v[100:103], v2, s[32:35], s52 offen offset:1024 sc1
    s_waitcnt vmcnt(19)
    v_mfma_f32_32x32x16_bf16 v[16:31], a[236:239], v[104:107], v[16:31]
    buffer_load_dwordx4 v[104:107], v2, s[32:35], s52 offen offset:2048 sc1
    s_waitcnt vmcnt(19)
    v_mfma_f32_32x32x16_bf16 v[16:31], a[240:243], v[108:111], v[16:31]
    buffer_load_dwordx4 v[108:111], v2, s[32:35], s52 offen offset:3072 sc1
    s_waitcnt vmcnt(19)
    v_mfma_f32_32x32x16_bf16 v[16:31], a[244:247], v[112:115], v[16:31]
    s_add_u32 s52, s52, 4096
    buffer_load_dwordx4 v[112:115], v2, s[32:35], s52 offen offset:0 sc1
    s_waitcnt vmcnt(19)
    v_mfma_f32_32x32x16_bf16 v[16:31], a[248:251], v[116:119], v[16:31]
    buffer_load_dwordx4 v[116:119], v2, s[32:35], s52 offen offset:1024 sc1
    s_waitcnt vmcnt(19)
    v_mfma_f32_32x32x16_bf16 v[16:31], a[252:255], v[120:123], v[16:31]
    buffer_load_dwordx4 v[120:123], v2, s[32:35], s52 offen offset:2048 sc1
    buffer_load_dwordx4 v[124:127], v2, s[32:35], s52 offen offset:3072 sc1
    s_add_u32 s52, s52, 4096
    buffer_load_dwordx4 v[128:131], v2, s[32:35], s52 offen offset:0 sc1
    buffer_load_dwordx4 v[132:135], v2, s[32:35], s52 offen offset:1024 sc1
    buffer_load_dwordx4 v[136:139], v2, s[32:35], s52 offen offset:2048 sc1
    buffer_load_dwordx4 v[140:143], v2, s[32:35], s52 offen offset:3072 sc1
    s_nop 4
    ds_write_b128 v6, v[16:19] offset:0
    ds_write_b128 v6, v[20:23] offset:1280
    ds_write_b128 v6, v[24:27] offset:2560
    ds_write_b128 v6, v[28:31] offset:3840
    s_waitcnt lgkmcnt(0)
    s_barrier
    ds_read_b128 v[32:35], v7 offset:5120
    ds_read_b128 v[36:39], v7 offset:15360
    ds_read_b128 v[40:43], v7 offset:25600
    ds_read_b128 v[44:47], v7 offset:35840
    ds_read_b128 v[16:19], v7 offset:0
    ds_read_b128 v[20:23], v7 offset:10240
    ds_read_b128 v[24:27], v7 offset:20480
    ds_read_b128 v[28:31], v7 offset:30720
    s_xor_b32 s56, s56, 40960
    s_waitcnt lgkmcnt(6)
    v_add_f32 v32, v32, v36
    s_waitcnt lgkmcnt(4)
    v_add_f32 v40, v40, v44
    v_add_f32 v33, v33, v37
    v_add_f32 v41, v41, v45
    v_add_f32 v34, v34, v38
    v_add_f32 v42, v42, v46
    v_add_f32 v35, v35, v39
    v_add_f32 v43, v43, v47
    v_add_f32 v32, v32, v40
    v_add_f32 v33, v33, v41
    v_add_f32 v34, v34, v42
    v_add_f32 v35, v35, v43
    v_cvt_pk_bf16_f32 v10, v32, v33
    v_lshlrev_b32 v32, 16, v10
    v_and_b32 v33, 0xffff0000, v10
    v_cvt_pk_bf16_f32 v11, v34, v35
    v_lshlrev_b32 v34, 16, v11
    v_and_b32 v35, 0xffff0000, v11
    v_mul_f32 v36, -1.4426950408889634, v32
    v_mul_f32 v37, -1.4426950408889634, v33
    v_mul_f32 v38, -1.4426950408889634, v34
    v_mul_f32 v39, -1.4426950408889634, v35
    v_exp_f32 v36, v36
    v_exp_f32 v37, v37
    v_exp_f32 v38, v38
    v_exp_f32 v39, v39
    v_add_f32 v36, 1.0, v36
    v_add_f32 v37, 1.0, v37
    v_add_f32 v38, 1.0, v38
    v_add_f32 v39, 1.0, v39
    v_rcp_f32 v36, v36
    v_rcp_f32 v37, v37
    v_rcp_f32 v38, v38
    v_rcp_f32 v39, v39
    v_mul_f32 v32, v32, v36
    v_mul_f32 v33, v33, v37
    v_mul_f32 v34, v34, v38
    v_mul_f32 v35, v35, v39
    v_cvt_pk_bf16_f32 v10, v32, v33
    v_lshlrev_b32 v32, 16, v10
    v_and_b32 v33, 0xffff0000, v10
    v_cvt_pk_bf16_f32 v11, v34, v35
    v_lshlrev_b32 v34, 16, v11
    v_and_b32 v35, 0xffff0000, v11
    s_waitcnt lgkmcnt(2)
    v_add_f32 v16, v16, v20
    s_waitcnt lgkmcnt(0)
    v_add_f32 v24, v24, v28
    v_add_f32 v17, v17, v21
    v_add_f32 v25, v25, v29
    v_add_f32 v18, v18, v22
    v_add_f32 v26, v26, v30
    v_add_f32 v19, v19, v23
    v_add_f32 v27, v27, v31
    v_add_f32 v16, v16, v24
    v_add_f32 v17, v17, v25
    v_add_f32 v18, v18, v26
    v_add_f32 v19, v19, v27
    v_cvt_pk_bf16_f32 v10, v16, v17
    v_lshlrev_b32 v16, 16, v10
    v_and_b32 v17, 0xffff0000, v10
    v_cvt_pk_bf16_f32 v11, v18, v19
    v_lshlrev_b32 v18, 16, v11
    v_and_b32 v19, 0xffff0000, v11
    v_mul_f32 v16, v16, v32
    v_mul_f32 v17, v17, v33
    v_mul_f32 v18, v18, v34
    v_mul_f32 v19, v19, v35
    v_cvt_pk_bf16_f32 v10, v16, v17
    v_lshlrev_b32 v16, 16, v10
    v_and_b32 v17, 0xffff0000, v10
    v_cvt_pk_bf16_f32 v11, v18, v19
    v_lshlrev_b32 v18, 16, v11
    v_and_b32 v19, 0xffff0000, v11
    s_waitcnt vmcnt(24)
    v_lshlrev_b32 v32, 16, v8
    v_and_b32 v33, 0xffff0000, v8
    v_lshlrev_b32 v34, 16, v9
    v_and_b32 v35, 0xffff0000, v9
    v_add_f32 v16, v16, v32
    v_add_f32 v17, v17, v33
    v_add_f32 v18, v18, v34
    v_add_f32 v19, v19, v35
    v_cvt_pk_bf16_f32 v10, v16, v17
    v_cvt_pk_bf16_f32 v11, v18, v19
    buffer_store_dwordx2 v[10:11], v5, s[40:43], s58 offen
    s_mov_b32 s90, s57
    s_cmp_lt_u32 s55, s92
    s_cbranch_scc1 Lout_81
    s_waitcnt vmcnt(0)
    s_mov_b32 s90, s89
    s_mov_b32 s52, 0xffbfffbf
    s_mov_b32 s57, 0x4000
    s_branch Lsplit_84
Lredo_85:
    s_sub_u32 s57, s57, 1
    s_cselect_b32 s52, 0x7fbf7fbf, s52
    s_lshl_b32 s53, s90, 18
    s_add_u32 s53, s53, s60
    s_nop 7
    s_nop 7
    buffer_load_dwordx4 v[48:51], v12, s[32:35], s53 offen sc1
    s_add_u32 s53, s53, 4096
    buffer_load_dwordx4 v[52:55], v12, s[32:35], s53 offen sc1
    s_add_u32 s53, s53, 4096
    buffer_load_dwordx4 v[56:59], v12, s[32:35], s53 offen sc1
    s_add_u32 s53, s53, 4096
    buffer_load_dwordx4 v[60:63], v12, s[32:35], s53 offen sc1
    s_add_u32 s53, s53, 4096
    buffer_load_dwordx4 v[64:67], v12, s[32:35], s53 offen sc1
    s_add_u32 s53, s53, 4096
    buffer_load_dwordx4 v[68:71], v12, s[32:35], s53 offen sc1
    s_add_u32 s53, s53, 4096
    buffer_load_dwordx4 v[72:75], v12, s[32:35], s53 offen sc1
    s_add_u32 s53, s53, 4096
    buffer_load_dwordx4 v[76:79], v12, s[32:35], s53 offen sc1
    s_add_u32 s53, s53, 4096
    buffer_load_dwordx4 v[80:83], v12, s[32:35], s53 offen sc1
    s_add_u32 s53, s53, 4096
    buffer_load_dwordx4 v[84:87], v12, s[32:35], s53 offen sc1
    s_add_u32 s53, s53, 4096
    buffer_load_dwordx4 v[88:91], v12, s[32:35], s53 offen sc1
    s_add_u32 s53, s53, 4096
    buffer_load_dwordx4 v[92:95], v12, s[32:35], s53 offen sc1
    s_add_u32 s53, s53, 4096
    buffer_load_dwordx4 v[96:99], v12, s[32:35], s53 offen sc1
    s_add_u32 s53, s53, 4096
    buffer_load_dwordx4 v[100:103], v12, s[32:35], s53 offen sc1
    s_add_u32 s53, s53, 4096
    buffer_load_dwordx4 v[104:107], v12, s[32:35], s53 offen sc1
    s_add_u32 s53, s53, 4096
    buffer_load_dwordx4 v[108:111], v12, s[32:35], s53 offen sc1
    s_add_u32 s53, s53, 4096
    s_branch Lredo_86
Lsplit_84:
    s_mul_i32 s58, s90, 40960
    s_lshl_b32 s94, s90, 7
    s_add_u32 s94, s94, 91228160
    s_cmp_lg_u32 s3, 0
    s_cbranch_scc1 Lwkat_88
Lwat_87:
    s_sub_u32 s100, s100, 1
    s_cselect_b32 s100, 0, s100
    s_cbranch_scc1 Lwkat_88
    buffer_load_dword v7, off, s[32:35], s94 sc1
    s_waitcnt vmcnt(0)
    v_readfirstlane_b32 s95, v7
    s_nop 0
    s_cmp_ge_u32 s95, 32
    s_cbranch_scc1 Lwkat_88
    s_sleep 8
    s_branch Lwat_87
Lwkat_88:
    s_waitcnt vmcnt(0)
    s_barrier
    s_add_u32 s55, s55, 1
    s_lshl_b32 s53, s90, 18
    s_add_u32 s53, s53, s60
    buffer_load_dwordx4 v[48:51], v12, s[32:35], s53 offen sc1
    s_add_u32 s53, s53, 4096
    buffer_load_dwordx4 v[52:55], v12, s[32:35], s53 offen sc1
    s_add_u32 s53, s53, 4096
    buffer_load_dwordx4 v[56:59], v12, s[32:35], s53 offen sc1
    s_add_u32 s53, s53, 4096
    buffer_load_dwordx4 v[60:63], v12, s[32:35], s53 offen sc1
    s_add_u32 s53, s53, 4096
    buffer_load_dwordx4 v[64:67], v12, s[32:35], s53 offen sc1
    s_add_u32 s53, s53, 4096
    buffer_load_dwordx4 v[68:71], v12, s[32:35], s53 offen sc1
    s_add_u32 s53, s53, 4096
    buffer_load_dwordx4 v[72:75], v12, s[32:35], s53 offen sc1
    s_add_u32 s53, s53, 4096
    buffer_load_dwordx4 v[76:79], v12, s[32:35], s53 offen sc1
    s_add_u32 s53, s53, 4096
    buffer_load_dwordx4 v[80:83], v12, s[32:35], s53 offen sc1
    s_add_u32 s53, s53, 4096
    buffer_load_dwordx4 v[84:87], v12, s[32:35], s53 offen sc1
    s_add_u32 s53, s53, 4096
    buffer_load_dwordx4 v[88:91], v12, s[32:35], s53 offen sc1
    s_add_u32 s53, s53, 4096
    buffer_load_dwordx4 v[92:95], v12, s[32:35], s53 offen sc1
    s_add_u32 s53, s53, 4096
    buffer_load_dwordx4 v[96:99], v12, s[32:35], s53 offen sc1
    s_add_u32 s53, s53, 4096
    buffer_load_dwordx4 v[100:103], v12, s[32:35], s53 offen sc1
    s_add_u32 s53, s53, 4096
    buffer_load_dwordx4 v[104:107], v12, s[32:35], s53 offen sc1
    s_add_u32 s53, s53, 4096
    buffer_load_dwordx4 v[108:111], v12, s[32:35], s53 offen sc1
    s_add_u32 s53, s53, 4096
Lredo_86:
    v_add_u32 v6, s56, v3
    v_add_u32 v7, s56, v13
    s_waitcnt vmcnt(15)
    v_mfma_f32_32x32x16_bf16 v[16:31], a[0:3], v[48:51], 0
    v_cmp_eq_u32 vcc, s52, v48
    v_mfma_f32_32x32x16_bf16 v[32:47], a[4:7], v[48:51], 0
    s_cbranch_vccnz Lredo_85
    v_mfma_f32_32x32x16_bf16 v[112:127], a[8:11], v[48:51], 0
    v_mfma_f32_32x32x16_bf16 v[128:143], a[12:15], v[48:51], 0
    s_waitcnt vmcnt(14)
    v_mfma_f32_32x32x16_bf16 v[16:31], a[16:19], v[52:55], v[16:31]
    v_cmp_eq_u32 vcc, s52, v52
    v_mfma_f32_32x32x16_bf16 v[32:47], a[20:23], v[52:55], v[32:47]
    s_cbranch_vccnz Lredo_85
    v_mfma_f32_32x32x16_bf16 v[112:127], a[24:27], v[52:55], v[112:127]
    v_mfma_f32_32x32x16_bf16 v[128:143], a[28:31], v[52:55], v[128:143]
    s_waitcnt vmcnt(13)
    v_mfma_f32_32x32x16_bf16 v[16:31], a[32:35], v[56:59], v[16:31]
    v_cmp_eq_u32 vcc, s52, v56
    v_mfma_f32_32x32x16_bf16 v[32:47], a[36:39], v[56:59], v[32:47]
    s_cbranch_vccnz Lredo_85
    v_mfma_f32_32x32x16_bf16 v[112:127], a[40:43], v[56:59], v[112:127]
    v_mfma_f32_32x32x16_bf16 v[128:143], a[44:47], v[56:59], v[128:143]
    s_waitcnt vmcnt(12)
    v_mfma_f32_32x32x16_bf16 v[16:31], a[48:51], v[60:63], v[16:31]
    v_cmp_eq_u32 vcc, s52, v60
    v_mfma_f32_32x32x16_bf16 v[32:47], a[52:55], v[60:63], v[32:47]
    s_cbranch_vccnz Lredo_85
    v_mfma_f32_32x32x16_bf16 v[112:127], a[56:59], v[60:63], v[112:127]
    v_mfma_f32_32x32x16_bf16 v[128:143], a[60:63], v[60:63], v[128:143]
    s_waitcnt vmcnt(11)
    v_mfma_f32_32x32x16_bf16 v[16:31], a[64:67], v[64:67], v[16:31]
    v_cmp_eq_u32 vcc, s52, v64
    v_mfma_f32_32x32x16_bf16 v[32:47], a[68:71], v[64:67], v[32:47]
    s_cbranch_vccnz Lredo_85
    v_mfma_f32_32x32x16_bf16 v[112:127], a[72:75], v[64:67], v[112:127]
    v_mfma_f32_32x32x16_bf16 v[128:143], a[76:79], v[64:67], v[128:143]
    s_waitcnt vmcnt(10)
    v_mfma_f32_32x32x16_bf16 v[16:31], a[80:83], v[68:71], v[16:31]
    v_cmp_eq_u32 vcc, s52, v68
    v_mfma_f32_32x32x16_bf16 v[32:47], a[84:87], v[68:71], v[32:47]
    s_cbranch_vccnz Lredo_85
    v_mfma_f32_32x32x16_bf16 v[112:127], a[88:91], v[68:71], v[112:127]
    v_mfma_f32_32x32x16_bf16 v[128:143], a[92:95], v[68:71], v[128:143]
    s_waitcnt vmcnt(9)
    v_mfma_f32_32x32x16_bf16 v[16:31], a[96:99], v[72:75], v[16:31]
    v_cmp_eq_u32 vcc, s52, v72
    v_mfma_f32_32x32x16_bf16 v[32:47], a[100:103], v[72:75], v[32:47]
    s_cbranch_vccnz Lredo_85
    v_mfma_f32_32x32x16_bf16 v[112:127], a[104:107], v[72:75], v[112:127]
    v_mfma_f32_32x32x16_bf16 v[128:143], a[108:111], v[72:75], v[128:143]
    s_waitcnt vmcnt(8)
    v_mfma_f32_32x32x16_bf16 v[16:31], a[112:115], v[76:79], v[16:31]
    v_cmp_eq_u32 vcc, s52, v76
    v_mfma_f32_32x32x16_bf16 v[32:47], a[116:119], v[76:79], v[32:47]
    s_cbranch_vccnz Lredo_85
    v_mfma_f32_32x32x16_bf16 v[112:127], a[120:123], v[76:79], v[112:127]
    v_mfma_f32_32x32x16_bf16 v[128:143], a[124:127], v[76:79], v[128:143]
    s_waitcnt vmcnt(7)
    v_mfma_f32_32x32x16_bf16 v[16:31], a[128:131], v[80:83], v[16:31]
    v_cmp_eq_u32 vcc, s52, v80
    v_mfma_f32_32x32x16_bf16 v[32:47], a[132:135], v[80:83], v[32:47]
    s_cbranch_vccnz Lredo_85
    v_mfma_f32_32x32x16_bf16 v[112:127], a[136:139], v[80:83], v[112:127]
    v_mfma_f32_32x32x16_bf16 v[128:143], a[140:143], v[80:83], v[128:143]
    s_waitcnt vmcnt(6)
    v_mfma_f32_32x32x16_bf16 v[16:31], a[144:147], v[84:87], v[16:31]
    v_cmp_eq_u32 vcc, s52, v84
    v_mfma_f32_32x32x16_bf16 v[32:47], a[148:151], v[84:87], v[32:47]
    s_cbranch_vccnz Lredo_85
    v_mfma_f32_32x32x16_bf16 v[112:127], a[152:155], v[84:87], v[112:127]
    v_mfma_f32_32x32x16_bf16 v[128:143], a[156:159], v[84:87], v[128:143]
    s_waitcnt vmcnt(5)
    v_mfma_f32_32x32x16_bf16 v[16:31], a[160:163], v[88:91], v[16:31]
    v_cmp_eq_u32 vcc, s52, v88
    v_mfma_f32_32x32x16_bf16 v[32:47], a[164:167], v[88:91], v[32:47]
    s_cbranch_vccnz Lredo_85
    v_mfma_f32_32x32x16_bf16 v[112:127], a[168:171], v[88:91], v[112:127]
    v_mfma_f32_32x32x16_bf16 v[128:143], a[172:175], v[88:91], v[128:143]
    s_waitcnt vmcnt(4)
    v_mfma_f32_32x32x16_bf16 v[16:31], a[176:179], v[92:95], v[16:31]
    v_cmp_eq_u32 vcc, s52, v92
    v_mfma_f32_32x32x16_bf16 v[32:47], a[180:183], v[92:95], v[32:47]
    s_cbranch_vccnz Lredo_85
    v_mfma_f32_32x32x16_bf16 v[112:127], a[184:187], v[92:95], v[112:127]
    v_mfma_f32_32x32x16_bf16 v[128:143], a[188:191], v[92:95], v[128:143]
    s_waitcnt vmcnt(3)
    v_mfma_f32_32x32x16_bf16 v[16:31], a[192:195], v[96:99], v[16:31]
    v_cmp_eq_u32 vcc, s52, v96
    v_mfma_f32_32x32x16_bf16 v[32:47], a[196:199], v[96:99], v[32:47]
    s_cbranch_vccnz Lredo_85
    v_mfma_f32_32x32x16_bf16 v[112:127], a[200:203], v[96:99], v[112:127]
    v_mfma_f32_32x32x16_bf16 v[128:143], a[204:207], v[96:99], v[128:143]
    s_waitcnt vmcnt(2)
    v_mfma_f32_32x32x16_bf16 v[16:31], a[208:211], v[100:103], v[16:31]
    v_cmp_eq_u32 vcc, s52, v100
    v_mfma_f32_32x32x16_bf16 v[32:47], a[212:215], v[100:103], v[32:47]
    s_cbranch_vccnz Lredo_85
    v_mfma_f32_32x32x16_bf16 v[112:127], a[216:219], v[100:103], v[112:127]
    v_mfma_f32_32x32x16_bf16 v[128:143], a[220:223], v[100:103], v[128:143]
    s_waitcnt vmcnt(1)
    v_mfma_f32_32x32x16_bf16 v[16:31], a[224:227], v[104:107], v[16:31]
    v_cmp_eq_u32 vcc, s52, v104
    v_mfma_f32_32x32x16_bf16 v[32:47], a[228:231], v[104:107], v[32:47]
    s_cbranch_vccnz Lredo_85
    v_mfma_f32_32x32x16_bf16 v[112:127], a[232:235], v[104:107], v[112:127]
    v_mfma_f32_32x32x16_bf16 v[128:143], a[236:239], v[104:107], v[128:143]
    s_waitcnt vmcnt(0)
    v_mfma_f32_32x32x16_bf16 v[16:31], a[240:243], v[108:111], v[16:31]
    v_cmp_eq_u32 vcc, s52, v108
    v_mfma_f32_32x32x16_bf16 v[32:47], a[244:247], v[108:111], v[32:47]
    s_cbranch_vccnz Lredo_85
    v_mfma_f32_32x32x16_bf16 v[112:127], a[248:251], v[108:111], v[112:127]
    v_mfma_f32_32x32x16_bf16 v[128:143], a[252:255], v[108:111], v[128:143]
    s_xor_b32 s56, s56, 40960
    s_mov_b32 exec_lo, 0xff
    s_mov_b32 exec_hi, 0xff
    ds_write_b128 v6, v[16:19] offset:0
    ds_write_b128 v6, v[20:23] offset:1280
    ds_write_b128 v6, v[24:27] offset:2560
    ds_write_b128 v6, v[28:31] offset:3840
    s_mov_b32 exec_lo, 0xff00
    s_mov_b32 exec_hi, 0xff00
    ds_write_b128 v6, v[32:35] offset:0
    ds_write_b128 v6, v[36:39] offset:1280
    ds_write_b128 v6, v[40:43] offset:2560
    ds_write_b128 v6, v[44:47] offset:3840
    s_mov_b32 exec_lo, 0xff0000
    s_mov_b32 exec_hi, 0xff0000
    ds_write_b128 v6, v[112:115] offset:0
    ds_write_b128 v6, v[116:119] offset:1280
    ds_write_b128 v6, v[120:123] offset:2560
    ds_write_b128 v6, v[124:127] offset:3840
    s_mov_b32 exec_lo, 0xff000000
    s_mov_b32 exec_hi, 0xff000000
    ds_write_b128 v6, v[128:131] offset:0
    ds_write_b128 v6, v[132:135] offset:1280
    ds_write_b128 v6, v[136:139] offset:2560
    ds_write_b128 v6, v[140:143] offset:3840
    s_mov_b64 exec, -1
    s_waitcnt lgkmcnt(0)
    s_barrier
    ds_read_b128 v[16:19], v7 offset:0
    ds_read_b128 v[20:23], v7 offset:10240
    ds_read_b128 v[24:27], v7 offset:20480
    ds_read_b128 v[28:31], v7 offset:30720
    s_waitcnt lgkmcnt(2)
    v_add_f32 v16, v16, v20
    v_add_f32 v17, v17, v21
    v_add_f32 v18, v18, v22
    v_add_f32 v19, v19, v23
    s_waitcnt lgkmcnt(0)
    v_add_f32 v24, v24, v28
    v_add_f32 v25, v25, v29
    v_add_f32 v26, v26, v30
    v_add_f32 v27, v27, v31
    v_add_f32 v16, v16, v24
    v_add_f32 v17, v17, v25
    v_add_f32 v18, v18, v26
    v_add_f32 v19, v19, v27
    s_nop 0
    v_permlane32_swap_b32 v16, v18
    v_permlane32_swap_b32 v17, v19
    v_add_f32 v16, v16, v18
    v_add_f32 v17, v17, v19
    s_nop 1
    v_permlane16_swap_b32 v16, v17
    v_add_f32 v16, v16, v17
    v_cvt_pk_bf16_f32 v16, v16, v16
    v_lshlrev_b32 v16, 16, v16
    v_mul_f32 v16, v16, v144
    v_cvt_pk_bf16_f32 v16, v16, v16
    v_lshlrev_b32 v16, 16, v16
    v_add_f32 v16, v16, v145
    s_add_u32 s90, s90, 2
    v_cvt_pk_bf16_f32 v16, v16, v16
    s_cmp_lt_u32 s90, 64
    buffer_store_short v16, v14, s[40:43], s58 offen
    v_mov_b32 v144, v146
    v_mov_b32 v145, v147
    s_cbranch_scc1 Lsplit_84
    s_waitcnt vmcnt(0)
    s_endpgm
Lattn:
    s_sub_u32 s90, s101, 165
    s_lshl_b32 s90, s90, 2
    s_add_u32 s90, s90, s3
    s_lshl_b32 s94, s90, 10
    s_add_u32 s94, s94, 91226112
    s_cmp_lt_u32 s90, 11
    s_cselect_b32 s94, s94, 0x10000000
    v_lshlrev_b32 v1, 4, v0
    v_and_b32 v1, 0x3f0, v1
    v_mov_b32 v152, 0
    v_mov_b32 v153, 0
    v_mov_b32 v154, 0
    v_mov_b32 v155, 0
    buffer_store_dwordx4 v[152:155], v1, s[32:35], s94 offen sc1
    s_mov_b32 s94, s90
Llnloop:
    s_mov_b32 s36, s4
    s_and_b32 s37, s5, 0xffff
    s_mov_b32 s38, 0x280000
    s_mov_b32 s39, 0x00020000
    v_and_b32 v1, 63, v0
    v_and_b32 v3, 7, v1
    v_lshrrev_b32 v4, 3, v1
    v_mul_u32_u24 v5, 1280, v3
    v_lshl_add_u32 v5, v4, 4, v5
    v_lshlrev_b32 v6, 9, v4
    v_lshl_add_u32 v6, v3, 4, v6
    s_mul_i32 s52, s94, 10240
    s_lshr_b32 s53, s94, 2
    s_mul_i32 s53, s53, 40960
    s_and_b32 s54, s94, 3
    s_lshl_b32 s54, s54, 7
    s_add_u32 s53, s53, s54
    buffer_load_dwordx4 v[16:19], v5, s[36:39], s52 offen offset:0
    buffer_load_dwordx4 v[20:23], v5, s[36:39], s52 offen offset:128
    buffer_load_dwordx4 v[24:27], v5, s[36:39], s52 offen offset:256
    buffer_load_dwordx4 v[28:31], v5, s[36:39], s52 offen offset:384
    buffer_load_dwordx4 v[32:35], v5, s[36:39], s52 offen offset:512
    buffer_load_dwordx4 v[36:39], v5, s[36:39], s52 offen offset:640
    buffer_load_dwordx4 v[40:43], v5, s[36:39], s52 offen offset:768
    buffer_load_dwordx4 v[44:47], v5, s[36:39], s52 offen offset:896
    buffer_load_dwordx4 v[48:51], v5, s[36:39], s52 offen offset:1024
    buffer_load_dwordx4 v[52:55], v5, s[36:39], s52 offen offset:1152
    s_mov_b32 s55, 0xffff0000
    s_waitcnt vmcnt(9)
    v_lshlrev_b32 v64, 16, v16
    v_and_b32 v65, s55, v16
    v_lshlrev_b32 v66, 16, v17
    v_and_b32 v67, s55, v17
    v_lshlrev_b32 v68, 16, v18
    v_and_b32 v69, s55, v18
    v_lshlrev_b32 v70, 16, v19
    v_and_b32 v71, s55, v19
    s_waitcnt vmcnt(8)
    v_lshlrev_b32 v72, 16, v20
    v_and_b32 v73, s55, v20
    v_lshlrev_b32 v74, 16, v21
    v_and_b32 v75, s55, v21
    v_lshlrev_b32 v76, 16, v22
    v_and_b32 v77, s55, v22
    v_lshlrev_b32 v78, 16, v23
    v_and_b32 v79, s55, v23
    s_waitcnt vmcnt(7)
    v_lshlrev_b32 v80, 16, v24
    v_and_b32 v81, s55, v24
    v_lshlrev_b32 v82, 16, v25
    v_and_b32 v83, s55, v25
    v_lshlrev_b32 v84, 16, v26
    v_and_b32 v85, s55, v26
    v_lshlrev_b32 v86, 16, v27
    v_and_b32 v87, s55, v27
    s_waitcnt vmcnt(6)
    v_lshlrev_b32 v88, 16, v28
    v_and_b32 v89, s55, v28
    v_lshlrev_b32 v90, 16, v29
    v_and_b32 v91, s55, v29
    v_lshlrev_b32 v92, 16, v30
    v_and_b32 v93, s55, v30
    v_lshlrev_b32 v94, 16, v31
    v_and_b32 v95, s55, v31
    s_waitcnt vmcnt(5)
    v_lshlrev_b32 v96, 16, v32
    v_and_b32 v97, s55, v32
    v_lshlrev_b32 v98, 16, v33
    v_and_b32 v99, s55, v33
    v_lshlrev_b32 v100, 16, v34
    v_and_b32 v101, s55, v34
    v_lshlrev_b32 v102, 16, v35
    v_and_b32 v103, s55, v35
    s_waitcnt vmcnt(4)
    v_lshlrev_b32 v104, 16, v36
    v_and_b32 v105, s55, v36
    v_lshlrev_b32 v106, 16, v37
    v_and_b32 v107, s55, v37
    v_lshlrev_b32 v108, 16, v38
    v_and_b32 v109, s55, v38
    v_lshlrev_b32 v110, 16, v39
    v_and_b32 v111, s55, v39
    s_waitcnt vmcnt(3)
    v_lshlrev_b32 v112, 16, v40
    v_and_b32 v113, s55, v40
    v_lshlrev_b32 v114, 16, v41
    v_and_b32 v115, s55, v41
    v_lshlrev_b32 v116, 16, v42
    v_and_b32 v117, s55, v42
    v_lshlrev_b32 v118, 16, v43
    v_and_b32 v119, s55, v43
    s_waitcnt vmcnt(2)
    v_lshlrev_b32 v120, 16, v44
    v_and_b32 v121, s55, v44
    v_lshlrev_b32 v122, 16, v45
    v_and_b32 v123, s55, v45
    v_lshlrev_b32 v124, 16, v46
    v_and_b32 v125, s55, v46
    v_lshlrev_b32 v126, 16, v47
    v_and_b32 v127, s55, v47
    s_waitcnt vmcnt(1)
    v_lshlrev_b32 v128, 16, v48
    v_and_b32 v129, s55, v48
    v_lshlrev_b32 v130, 16, v49
    v_and_b32 v131, s55, v49
    v_lshlrev_b32 v132, 16, v50
    v_and_b32 v133, s55, v50
    v_lshlrev_b32 v134, 16, v51
    v_and_b32 v135, s55, v51
    s_waitcnt vmcnt(0)
    v_lshlrev_b32 v136, 16, v52
    v_and_b32 v137, s55, v52
    v_lshlrev_b32 v138, 16, v53
    v_and_b32 v139, s55, v53
    v_lshlrev_b32 v140, 16, v54
    v_and_b32 v141, s55, v54
    v_lshlrev_b32 v142, 16, v55
    v_and_b32 v143, s55, v55
    v_add_f32 v8, v64, v68
    v_add_f32 v9, v65, v69
    v_add_f32 v10, v66, v70
    v_add_f32 v11, v67, v71
    v_add_f32 v8, v8, v72
    v_add_f32 v9, v9, v73
    v_add_f32 v10, v10, v74
    v_add_f32 v11, v11, v75
    v_add_f32 v8, v8, v76
    v_add_f32 v9, v9, v77
    v_add_f32 v10, v10, v78
    v_add_f32 v11, v11, v79
    v_add_f32 v8, v8, v80
    v_add_f32 v9, v9, v81
    v_add_f32 v10, v10, v82
    v_add_f32 v11, v11, v83
    v_add_f32 v8, v8, v84
    v_add_f32 v9, v9, v85
    v_add_f32 v10, v10, v86
    v_add_f32 v11, v11, v87
    v_add_f32 v8, v8, v88
    v_add_f32 v9, v9, v89
    v_add_f32 v10, v10, v90
    v_add_f32 v11, v11, v91
    v_add_f32 v8, v8, v92
    v_add_f32 v9, v9, v93
    v_add_f32 v10, v10, v94
    v_add_f32 v11, v11, v95
    v_add_f32 v8, v8, v96
    v_add_f32 v9, v9, v97
    v_add_f32 v10, v10, v98
    v_add_f32 v11, v11, v99
    v_add_f32 v8, v8, v100
    v_add_f32 v9, v9, v101
    v_add_f32 v10, v10, v102
    v_add_f32 v11, v11, v103
    v_add_f32 v8, v8, v104
    v_add_f32 v9, v9, v105
    v_add_f32 v10, v10, v106
    v_add_f32 v11, v11, v107
    v_add_f32 v8, v8, v108
    v_add_f32 v9, v9, v109
    v_add_f32 v10, v10, v110
    v_add_f32 v11, v11, v111
    v_add_f32 v8, v8, v112
    v_add_f32 v9, v9, v113
    v_add_f32 v10, v10, v114
    v_add_f32 v11, v11, v115
    v_add_f32 v8, v8, v116
    v_add_f32 v9, v9, v117
    v_add_f32 v10, v10, v118
    v_add_f32 v11, v11, v119
    v_add_f32 v8, v8, v120
    v_add_f32 v9, v9, v121
    v_add_f32 v10, v10, v122
    v_add_f32 v11, v11, v123
    v_add_f32 v8, v8, v124
    v_add_f32 v9, v9, v125
    v_add_f32 v10, v10, v126
    v_add_f32 v11, v11, v127
    v_add_f32 v8, v8, v128
    v_add_f32 v9, v9, v129
    v_add_f32 v10, v10, v130
    v_add_f32 v11, v11, v131
    v_add_f32 v8, v8, v132
    v_add_f32 v9, v9, v133
    v_add_f32 v10, v10, v134
    v_add_f32 v11, v11, v135
    v_add_f32 v8, v8, v136
    v_add_f32 v9, v9, v137
    v_add_f32 v10, v10, v138
    v_add_f32 v11, v11, v139
    v_add_f32 v8, v8, v140
    v_add_f32 v9, v9, v141
    v_add_f32 v10, v10, v142
    v_add_f32 v11, v11, v143
    v_add_f32 v8, v8, v9
    v_add_f32 v10, v10, v11
    v_add_f32 v8, v8, v10
    s_nop 1
    v_add_f32_dpp v8, v8, v8 row_ror:8 row_mask:0xf bank_mask:0xf
    v_mov_b32 v9, v8
    s_nop 1
    v_permlane16_swap_b32 v8, v9
    v_add_f32 v8, v8, v9
    v_mov_b32 v9, v8
    s_nop 1
    v_permlane32_swap_b32 v8, v9
    v_add_f32 v8, v8, v9
    v_mul_f32 v8, 0.0015625, v8
    v_sub_f32 v56, v64, v8
    v_sub_f32 v57, v65, v8
    v_sub_f32 v58, v66, v8
    v_sub_f32 v59, v67, v8
    v_mul_f32 v10, v56, v56
    v_mul_f32 v11, v57, v57
    v_mul_f32 v12, v58, v58
    v_mul_f32 v13, v59, v59
    v_sub_f32 v56, v68, v8
    v_sub_f32 v57, v69, v8
    v_sub_f32 v58, v70, v8
    v_sub_f32 v59, v71, v8
    v_fmac_f32 v10, v56, v56
    v_fmac_f32 v11, v57, v57
    v_fmac_f32 v12, v58, v58
    v_fmac_f32 v13, v59, v59
    v_sub_f32 v56, v72, v8
    v_sub_f32 v57, v73, v8
    v_sub_f32 v58, v74, v8
    v_sub_f32 v59, v75, v8
    v_fmac_f32 v10, v56, v56
    v_fmac_f32 v11, v57, v57
    v_fmac_f32 v12, v58, v58
    v_fmac_f32 v13, v59, v59
    v_sub_f32 v56, v76, v8
    v_sub_f32 v57, v77, v8
    v_sub_f32 v58, v78, v8
    v_sub_f32 v59, v79, v8
    v_fmac_f32 v10, v56, v56
    v_fmac_f32 v11, v57, v57
    v_fmac_f32 v12, v58, v58
    v_fmac_f32 v13, v59, v59
    v_sub_f32 v56, v80, v8
    v_sub_f32 v57, v81, v8
    v_sub_f32 v58, v82, v8
    v_sub_f32 v59, v83, v8
    v_fmac_f32 v10, v56, v56
    v_fmac_f32 v11, v57, v57
    v_fmac_f32 v12, v58, v58
    v_fmac_f32 v13, v59, v59
    v_sub_f32 v56, v84, v8
    v_sub_f32 v57, v85, v8
    v_sub_f32 v58, v86, v8
    v_sub_f32 v59, v87, v8
    v_fmac_f32 v10, v56, v56
    v_fmac_f32 v11, v57, v57
    v_fmac_f32 v12, v58, v58
    v_fmac_f32 v13, v59, v59
    v_sub_f32 v56, v88, v8
    v_sub_f32 v57, v89, v8
    v_sub_f32 v58, v90, v8
    v_sub_f32 v59, v91, v8
    v_fmac_f32 v10, v56, v56
    v_fmac_f32 v11, v57, v57
    v_fmac_f32 v12, v58, v58
    v_fmac_f32 v13, v59, v59
    v_sub_f32 v56, v92, v8
    v_sub_f32 v57, v93, v8
    v_sub_f32 v58, v94, v8
    v_sub_f32 v59, v95, v8
    v_fmac_f32 v10, v56, v56
    v_fmac_f32 v11, v57, v57
    v_fmac_f32 v12, v58, v58
    v_fmac_f32 v13, v59, v59
    v_sub_f32 v56, v96, v8
    v_sub_f32 v57, v97, v8
    v_sub_f32 v58, v98, v8
    v_sub_f32 v59, v99, v8
    v_fmac_f32 v10, v56, v56
    v_fmac_f32 v11, v57, v57
    v_fmac_f32 v12, v58, v58
    v_fmac_f32 v13, v59, v59
    v_sub_f32 v56, v100, v8
    v_sub_f32 v57, v101, v8
    v_sub_f32 v58, v102, v8
    v_sub_f32 v59, v103, v8
    v_fmac_f32 v10, v56, v56
    v_fmac_f32 v11, v57, v57
    v_fmac_f32 v12, v58, v58
    v_fmac_f32 v13, v59, v59
    v_sub_f32 v56, v104, v8
    v_sub_f32 v57, v105, v8
    v_sub_f32 v58, v106, v8
    v_sub_f32 v59, v107, v8
    v_fmac_f32 v10, v56, v56
    v_fmac_f32 v11, v57, v57
    v_fmac_f32 v12, v58, v58
    v_fmac_f32 v13, v59, v59
    v_sub_f32 v56, v108, v8
    v_sub_f32 v57, v109, v8
    v_sub_f32 v58, v110, v8
    v_sub_f32 v59, v111, v8
    v_fmac_f32 v10, v56, v56
    v_fmac_f32 v11, v57, v57
    v_fmac_f32 v12, v58, v58
    v_fmac_f32 v13, v59, v59
    v_sub_f32 v56, v112, v8
    v_sub_f32 v57, v113, v8
    v_sub_f32 v58, v114, v8
    v_sub_f32 v59, v115, v8
    v_fmac_f32 v10, v56, v56
    v_fmac_f32 v11, v57, v57
    v_fmac_f32 v12, v58, v58
    v_fmac_f32 v13, v59, v59
    v_sub_f32 v56, v116, v8
    v_sub_f32 v57, v117, v8
    v_sub_f32 v58, v118, v8
    v_sub_f32 v59, v119, v8
    v_fmac_f32 v10, v56, v56
    v_fmac_f32 v11, v57, v57
    v_fmac_f32 v12, v58, v58
    v_fmac_f32 v13, v59, v59
    v_sub_f32 v56, v120, v8
    v_sub_f32 v57, v121, v8
    v_sub_f32 v58, v122, v8
    v_sub_f32 v59, v123, v8
    v_fmac_f32 v10, v56, v56
    v_fmac_f32 v11, v57, v57
    v_fmac_f32 v12, v58, v58
    v_fmac_f32 v13, v59, v59
    v_sub_f32 v56, v124, v8
    v_sub_f32 v57, v125, v8
    v_sub_f32 v58, v126, v8
    v_sub_f32 v59, v127, v8
    v_fmac_f32 v10, v56, v56
    v_fmac_f32 v11, v57, v57
    v_fmac_f32 v12, v58, v58
    v_fmac_f32 v13, v59, v59
    v_sub_f32 v56, v128, v8
    v_sub_f32 v57, v129, v8
    v_sub_f32 v58, v130, v8
    v_sub_f32 v59, v131, v8
    v_fmac_f32 v10, v56, v56
    v_fmac_f32 v11, v57, v57
    v_fmac_f32 v12, v58, v58
    v_fmac_f32 v13, v59, v59
    v_sub_f32 v56, v132, v8
    v_sub_f32 v57, v133, v8
    v_sub_f32 v58, v134, v8
    v_sub_f32 v59, v135, v8
    v_fmac_f32 v10, v56, v56
    v_fmac_f32 v11, v57, v57
    v_fmac_f32 v12, v58, v58
    v_fmac_f32 v13, v59, v59
    v_sub_f32 v56, v136, v8
    v_sub_f32 v57, v137, v8
    v_sub_f32 v58, v138, v8
    v_sub_f32 v59, v139, v8
    v_fmac_f32 v10, v56, v56
    v_fmac_f32 v11, v57, v57
    v_fmac_f32 v12, v58, v58
    v_fmac_f32 v13, v59, v59
    v_sub_f32 v56, v140, v8
    v_sub_f32 v57, v141, v8
    v_sub_f32 v58, v142, v8
    v_sub_f32 v59, v143, v8
    v_fmac_f32 v10, v56, v56
    v_fmac_f32 v11, v57, v57
    v_fmac_f32 v12, v58, v58
    v_fmac_f32 v13, v59, v59
    v_add_f32 v10, v10, v11
    v_add_f32 v12, v12, v13
    v_add_f32 v10, v10, v12
    s_nop 1
    v_add_f32_dpp v10, v10, v10 row_ror:8 row_mask:0xf bank_mask:0xf
    v_mov_b32 v9, v10
    s_nop 1
    v_permlane16_swap_b32 v10, v9
    v_add_f32 v10, v10, v9
    v_mov_b32 v9, v10
    s_nop 1
    v_permlane32_swap_b32 v10, v9
    v_add_f32 v10, v10, v9
    v_mul_f32 v10, 0.0015625, v10
    v_cvt_pk_bf16_f32 v9, v8, v10
    v_lshlrev_b32 v8, 16, v9
    v_and_b32 v10, s55, v9
    v_add_f32 v10, 0x3727c5ac, v10
    v_cvt_pk_bf16_f32 v10, v10, v10
    v_lshlrev_b32 v10, 16, v10
    v_sqrt_f32 v10, v10
    s_nop 0
    v_cvt_pk_bf16_f32 v10, v10, v10
    v_lshlrev_b32 v10, 16, v10
    v_rcp_f32 v10, v10
    v_sub_f32 v64, v64, v8
    v_sub_f32 v65, v65, v8
    v_cvt_pk_bf16_f32 v16, v64, v65
    v_lshlrev_b32 v64, 16, v16
    v_and_b32 v65, s55, v16
    v_mul_f32 v64, v64, v10
    v_mul_f32 v65, v65, v10
    v_cvt_pk_bf16_f32 v16, v64, v65
    v_sub_f32 v66, v66, v8
    v_sub_f32 v67, v67, v8
    v_cvt_pk_bf16_f32 v17, v66, v67
    v_lshlrev_b32 v66, 16, v17
    v_and_b32 v67, s55, v17
    v_mul_f32 v66, v66, v10
    v_mul_f32 v67, v67, v10
    v_cvt_pk_bf16_f32 v17, v66, v67
    v_sub_f32 v68, v68, v8
    v_sub_f32 v69, v69, v8
    v_cvt_pk_bf16_f32 v18, v68, v69
    v_lshlrev_b32 v68, 16, v18
    v_and_b32 v69, s55, v18
    v_mul_f32 v68, v68, v10
    v_mul_f32 v69, v69, v10
    v_cvt_pk_bf16_f32 v18, v68, v69
    v_sub_f32 v70, v70, v8
    v_sub_f32 v71, v71, v8
    v_cvt_pk_bf16_f32 v19, v70, v71
    v_lshlrev_b32 v70, 16, v19
    v_and_b32 v71, s55, v19
    v_mul_f32 v70, v70, v10
    v_mul_f32 v71, v71, v10
    v_cvt_pk_bf16_f32 v19, v70, v71
    buffer_store_dwordx4 v[16:19], v6, s[32:35], s53 offen sc1
    s_add_u32 s53, s53, 4096
    v_sub_f32 v72, v72, v8
    v_sub_f32 v73, v73, v8
    v_cvt_pk_bf16_f32 v20, v72, v73
    v_lshlrev_b32 v72, 16, v20
    v_and_b32 v73, s55, v20
    v_mul_f32 v72, v72, v10
    v_mul_f32 v73, v73, v10
    v_cvt_pk_bf16_f32 v20, v72, v73
    v_sub_f32 v74, v74, v8
    v_sub_f32 v75, v75, v8
    v_cvt_pk_bf16_f32 v21, v74, v75
    v_lshlrev_b32 v74, 16, v21
    v_and_b32 v75, s55, v21
    v_mul_f32 v74, v74, v10
    v_mul_f32 v75, v75, v10
    v_cvt_pk_bf16_f32 v21, v74, v75
    v_sub_f32 v76, v76, v8
    v_sub_f32 v77, v77, v8
    v_cvt_pk_bf16_f32 v22, v76, v77
    v_lshlrev_b32 v76, 16, v22
    v_and_b32 v77, s55, v22
    v_mul_f32 v76, v76, v10
    v_mul_f32 v77, v77, v10
    v_cvt_pk_bf16_f32 v22, v76, v77
    v_sub_f32 v78, v78, v8
    v_sub_f32 v79, v79, v8
    v_cvt_pk_bf16_f32 v23, v78, v79
    v_lshlrev_b32 v78, 16, v23
    v_and_b32 v79, s55, v23
    v_mul_f32 v78, v78, v10
    v_mul_f32 v79, v79, v10
    v_cvt_pk_bf16_f32 v23, v78, v79
    buffer_store_dwordx4 v[20:23], v6, s[32:35], s53 offen sc1
    s_add_u32 s53, s53, 4096
    v_sub_f32 v80, v80, v8
    v_sub_f32 v81, v81, v8
    v_cvt_pk_bf16_f32 v24, v80, v81
    v_lshlrev_b32 v80, 16, v24
    v_and_b32 v81, s55, v24
    v_mul_f32 v80, v80, v10
    v_mul_f32 v81, v81, v10
    v_cvt_pk_bf16_f32 v24, v80, v81
    v_sub_f32 v82, v82, v8
    v_sub_f32 v83, v83, v8
    v_cvt_pk_bf16_f32 v25, v82, v83
    v_lshlrev_b32 v82, 16, v25
    v_and_b32 v83, s55, v25
    v_mul_f32 v82, v82, v10
    v_mul_f32 v83, v83, v10
    v_cvt_pk_bf16_f32 v25, v82, v83
    v_sub_f32 v84, v84, v8
    v_sub_f32 v85, v85, v8
    v_cvt_pk_bf16_f32 v26, v84, v85
    v_lshlrev_b32 v84, 16, v26
    v_and_b32 v85, s55, v26
    v_mul_f32 v84, v84, v10
    v_mul_f32 v85, v85, v10
    v_cvt_pk_bf16_f32 v26, v84, v85
    v_sub_f32 v86, v86, v8
    v_sub_f32 v87, v87, v8
    v_cvt_pk_bf16_f32 v27, v86, v87
    v_lshlrev_b32 v86, 16, v27
    v_and_b32 v87, s55, v27
    v_mul_f32 v86, v86, v10
    v_mul_f32 v87, v87, v10
    v_cvt_pk_bf16_f32 v27, v86, v87
    buffer_store_dwordx4 v[24:27], v6, s[32:35], s53 offen sc1
    s_add_u32 s53, s53, 4096
    v_sub_f32 v88, v88, v8
    v_sub_f32 v89, v89, v8
    v_cvt_pk_bf16_f32 v28, v88, v89
    v_lshlrev_b32 v88, 16, v28
    v_and_b32 v89, s55, v28
    v_mul_f32 v88, v88, v10
    v_mul_f32 v89, v89, v10
    v_cvt_pk_bf16_f32 v28, v88, v89
    v_sub_f32 v90, v90, v8
    v_sub_f32 v91, v91, v8
    v_cvt_pk_bf16_f32 v29, v90, v91
    v_lshlrev_b32 v90, 16, v29
    v_and_b32 v91, s55, v29
    v_mul_f32 v90, v90, v10
    v_mul_f32 v91, v91, v10
    v_cvt_pk_bf16_f32 v29, v90, v91
    v_sub_f32 v92, v92, v8
    v_sub_f32 v93, v93, v8
    v_cvt_pk_bf16_f32 v30, v92, v93
    v_lshlrev_b32 v92, 16, v30
    v_and_b32 v93, s55, v30
    v_mul_f32 v92, v92, v10
    v_mul_f32 v93, v93, v10
    v_cvt_pk_bf16_f32 v30, v92, v93
    v_sub_f32 v94, v94, v8
    v_sub_f32 v95, v95, v8
    v_cvt_pk_bf16_f32 v31, v94, v95
    v_lshlrev_b32 v94, 16, v31
    v_and_b32 v95, s55, v31
    v_mul_f32 v94, v94, v10
    v_mul_f32 v95, v95, v10
    v_cvt_pk_bf16_f32 v31, v94, v95
    buffer_store_dwordx4 v[28:31], v6, s[32:35], s53 offen sc1
    s_add_u32 s53, s53, 4096
    v_sub_f32 v96, v96, v8
    v_sub_f32 v97, v97, v8
    v_cvt_pk_bf16_f32 v32, v96, v97
    v_lshlrev_b32 v96, 16, v32
    v_and_b32 v97, s55, v32
    v_mul_f32 v96, v96, v10
    v_mul_f32 v97, v97, v10
    v_cvt_pk_bf16_f32 v32, v96, v97
    v_sub_f32 v98, v98, v8
    v_sub_f32 v99, v99, v8
    v_cvt_pk_bf16_f32 v33, v98, v99
    v_lshlrev_b32 v98, 16, v33
    v_and_b32 v99, s55, v33
    v_mul_f32 v98, v98, v10
    v_mul_f32 v99, v99, v10
    v_cvt_pk_bf16_f32 v33, v98, v99
    v_sub_f32 v100, v100, v8
    v_sub_f32 v101, v101, v8
    v_cvt_pk_bf16_f32 v34, v100, v101
    v_lshlrev_b32 v100, 16, v34
    v_and_b32 v101, s55, v34
    v_mul_f32 v100, v100, v10
    v_mul_f32 v101, v101, v10
    v_cvt_pk_bf16_f32 v34, v100, v101
    v_sub_f32 v102, v102, v8
    v_sub_f32 v103, v103, v8
    v_cvt_pk_bf16_f32 v35, v102, v103
    v_lshlrev_b32 v102, 16, v35
    v_and_b32 v103, s55, v35
    v_mul_f32 v102, v102, v10
    v_mul_f32 v103, v103, v10
    v_cvt_pk_bf16_f32 v35, v102, v103
    buffer_store_dwordx4 v[32:35], v6, s[32:35], s53 offen sc1
    s_add_u32 s53, s53, 4096
    v_sub_f32 v104, v104, v8
    v_sub_f32 v105, v105, v8
    v_cvt_pk_bf16_f32 v36, v104, v105
    v_lshlrev_b32 v104, 16, v36
    v_and_b32 v105, s55, v36
    v_mul_f32 v104, v104, v10
    v_mul_f32 v105, v105, v10
    v_cvt_pk_bf16_f32 v36, v104, v105
    v_sub_f32 v106, v106, v8
    v_sub_f32 v107, v107, v8
    v_cvt_pk_bf16_f32 v37, v106, v107
    v_lshlrev_b32 v106, 16, v37
    v_and_b32 v107, s55, v37
    v_mul_f32 v106, v106, v10
    v_mul_f32 v107, v107, v10
    v_cvt_pk_bf16_f32 v37, v106, v107
    v_sub_f32 v108, v108, v8
    v_sub_f32 v109, v109, v8
    v_cvt_pk_bf16_f32 v38, v108, v109
    v_lshlrev_b32 v108, 16, v38
    v_and_b32 v109, s55, v38
    v_mul_f32 v108, v108, v10
    v_mul_f32 v109, v109, v10
    v_cvt_pk_bf16_f32 v38, v108, v109
    v_sub_f32 v110, v110, v8
    v_sub_f32 v111, v111, v8
    v_cvt_pk_bf16_f32 v39, v110, v111
    v_lshlrev_b32 v110, 16, v39
    v_and_b32 v111, s55, v39
    v_mul_f32 v110, v110, v10
    v_mul_f32 v111, v111, v10
    v_cvt_pk_bf16_f32 v39, v110, v111
    buffer_store_dwordx4 v[36:39], v6, s[32:35], s53 offen sc1
    s_add_u32 s53, s53, 4096
    v_sub_f32 v112, v112, v8
    v_sub_f32 v113, v113, v8
    v_cvt_pk_bf16_f32 v40, v112, v113
    v_lshlrev_b32 v112, 16, v40
    v_and_b32 v113, s55, v40
    v_mul_f32 v112, v112, v10
    v_mul_f32 v113, v113, v10
    v_cvt_pk_bf16_f32 v40, v112, v113
    v_sub_f32 v114, v114, v8
    v_sub_f32 v115, v115, v8
    v_cvt_pk_bf16_f32 v41, v114, v115
    v_lshlrev_b32 v114, 16, v41
    v_and_b32 v115, s55, v41
    v_mul_f32 v114, v114, v10
    v_mul_f32 v115, v115, v10
    v_cvt_pk_bf16_f32 v41, v114, v115
    v_sub_f32 v116, v116, v8
    v_sub_f32 v117, v117, v8
    v_cvt_pk_bf16_f32 v42, v116, v117
    v_lshlrev_b32 v116, 16, v42
    v_and_b32 v117, s55, v42
    v_mul_f32 v116, v116, v10
    v_mul_f32 v117, v117, v10
    v_cvt_pk_bf16_f32 v42, v116, v117
    v_sub_f32 v118, v118, v8
    v_sub_f32 v119, v119, v8
    v_cvt_pk_bf16_f32 v43, v118, v119
    v_lshlrev_b32 v118, 16, v43
    v_and_b32 v119, s55, v43
    v_mul_f32 v118, v118, v10
    v_mul_f32 v119, v119, v10
    v_cvt_pk_bf16_f32 v43, v118, v119
    buffer_store_dwordx4 v[40:43], v6, s[32:35], s53 offen sc1
    s_add_u32 s53, s53, 4096
    v_sub_f32 v120, v120, v8
    v_sub_f32 v121, v121, v8
    v_cvt_pk_bf16_f32 v44, v120, v121
    v_lshlrev_b32 v120, 16, v44
    v_and_b32 v121, s55, v44
    v_mul_f32 v120, v120, v10
    v_mul_f32 v121, v121, v10
    v_cvt_pk_bf16_f32 v44, v120, v121
    v_sub_f32 v122, v122, v8
    v_sub_f32 v123, v123, v8
    v_cvt_pk_bf16_f32 v45, v122, v123
    v_lshlrev_b32 v122, 16, v45
    v_and_b32 v123, s55, v45
    v_mul_f32 v122, v122, v10
    v_mul_f32 v123, v123, v10
    v_cvt_pk_bf16_f32 v45, v122, v123
    v_sub_f32 v124, v124, v8
    v_sub_f32 v125, v125, v8
    v_cvt_pk_bf16_f32 v46, v124, v125
    v_lshlrev_b32 v124, 16, v46
    v_and_b32 v125, s55, v46
    v_mul_f32 v124, v124, v10
    v_mul_f32 v125, v125, v10
    v_cvt_pk_bf16_f32 v46, v124, v125
    v_sub_f32 v126, v126, v8
    v_sub_f32 v127, v127, v8
    v_cvt_pk_bf16_f32 v47, v126, v127
    v_lshlrev_b32 v126, 16, v47
    v_and_b32 v127, s55, v47
    v_mul_f32 v126, v126, v10
    v_mul_f32 v127, v127, v10
    v_cvt_pk_bf16_f32 v47, v126, v127
    buffer_store_dwordx4 v[44:47], v6, s[32:35], s53 offen sc1
    s_add_u32 s53, s53, 4096
    v_sub_f32 v128, v128, v8
    v_sub_f32 v129, v129, v8
    v_cvt_pk_bf16_f32 v48, v128, v129
    v_lshlrev_b32 v128, 16, v48
    v_and_b32 v129, s55, v48
    v_mul_f32 v128, v128, v10
    v_mul_f32 v129, v129, v10
    v_cvt_pk_bf16_f32 v48, v128, v129
    v_sub_f32 v130, v130, v8
    v_sub_f32 v131, v131, v8
    v_cvt_pk_bf16_f32 v49, v130, v131
    v_lshlrev_b32 v130, 16, v49
    v_and_b32 v131, s55, v49
    v_mul_f32 v130, v130, v10
    v_mul_f32 v131, v131, v10
    v_cvt_pk_bf16_f32 v49, v130, v131
    v_sub_f32 v132, v132, v8
    v_sub_f32 v133, v133, v8
    v_cvt_pk_bf16_f32 v50, v132, v133
    v_lshlrev_b32 v132, 16, v50
    v_and_b32 v133, s55, v50
    v_mul_f32 v132, v132, v10
    v_mul_f32 v133, v133, v10
    v_cvt_pk_bf16_f32 v50, v132, v133
    v_sub_f32 v134, v134, v8
    v_sub_f32 v135, v135, v8
    v_cvt_pk_bf16_f32 v51, v134, v135
    v_lshlrev_b32 v134, 16, v51
    v_and_b32 v135, s55, v51
    v_mul_f32 v134, v134, v10
    v_mul_f32 v135, v135, v10
    v_cvt_pk_bf16_f32 v51, v134, v135
    buffer_store_dwordx4 v[48:51], v6, s[32:35], s53 offen sc1
    s_add_u32 s53, s53, 4096
    v_sub_f32 v136, v136, v8
    v_sub_f32 v137, v137, v8
    v_cvt_pk_bf16_f32 v52, v136, v137
    v_lshlrev_b32 v136, 16, v52
    v_and_b32 v137, s55, v52
    v_mul_f32 v136, v136, v10
    v_mul_f32 v137, v137, v10
    v_cvt_pk_bf16_f32 v52, v136, v137
    v_sub_f32 v138, v138, v8
    v_sub_f32 v139, v139, v8
    v_cvt_pk_bf16_f32 v53, v138, v139
    v_lshlrev_b32 v138, 16, v53
    v_and_b32 v139, s55, v53
    v_mul_f32 v138, v138, v10
    v_mul_f32 v139, v139, v10
    v_cvt_pk_bf16_f32 v53, v138, v139
    v_sub_f32 v140, v140, v8
    v_sub_f32 v141, v141, v8
    v_cvt_pk_bf16_f32 v54, v140, v141
    v_lshlrev_b32 v140, 16, v54
    v_and_b32 v141, s55, v54
    v_mul_f32 v140, v140, v10
    v_mul_f32 v141, v141, v10
    v_cvt_pk_bf16_f32 v54, v140, v141
    v_sub_f32 v142, v142, v8
    v_sub_f32 v143, v143, v8
    v_cvt_pk_bf16_f32 v55, v142, v143
    v_lshlrev_b32 v142, 16, v55
    v_and_b32 v143, s55, v55
    v_mul_f32 v142, v142, v10
    v_mul_f32 v143, v143, v10
    v_cvt_pk_bf16_f32 v55, v142, v143
    buffer_store_dwordx4 v[52:55], v6, s[32:35], s53 offen sc1
    s_cmp_ge_u32 s94, 108
    s_cbranch_scc1 Llnb
    s_waitcnt vmcnt(0)
    s_barrier
    s_cmp_lg_u32 s3, 0
    s_cbranch_scc1 Lsgln_89
    s_mov_b64 exec, 1
    v_mov_b32 v8, 1
    buffer_atomic_add v8, off, s[44:47], 0 offset:32 sc1
    s_mov_b64 exec, -1
Lsgln_89:
Llnb:
    s_add_u32 s94, s94, 108
    s_cmp_lt_u32 s94, 256
    s_cbranch_scc1 Llnloop
    s_mul_i32 s94, s90, 5
    s_min_u32 s94, s94, 507
    s_lshl_b32 s94, s94, 10
    s_add_u32 s94, s94, 83361792
    v_lshlrev_b32 v1, 4, v0
    v_and_b32 v1, 0x3f0, v1
    v_mov_b32 v152, 0xffbfffbf
    v_mov_b32 v153, 0xffbfffbf
    v_mov_b32 v154, 0xffbfffbf
    v_mov_b32 v155, 0xffbfffbf
    s_add_u32 s95, s94, 4194304
    buffer_store_dwordx4 v[152:155], v1, s[32:35], s94 offen sc1
    buffer_store_dwordx4 v[152:155], v1, s[32:35], s95 offen sc1
    s_add_u32 s94, s94, 1024
    s_add_u32 s95, s94, 4194304
    buffer_store_dwordx4 v[152:155], v1, s[32:35], s94 offen sc1
    buffer_store_dwordx4 v[152:155], v1, s[32:35], s95 offen sc1
    s_add_u32 s94, s94, 1024
    s_add_u32 s95, s94, 4194304
    buffer_store_dwordx4 v[152:155], v1, s[32:35], s94 offen sc1
    buffer_store_dwordx4 v[152:155], v1, s[32:35], s95 offen sc1
    s_add_u32 s94, s94, 1024
    s_add_u32 s95, s94, 4194304
    buffer_store_dwordx4 v[152:155], v1, s[32:35], s94 offen sc1
    buffer_store_dwordx4 v[152:155], v1, s[32:35], s95 offen sc1
    s_add_u32 s94, s94, 1024
    s_add_u32 s95, s94, 4194304
    buffer_store_dwordx4 v[152:155], v1, s[32:35], s94 offen sc1
    buffer_store_dwordx4 v[152:155], v1, s[32:35], s95 offen sc1
    s_add_u32 s94, s94, 1024
    s_mul_i32 s94, s90, 3
    s_min_u32 s94, s94, 253
    s_lshl_b32 s94, s94, 10
    s_add_u32 s94, s94, 71041024
    buffer_store_dwordx4 v[152:155], v1, s[32:35], s94 offen offset:0 sc1
    buffer_store_dwordx4 v[152:155], v1, s[32:35], s94 offen offset:1024 sc1
    buffer_store_dwordx4 v[152:155], v1, s[32:35], s94 offen offset:2048 sc1
    s_waitcnt vmcnt(0)
    s_barrier
    s_cmp_lg_u32 s3, 0
    s_cbranch_scc1 Lsglb_90
    s_mov_b64 exec, 1
    v_mov_b32 v8, 256
    buffer_atomic_add v8, off, s[44:47], 0 offset:32 sc1
    s_mov_b64 exec, -1
Lsglb_90:
    s_mov_b32 s89, 0
    v_and_b32 v1, 63, v0
    v_lshlrev_b32 v2, 4, v1
    v_lshrrev_b32 v5, 5, v1
    v_bfe_u32 v6, v1, 2, 2
    v_lshl_add_u32 v3, v5, 2, v6
    v_lshlrev_b32 v3, 3, v3
    v_and_b32 v6, 1, v1
    v_lshl_add_u32 v3, v6, 7, v3
    s_lshl_b32 s52, s3, 11
    v_add_u32 v3, s52, v3
    v_and_b32 v6, 31, v1
    v_and_b32 v4, 15, v1
    v_lshlrev_b32 v4, 3, v4
    v_lshl_add_u32 v4, v5, 7, v4
    v_bfe_u32 v7, v1, 4, 1
    v_lshl_add_u32 v4, v7, 8, v4
    v_lshlrev_b32 v5, 2, v5
    v_sub_u32 v6, v6, v5
    v_mov_b32 v7, 0xf149f2ca
    v_cmp_gt_i32 vcc, 0, v6
    s_nop 1
    v_cndmask_b32 v152, 0, v7, vcc
    v_cmp_gt_i32 vcc, 1, v6
    s_nop 1
    v_cndmask_b32 v153, 0, v7, vcc
    v_cmp_gt_i32 vcc, 2, v6
    s_nop 1
    v_cndmask_b32 v154, 0, v7, vcc
    v_cmp_gt_i32 vcc, 3, v6
    s_nop 1
    v_cndmask_b32 v155, 0, v7, vcc
    v_cmp_gt_i32 vcc, 8, v6
    s_nop 1
    v_cndmask_b32 v156, 0, v7, vcc
    v_cmp_gt_i32 vcc, 9, v6
    s_nop 1
    v_cndmask_b32 v157, 0, v7, vcc
    v_cmp_gt_i32 vcc, 10, v6
    s_nop 1
    v_cndmask_b32 v158, 0, v7, vcc
    v_cmp_gt_i32 vcc, 11, v6
    s_nop 1
    v_cndmask_b32 v159, 0, v7, vcc
    v_cmp_gt_i32 vcc, 16, v6
    s_nop 1
    v_cndmask_b32 v160, 0, v7, vcc
    v_cmp_gt_i32 vcc, 17, v6
    s_nop 1
    v_cndmask_b32 v161, 0, v7, vcc
    v_cmp_gt_i32 vcc, 18, v6
    s_nop 1
    v_cndmask_b32 v162, 0, v7, vcc
    v_cmp_gt_i32 vcc, 19, v6
    s_nop 1
    v_cndmask_b32 v163, 0, v7, vcc
    v_cmp_gt_i32 vcc, 24, v6
    s_nop 1
    v_cndmask_b32 v164, 0, v7, vcc
    v_cmp_gt_i32 vcc, 25, v6
    s_nop 1
    v_cndmask_b32 v165, 0, v7, vcc
    v_cmp_gt_i32 vcc, 26, v6
    s_nop 1
    v_cndmask_b32 v166, 0, v7, vcc
    v_cmp_gt_i32 vcc, 27, v6
    s_nop 1
    v_cndmask_b32 v167, 0, v7, vcc
    s_mov_b32 s53, 0.12751743082459868
    v_add_u32 v14, s52, v2
    s_mov_b32 s87, 0xffbfffbf
    v_and_b32 v10, 15, v1
    v_min_u32 v10, 8, v10
    v_lshlrev_b32 v10, 2, v10
    s_cmp_lg_u32 s3, 0
    s_cbranch_scc1 Lwkrl_93
Lwrl_92:
    s_sub_u32 s100, s100, 1
    s_cselect_b32 s100, 0, s100
    s_cbranch_scc1 Lwkrl_93
    buffer_load_dword v7, off, s[44:47], 0 offset:140 sc1
    s_waitcnt vmcnt(0)
    v_readfirstlane_b32 s95, v7
    s_nop 0
    s_cmp_lg_u32 s95, 0
    s_cbranch_scc1 Lwkrl_93
    s_sleep 24
    s_branch Lwrl_92
Lwkrl_93:
    s_waitcnt vmcnt(0)
Lnp_91:
    s_cmp_lg_u32 s3, 0
    s_cbranch_scc1 Lwkln_95
Lwln_94:
    s_sub_u32 s100, s100, 1
    s_cselect_b32 s100, 0, s100
    s_cbranch_scc1 Lwkln_95
    buffer_load_dword v7, off, s[44:47], 0 offset:32 sc1
    s_waitcnt vmcnt(0)
    v_readfirstlane_b32 s95, v7
    s_nop 0
    s_and_b32 s95, s95, 0xff
    s_cmp_ge_u32 s95, 27
    s_cbranch_scc1 Lwkln_95
    s_sleep 2
    s_branch Lwln_94
Lwkln_95:
    s_waitcnt vmcnt(0)
    s_barrier
    s_mov_b32 s91, 0
    s_mov_b32 s92, 0
Latloop:
    s_lshr_b32 s93, s90, 5
    s_cmp_ge_u32 s93, 56
    s_cselect_b32 s88, 2, 0
    s_cmp_ge_u32 s93, 63
    s_cselect_b32 s88, 3, s88
    s_sub_u32 s88, s93, s88
    s_cmp_eq_u32 s91, 0
    s_cbranch_scc1 Laq_96p
Laqk_97:
    s_lshl_b32 s54, s90, 13
    s_add_u32 s55, s54, 20971520
    buffer_load_dwordx4 v[48:51], v2, s[32:35], s55 offen offset:0 sc1
    buffer_load_dwordx4 v[52:55], v2, s[32:35], s55 offen offset:1024 sc1
    buffer_load_dwordx4 v[56:59], v2, s[32:35], s55 offen offset:2048 sc1
    buffer_load_dwordx4 v[60:63], v2, s[32:35], s55 offen offset:3072 sc1
    s_add_u32 s55, s54, 20975616
    buffer_load_dwordx4 v[64:67], v2, s[32:35], s55 offen offset:0 sc1
    buffer_load_dwordx4 v[68:71], v2, s[32:35], s55 offen offset:1024 sc1
    buffer_load_dwordx4 v[72:75], v2, s[32:35], s55 offen offset:2048 sc1
    buffer_load_dwordx4 v[76:79], v2, s[32:35], s55 offen offset:3072 sc1
    s_add_u32 s55, s54, 4194304
    buffer_load_dwordx4 v[16:19], v2, s[32:35], s55 offen offset:0 sc1
    buffer_load_dwordx4 v[20:23], v2, s[32:35], s55 offen offset:1024 sc1
    buffer_load_dwordx4 v[24:27], v2, s[32:35], s55 offen offset:2048 sc1
    buffer_load_dwordx4 v[28:31], v2, s[32:35], s55 offen offset:3072 sc1
    s_add_u32 s55, s54, 4198400
    buffer_load_dwordx4 v[32:35], v2, s[32:35], s55 offen offset:0 sc1
    buffer_load_dwordx4 v[36:39], v2, s[32:35], s55 offen offset:1024 sc1
    buffer_load_dwordx4 v[40:43], v2, s[32:35], s55 offen offset:2048 sc1
    buffer_load_dwordx4 v[44:47], v2, s[32:35], s55 offen offset:3072 sc1
    s_add_u32 s55, s54, 37748736
    buffer_load_dwordx4 v[80:83], v2, s[32:35], s55 offen offset:0 sc1
    buffer_load_dwordx4 v[84:87], v2, s[32:35], s55 offen offset:1024 sc1
    buffer_load_dwordx4 v[88:91], v2, s[32:35], s55 offen offset:2048 sc1
    buffer_load_dwordx4 v[92:95], v2, s[32:35], s55 offen offset:3072 sc1
    s_add_u32 s55, s54, 37752832
    buffer_load_dwordx4 v[96:99], v2, s[32:35], s55 offen offset:0 sc1
    buffer_load_dwordx4 v[100:103], v2, s[32:35], s55 offen offset:1024 sc1
    buffer_load_dwordx4 v[104:107], v2, s[32:35], s55 offen offset:2048 sc1
    buffer_load_dwordx4 v[108:111], v2, s[32:35], s55 offen offset:3072 sc1
    s_waitcnt vmcnt(15)
    v_mfma_f32_32x32x16_bf16 v[168:183], v[48:51], v[16:19], v[152:167]
    s_waitcnt vmcnt(14)
    v_mfma_f32_32x32x16_bf16 v[168:183], v[52:55], v[20:23], v[168:183]
    s_waitcnt vmcnt(13)
    v_mfma_f32_32x32x16_bf16 v[168:183], v[56:59], v[24:27], v[168:183]
    s_waitcnt vmcnt(12)
    v_mfma_f32_32x32x16_bf16 v[168:183], v[60:63], v[28:31], v[168:183]
    s_waitcnt vmcnt(11)
    v_mfma_f32_32x32x16_bf16 v[168:183], v[64:67], v[32:35], v[168:183]
    s_waitcnt vmcnt(10)
    v_mfma_f32_32x32x16_bf16 v[168:183], v[68:71], v[36:39], v[168:183]
    s_waitcnt vmcnt(9)
    v_mfma_f32_32x32x16_bf16 v[168:183], v[72:75], v[40:43], v[168:183]
    s_waitcnt vmcnt(8)
    v_mfma_f32_32x32x16_bf16 v[168:183], v[76:79], v[44:47], v[168:183]
    s_lshl_b32 s56, s90, 11
    s_mov_b32 m0, s52
    v_mov_b32 v200, 0xffbfffbf
    v_mov_b32 v201, 0xffbfffbf
    v_mov_b32 v202, 0xffbfffbf
    v_mov_b32 v203, 0xffbfffbf
    v_mov_b32 v145, 0xffbfffbf
    v_mov_b32 v147, 0xffbfffbf
    v_mov_b32 v149, 0xffbfffbf
    v_mov_b32 v151, 0xffbfffbf
    ds_write_b128 v14, v[200:203]
    ds_write_b128 v14, v[200:203] offset:1024
    v_max3_f32 v8, v168, v169, v170
    v_max3_f32 v9, v171, v172, v173
    v_max3_f32 v8, v8, v174, v175
    v_max3_f32 v9, v9, v176, v177
    v_max3_f32 v8, v8, v178, v179
    v_max3_f32 v9, v9, v180, v181
    v_max3_f32 v8, v8, v182, v183
    v_max_f32 v8, v8, v9
    s_waitcnt lgkmcnt(0)
    s_cmp_lt_i32 s88, s92
    s_cbranch_scc0 Lak_98
Lakk_99:
    s_cmp_ge_u32 s93, 63
    s_cbranch_scc0 Lkvld
    s_waitcnt vmcnt(0)
    s_add_u32 s95, s92, 1
    s_cmp_lt_i32 s95, s93
    s_cbranch_scc0 Lkvld
    s_sleep 32
Lkvld:
    s_add_u32 s55, s56, 79691776
    buffer_load_dwordx4 v2, s[32:35], s55 offen sc1 lds
    buffer_load_dwordx4 v2, s[32:35], s55 offen offset:1024 sc1 lds
    s_add_u32 s55, s56, 83886080
    buffer_load_dwordx2 v[144:145], v4, s[32:35], s55 offen offset:0 sc1
    buffer_load_dwordx2 v[146:147], v4, s[32:35], s55 offen offset:512 sc1
    buffer_load_dwordx2 v[148:149], v4, s[32:35], s55 offen offset:1024 sc1
    buffer_load_dwordx2 v[150:151], v4, s[32:35], s55 offen offset:1536 sc1
    s_mov_b32 s86, 1
    s_cmp_ge_u32 s93, 63
    s_cbranch_scc1 Lkvc
    s_waitcnt vmcnt(0)
Lkvc:
    ds_read_b128 v[200:203], v14
    ds_read_b128 v[204:207], v14 offset:1024
    v_cmpx_ne_u32 vcc, s87, v145
    v_cmpx_ne_u32 vcc, s87, v147
    v_cmpx_ne_u32 vcc, s87, v149
    v_cmpx_ne_u32 vcc, s87, v151
    s_waitcnt lgkmcnt(1)
    v_cmpx_ne_u32 vcc, s87, v200
    v_cmpx_ne_u32 vcc, s87, v202
    s_waitcnt lgkmcnt(0)
    v_cmpx_ne_u32 vcc, s87, v204
    v_cmpx_ne_u32 vcc, s87, v206
    s_nop 0
    s_cmp_eq_u64 exec, -1
    s_mov_b64 exec, -1
    s_cbranch_scc1 Lkvok
    s_sub_u32 s86, s86, 1
    s_cbranch_scc0 Lkvc
    s_sub_u32 s100, s100, 1
    s_cselect_b32 s100, 0, s100
    s_cbranch_scc0 Lkvld
Lkvok:
    ds_read_b64_tr_b16 v[112:113], v3 offset:0
    ds_read_b64_tr_b16 v[114:115], v3 offset:64
    ds_read_b64_tr_b16 v[116:117], v3 offset:256
    ds_read_b64_tr_b16 v[118:119], v3 offset:320
    ds_read_b64_tr_b16 v[120:121], v3 offset:512
    ds_read_b64_tr_b16 v[122:123], v3 offset:576
    ds_read_b64_tr_b16 v[124:125], v3 offset:768
    ds_read_b64_tr_b16 v[126:127], v3 offset:832
    ds_read_b64_tr_b16 v[128:129], v3 offset:1024
    ds_read_b64_tr_b16 v[130:131], v3 offset:1088
    ds_read_b64_tr_b16 v[132:133], v3 offset:1280
    ds_read_b64_tr_b16 v[134:135], v3 offset:1344
    ds_read_b64_tr_b16 v[136:137], v3 offset:1536
    ds_read_b64_tr_b16 v[138:139], v3 offset:1600
    ds_read_b64_tr_b16 v[140:141], v3 offset:1792
    ds_read_b64_tr_b16 v[142:143], v3 offset:1856
    s_waitcnt lgkmcnt(14)
    v_mfma_f32_32x32x16_bf16 v[184:199], v[112:115], v[16:19], 0
    s_waitcnt lgkmcnt(12)
    v_mfma_f32_32x32x16_bf16 v[184:199], v[116:119], v[20:23], v[184:199]
    s_waitcnt lgkmcnt(10)
    v_mfma_f32_32x32x16_bf16 v[184:199], v[120:123], v[24:27], v[184:199]
    s_waitcnt lgkmcnt(8)
    v_mfma_f32_32x32x16_bf16 v[184:199], v[124:127], v[28:31], v[184:199]
    s_waitcnt lgkmcnt(6)
    v_mfma_f32_32x32x16_bf16 v[184:199], v[128:131], v[32:35], v[184:199]
    s_waitcnt lgkmcnt(4)
    v_mfma_f32_32x32x16_bf16 v[184:199], v[132:135], v[36:39], v[184:199]
    s_waitcnt lgkmcnt(2)
    v_mfma_f32_32x32x16_bf16 v[184:199], v[136:139], v[40:43], v[184:199]
    s_waitcnt lgkmcnt(0)
    v_mfma_f32_32x32x16_bf16 v[184:199], v[140:143], v[44:47], v[184:199]
    v_mov_b32 v11, 1
    s_cmp_eq_u32 s93, 63
    s_cselect_b32 s94, 0x5702780, s34
    s_mov_b64 exec, 1
    buffer_atomic_add v11, off, s[32:35], s94 sc1
    s_mov_b64 exec, -1
    s_nop 5
    v_max3_f32 v8, v8, v184, v185
    v_max3_f32 v8, v8, v186, v187
    v_mov_b32 v9, v8
    s_nop 1
    v_permlane32_swap_b32 v8, v9
    v_max_f32 v8, v8, v9
    v_mul_f32 v8, s53, v8
    v_fma_f32 v168, v168, s53, -v8
    v_fma_f32 v169, v169, s53, -v8
    v_fma_f32 v170, v170, s53, -v8
    v_fma_f32 v171, v171, s53, -v8
    v_fma_f32 v172, v172, s53, -v8
    v_fma_f32 v173, v173, s53, -v8
    v_fma_f32 v174, v174, s53, -v8
    v_fma_f32 v175, v175, s53, -v8
    v_fma_f32 v176, v176, s53, -v8
    v_fma_f32 v177, v177, s53, -v8
    v_fma_f32 v178, v178, s53, -v8
    v_fma_f32 v179, v179, s53, -v8
    v_fma_f32 v180, v180, s53, -v8
    v_fma_f32 v181, v181, s53, -v8
    v_fma_f32 v182, v182, s53, -v8
    v_fma_f32 v183, v183, s53, -v8
    v_fma_f32 v184, v184, s53, -v8
    v_fma_f32 v185, v185, s53, -v8
    v_fma_f32 v186, v186, s53, -v8
    v_fma_f32 v187, v187, s53, -v8
    v_exp_f32 v168, v168
    v_exp_f32 v169, v169
    v_exp_f32 v170, v170
    v_exp_f32 v171, v171
    v_exp_f32 v172, v172
    v_exp_f32 v173, v173
    v_exp_f32 v174, v174
    v_exp_f32 v175, v175
    v_exp_f32 v176, v176
    v_exp_f32 v177, v177
    v_exp_f32 v178, v178
    v_exp_f32 v179, v179
    v_exp_f32 v180, v180
    v_exp_f32 v181, v181
    v_exp_f32 v182, v182
    v_exp_f32 v183, v183
    v_exp_f32 v184, v184
    v_exp_f32 v185, v185
    v_exp_f32 v186, v186
    v_exp_f32 v187, v187
    v_add_f32 v8, v168, v169
    v_add_f32 v9, v170, v171
    v_add_f32 v8, v8, v172
    v_add_f32 v9, v9, v173
    v_add_f32 v8, v8, v174
    v_add_f32 v9, v9, v175
    v_add_f32 v8, v8, v176
    v_add_f32 v9, v9, v177
    v_add_f32 v8, v8, v178
    v_add_f32 v9, v9, v179
    v_add_f32 v8, v8, v180
    v_add_f32 v9, v9, v181
    v_add_f32 v8, v8, v182
    v_add_f32 v9, v9, v183
    v_add_f32 v8, v8, v184
    v_add_f32 v9, v9, v185
    v_add_f32 v8, v8, v186
    v_add_f32 v9, v9, v187
    v_add_f32 v8, v8, v9
    v_mov_b32 v9, v8
    s_nop 1
    v_permlane32_swap_b32 v8, v9
    v_add_f32 v8, v8, v9
    v_rcp_f32 v8, v8
    s_nop 0
    v_mul_f32 v168, v168, v8
    v_mul_f32 v169, v169, v8
    v_mul_f32 v170, v170, v8
    v_mul_f32 v171, v171, v8
    v_mul_f32 v172, v172, v8
    v_mul_f32 v173, v173, v8
    v_mul_f32 v174, v174, v8
    v_mul_f32 v175, v175, v8
    v_mul_f32 v176, v176, v8
    v_mul_f32 v177, v177, v8
    v_mul_f32 v178, v178, v8
    v_mul_f32 v179, v179, v8
    v_mul_f32 v180, v180, v8
    v_mul_f32 v181, v181, v8
    v_mul_f32 v182, v182, v8
    v_mul_f32 v183, v183, v8
    v_mul_f32 v184, v184, v8
    v_mul_f32 v185, v185, v8
    v_mul_f32 v186, v186, v8
    v_mul_f32 v187, v187, v8
    v_cvt_pk_bf16_f32 v200, v168, v169
    v_cvt_pk_bf16_f32 v201, v170, v171
    v_cvt_pk_bf16_f32 v202, v172, v173
    v_cvt_pk_bf16_f32 v203, v174, v175
    v_cvt_pk_bf16_f32 v204, v176, v177
    v_cvt_pk_bf16_f32 v205, v178, v179
    v_cvt_pk_bf16_f32 v206, v180, v181
    v_cvt_pk_bf16_f32 v207, v182, v183
    v_cvt_pk_bf16_f32 v208, v184, v185
    v_cvt_pk_bf16_f32 v209, v186, v187
    s_nop 1
    v_mfma_f32_32x32x8_bf16 v[16:31], v[144:145], v[208:209], 0
    v_mfma_f32_32x32x8_bf16 v[32:47], v[146:147], v[208:209], 0
    v_mfma_f32_32x32x8_bf16 v[48:63], v[148:149], v[208:209], 0
    v_mfma_f32_32x32x8_bf16 v[64:79], v[150:151], v[208:209], 0
    v_mfma_f32_32x32x16_bf16 v[16:31], v[80:83], v[200:203], v[16:31]
    v_mfma_f32_32x32x16_bf16 v[32:47], v[88:91], v[200:203], v[32:47]
    v_mfma_f32_32x32x16_bf16 v[48:63], v[96:99], v[200:203], v[48:63]
    v_mfma_f32_32x32x16_bf16 v[64:79], v[104:107], v[200:203], v[64:79]
    v_mfma_f32_32x32x16_bf16 v[16:31], v[84:87], v[204:207], v[16:31]
    v_mfma_f32_32x32x16_bf16 v[32:47], v[92:95], v[204:207], v[32:47]
    v_mfma_f32_32x32x16_bf16 v[48:63], v[100:103], v[204:207], v[48:63]
    v_mfma_f32_32x32x16_bf16 v[64:79], v[108:111], v[204:207], v[64:79]
    s_add_u32 s55, s54, 54525952
    v_cvt_pk_bf16_f32 v112, v16, v17
    v_cvt_pk_bf16_f32 v113, v18, v19
    v_cvt_pk_bf16_f32 v114, v20, v21
    v_cvt_pk_bf16_f32 v115, v22, v23
    buffer_store_dwordx4 v[112:115], v2, s[32:35], s55 offen offset:0 sc1
    v_cvt_pk_bf16_f32 v116, v24, v25
    v_cvt_pk_bf16_f32 v117, v26, v27
    v_cvt_pk_bf16_f32 v118, v28, v29
    v_cvt_pk_bf16_f32 v119, v30, v31
    buffer_store_dwordx4 v[116:119], v2, s[32:35], s55 offen offset:1024 sc1
    v_cvt_pk_bf16_f32 v120, v32, v33
    v_cvt_pk_bf16_f32 v121, v34, v35
    v_cvt_pk_bf16_f32 v122, v36, v37
    v_cvt_pk_bf16_f32 v123, v38, v39
    buffer_store_dwordx4 v[120:123], v2, s[32:35], s55 offen offset:2048 sc1
    v_cvt_pk_bf16_f32 v124, v40, v41
    v_cvt_pk_bf16_f32 v125, v42, v43
    v_cvt_pk_bf16_f32 v126, v44, v45
    v_cvt_pk_bf16_f32 v127, v46, v47
    buffer_store_dwordx4 v[124:127], v2, s[32:35], s55 offen offset:3072 sc1
    s_add_u32 s55, s54, 54530048
    v_cvt_pk_bf16_f32 v128, v48, v49
    v_cvt_pk_bf16_f32 v129, v50, v51
    v_cvt_pk_bf16_f32 v130, v52, v53
    v_cvt_pk_bf16_f32 v131, v54, v55
    buffer_store_dwordx4 v[128:131], v2, s[32:35], s55 offen offset:0 sc1
    v_cvt_pk_bf16_f32 v132, v56, v57
    v_cvt_pk_bf16_f32 v133, v58, v59
    v_cvt_pk_bf16_f32 v134, v60, v61
    v_cvt_pk_bf16_f32 v135, v62, v63
    buffer_store_dwordx4 v[132:135], v2, s[32:35], s55 offen offset:1024 sc1
    v_cvt_pk_bf16_f32 v136, v64, v65
    v_cvt_pk_bf16_f32 v137, v66, v67
    v_cvt_pk_bf16_f32 v138, v68, v69
    v_cvt_pk_bf16_f32 v139, v70, v71
    buffer_store_dwordx4 v[136:139], v2, s[32:35], s55 offen offset:2048 sc1
    v_cvt_pk_bf16_f32 v140, v72, v73
    v_cvt_pk_bf16_f32 v141, v74, v75
    v_cvt_pk_bf16_f32 v142, v76, v77
    v_cvt_pk_bf16_f32 v143, v78, v79
    buffer_store_dwordx4 v[140:143], v2, s[32:35], s55 offen offset:3072 sc1
    v_mov_b32 v11, 1
    s_lshl_b32 s94, s93, 7
    s_add_u32 s94, s94, 91228160
    s_cmp_eq_u32 s93, 63
    s_cselect_b32 s94, s34, s94
    s_mov_b64 exec, 1
    s_waitcnt vmcnt(0)
    buffer_atomic_add v11, off, s[32:35], s94 sc1
    s_mov_b64 exec, -1
    s_add_u32 s89, s89, 1
    s_add_u32 s90, s90, 108
    s_cmp_lt_u32 s90, 2048
    s_cbranch_scc1 Latloop
    s_endpgm
Laq_96p:
    s_bfe_u32 s94, s90, 0x40001
    s_lshl_b32 s94, s94, 7
    s_add_u32 s94, s94, 91226112
Laq_96:
    s_sub_u32 s100, s100, 1
    s_cselect_b32 s100, 0, s100
    s_cbranch_scc1 Laqk_97
    buffer_load_dword v11, v10, s[32:35], s94 offen sc1
    buffer_load_dword v12, off, s[44:47], 0 offset:32 sc1
    s_waitcnt vmcnt(0)
    v_min_u32_dpp v11, v11, v11 row_ror:8 row_mask:0xf bank_mask:0xf
    s_nop 1
    v_min_u32_dpp v11, v11, v11 row_ror:4 row_mask:0xf bank_mask:0xf
    s_nop 1
    v_min_u32_dpp v11, v11, v11 row_ror:2 row_mask:0xf bank_mask:0xf
    s_nop 1
    v_min_u32_dpp v11, v11, v11 row_ror:1 row_mask:0xf bank_mask:0xf
    v_readfirstlane_b32 s95, v12
    s_nop 0
    s_lshr_b32 s95, s95, 16
    s_cmp_ge_u32 s95, 165
    s_cselect_b32 s91, 1, 0
    v_readfirstlane_b32 s95, v11
    s_nop 0
    s_mul_i32 s95, s95, 3
    s_cmp_lt_u32 s93, s95
    s_cbranch_scc1 Laqk_97
    s_sleep 8
    s_branch Laq_96
Lak_98:
    s_sub_u32 s100, s100, 1
    s_cselect_b32 s100, 0, s100
    s_cbranch_scc1 Lakk_99
    s_and_b32 s95, s101, 7
    s_lshl_b32 s95, s95, 7
    s_add_u32 s95, s95, 0x5702800
    buffer_load_dword v13, off, s[32:35], s95 sc1
    s_waitcnt vmcnt(0)
    v_readfirstlane_b32 s92, v13
    s_nop 0
    s_sub_u32 s92, s92, 1
    s_cmp_lt_i32 s88, s92
    s_cbranch_scc1 Lakk_99
    s_sleep 8
    s_branch Lak_98
Lend:
    s_endpgm
Lcode_end:

.section .rodata,"a"
.p2align 6
.amdhsa_kernel recurrent_scan__memory_aug_recurrent_mem_tr__dense_activation_mish__prompt_kernel
  .amdhsa_next_free_vgpr 512
  .amdhsa_next_free_sgpr 102
  .amdhsa_accum_offset 256
  .amdhsa_group_segment_fixed_size 0
  .amdhsa_kernarg_size 112
  .amdhsa_user_sgpr_count 2
  .amdhsa_user_sgpr_kernarg_segment_ptr 1
  .amdhsa_system_sgpr_workgroup_id_x 1
.end_amdhsa_kernel
```
